```python
import torch

def _softmax(x, axis=-1):
    return torch.softmax(x, dim=axis)
def _gelu(x):
    return torch.nn.functional.gelu(x, approximate="tanh")
def _silu(x):
    return torch.nn.functional.silu(x)
def _sigmoid(x):
    return torch.sigmoid(x)
def _layernorm(x, axis=-1, eps=1e-5):
    m = x.mean(dim=axis, keepdim=True)
    v = x.var(dim=axis, keepdim=True, unbiased=False)
    return (x - m) / torch.sqrt(v + eps)
def _scatter_add(tgt, idx, src, axis=0):
    return tgt.clone().index_add_(axis, idx, src)
def _segment_sum(src, seg, n):
    out = torch.zeros((n,) + src.shape[1:], dtype=src.dtype)
    return out.index_add_(0, seg, src)
def _pad(x, pw):
    flat = tuple(v for pair in reversed(pw) for v in pair)
    return torch.nn.functional.pad(x, flat)

kernel_name = 'concat_heads__mha_block_cached__mha_block_cached__near_ridge'

def setup_inputs():

    _w = (lambda a: (lambda t: t.to(torch.bfloat16) if t.is_floating_point() else t)(torch.as_tensor(a)))
    def _A_setup():
        B, Sq, D = 8, 128, 576
        H, Sk, Dh = 32, 512, 128
        return {
            "x": _w((lambda *s: torch.randn(*s, dtype=torch.bfloat16) * 0.8)(B, Sq, D)),
            "k_cache": _w((lambda *s: torch.randn(*s, dtype=torch.bfloat16) * 0.8)(B, H, Sk, Dh)),
            "v_cache": _w((lambda *s: torch.randn(*s, dtype=torch.bfloat16) * 0.05)(B, H, Sk, Dh)),
            "wq": _w((lambda *s: torch.randn(*s, dtype=torch.bfloat16) * 0.8)(D, H * Dh) * (D ** -0.5)),
            "wo": _w((lambda *s: torch.randn(*s, dtype=torch.bfloat16) * 0.05)(H * Dh, D) * ((H * Dh) ** -0.5)),
        }
    _A_in = _A_setup()

    def _B_setup():
        B, Sq, D = 8, 128, 576
        H, Sk, Dh = 32, 512, 128
        return {
            "x": _w((lambda *s: torch.randn(*s, dtype=torch.bfloat16) * 0.8)(B, Sq, D)),
            "k_cache": _w((lambda *s: torch.randn(*s, dtype=torch.bfloat16) * 0.8)(B, H, Sk, Dh)),
            "v_cache": _w((lambda *s: torch.randn(*s, dtype=torch.bfloat16) * 0.05)(B, H, Sk, Dh)),
            "wq": _w((lambda *s: torch.randn(*s, dtype=torch.bfloat16) * 0.8)(D, H * Dh) * (D ** -0.5)),
            "wo": _w((lambda *s: torch.randn(*s, dtype=torch.bfloat16) * 0.05)(H * Dh, D) * ((H * Dh) ** -0.5)),
        }
    _B_in = _B_setup()

    return {
        "A_x": _A_in["x"],
        "A_k_cache": _A_in["k_cache"],
        "A_v_cache": _A_in["v_cache"],
        "A_wq": _A_in["wq"],
        "A_wo": _A_in["wo"],
        "B_x": _B_in["x"],
        "B_k_cache": _B_in["k_cache"],
        "B_v_cache": _B_in["v_cache"],
        "B_wq": _B_in["wq"],
        "B_wo": _B_in["wo"],
    }

def reference(A_x, A_k_cache, A_v_cache, A_wq, A_wo, B_x, B_k_cache, B_v_cache, B_wq, B_wo):
    def _A_ref(x, k_cache, v_cache, wq, wo):
        B, Sq, D = x.shape
        H, Dh = 32, 128
        q = (lambda x, *d: x.permute(*d))((x @ wq).reshape(B, Sq, H, Dh), 0, 2, 1, 3)
        scores = torch.einsum("bhqd,bhkd->bhqk", q, k_cache) * (Dh ** -0.5)
        p = _softmax(scores, axis=-1)
        o = torch.einsum("bhqk,bhkd->bhqd", p, v_cache)
        return (lambda x, *d: x.permute(*d))(o, 0, 2, 1, 3).reshape(B, Sq, H * Dh) @ wo

    def _B_ref(x, k_cache, v_cache, wq, wo):
        B, Sq, D = x.shape
        H, Dh = 32, 128
        q = (lambda x, *d: x.permute(*d))((x @ wq).reshape(B, Sq, H, Dh), 0, 2, 1, 3)
        scores = torch.einsum("bhqd,bhkd->bhqk", q, k_cache) * (Dh ** -0.5)
        p = _softmax(scores, axis=-1)
        o = torch.einsum("bhqk,bhkd->bhqd", p, v_cache)
        return (lambda x, *d: x.permute(*d))(o, 0, 2, 1, 3).reshape(B, Sq, H * Dh) @ wo

    a = _A_ref(A_x, A_k_cache, A_v_cache, A_wq, A_wo)
    b = _B_ref(B_x, B_k_cache, B_v_cache, B_wq, B_wo)
    return torch.concatenate([a, b], axis=-1)
```

```asm
; @launch grid=(256,1,1) block=(512,1,1) lds=163840
.amdgcn_target "amdgcn-amd-amdhsa--gfx950"
.text
.globl concat_heads__mha_block_cached__mha_block_cached__near_ridge_kernel
.p2align 8
.type concat_heads__mha_block_cached__mha_block_cached__near_ridge_kernel,@function
concat_heads__mha_block_cached__mha_block_cached__near_ridge_kernel:
L_start:
    s_cmp_ge_u32 s2, 256
    s_cbranch_scc1 L_end
    s_load_dwordx16 s[16:31], s[0:1], 0
    s_load_dwordx8 s[32:39], s[0:1], 64
    s_load_dwordx2 s[40:41], s[0:1], 96
    v_lshrrev_b32 v3, 6, v0
    v_and_b32 v2, 63, v0
    v_readfirstlane_b32 s3, v3
    s_bfe_u32 s6, s2, 0x20003
    s_bfe_u32 s7, s2, 0x30005
    s_bfe_u32 s9, s2, 0x10002
    s_and_b32 s8, s2, 3
    s_and_b32 s4, s3, 3
    s_lshl_b32 s76, s4, 13
    s_lshl_b32 s77, s4, 12
    s_lshl_b32 s78, s4, 11
    s_cmp_ge_u32 s3, 4
    s_cselect_b32 s5, 1, 0
    s_cmp_eq_u32 s5, 0
    s_cbranch_scc1 L_lo0
    s_mul_i32 s79, s7, 147456
    s_mul_i32 s11, s4, 36864
    s_add_u32 s79, s79, s11
    s_lshl_b32 s11, s8, 2
    s_add_u32 s11, s11, s6
    s_lshl_b32 s80, s11, 9
    s_and_b32 s11, s4, 1
    s_lshl_b32 s11, s11, 17
    s_add_u32 s80, s80, s11
    s_lshr_b32 s11, s4, 1
    s_lshl_b32 s11, s11, 15
    s_add_u32 s80, s80, s11
    s_lshl_b32 s11, s6, 1
    s_add_u32 s81, s7, s11
    s_sub_u32 s11, s81, 9
    s_cmp_ge_u32 s81, 9
    s_cselect_b32 s81, s11, s81
    s_mov_b32 s15, s81
    v_lshrrev_b32 v3, 3, v2
    v_mul_u32_u24 v3, 1152, v3
    v_lshrrev_b32 v7, 4, v2
    v_and_b32 v4, 7, v2
    v_xor_b32 v4, v7, v4
    v_lshl_add_u32 v200, v4, 4, v3
    v_xor_b32 v4, 4, v4
    v_lshl_add_u32 v201, v4, 4, v3
    v_add_u32 v202, 16384, v200
    v_add_u32 v203, 24576, v201
    v_add_u32 v201, 8192, v201
    v_lshlrev_b32 v3, 13, v7
    v_lshlrev_b32 v7, 1, v7
    v_and_b32 v4, 15, v2
    v_xor_b32 v7, v7, v4
    v_lshl_add_u32 v6, v7, 4, v3
    v_and_b32 v212, 31, v2
    v_mul_u32_u24 v212, 1152, v212
    v_and_b32 v213, 3, v2
    v_and_b32 v3, 4, v2
    v_lshl_add_u32 v213, v3, 1, v213
    v_and_b32 v3, 8, v2
    v_lshl_add_u32 v213, v3, 2, v213
    v_lshlrev_b32 v213, 13, v213
    v_and_b32 v3, 16, v2
    v_lshl_add_u32 v213, v3, 3, v213
    s_waitcnt lgkmcnt(0)
    s_cmp_eq_u32 s9, 0
    s_cselect_b32 s44, s16, s26
    s_cselect_b32 s45, s17, s27
    s_mov_b32 s46, 1179648
    s_mov_b32 s47, 0x20000
    s_cselect_b32 s56, s22, s32
    s_cselect_b32 s57, s23, s33
    s_mov_b32 s58, 4718592
    s_mov_b32 s59, 0x20000
    s_setprio 3
    s_lshl_b32 s11, s81, 7
    s_add_u32 s11, s11, s79
    s_add_u32 m0, s77, 0
    s_nop 0
    buffer_load_dwordx4 v200, s[44:47], s11 offen offset:0 lds
    buffer_load_dwordx4 v201, s[44:47], s11 offen offset:1024 lds
    buffer_load_dwordx4 v202, s[44:47], s11 offen offset:2048 lds
    buffer_load_dwordx4 v203, s[44:47], s11 offen offset:3072 lds
    s_lshl_b32 s12, s81, 19
    s_add_u32 s12, s12, s80
    s_add_u32 m0, s78, 16384
    s_nop 0
    buffer_load_dwordx4 v6, s[56:59], s12 offen nt lds
    s_add_u32 s13, s12, 262144
    s_add_u32 m0, s78, 24576
    s_nop 0
    buffer_load_dwordx4 v6, s[56:59], s13 offen nt lds
    v_xor_b32 v6, 128, v6
    s_add_u32 s13, s12, 65536
    s_add_u32 m0, s78, 17408
    s_nop 0
    buffer_load_dwordx4 v6, s[56:59], s13 offen nt lds
    s_add_u32 s13, s12, 327680
    s_add_u32 m0, s78, 25600
    s_nop 0
    buffer_load_dwordx4 v6, s[56:59], s13 offen nt lds
    v_xor_b32 v6, 128, v6
    buffer_load_dword v214, v213, s[56:59], s12 offen
    s_add_u32 s81, s81, 1
    s_cmp_eq_u32 s81, 9
    s_cselect_b32 s81, 0, s81
    s_cmp_eq_u32 s9, 0
    s_cselect_b32 s48, s18, s28
    s_cselect_b32 s49, s19, s29
    s_mov_b32 s50, 33554432
    s_mov_b32 s51, 0x20000
    s_cselect_b32 s52, s20, s30
    s_cselect_b32 s53, s21, s31
    s_mov_b32 s54, 33554432
    s_mov_b32 s55, 0x20000
    s_cselect_b32 s60, s24, s34
    s_cselect_b32 s61, s25, s35
    s_mov_b32 s62, 4718592
    s_mov_b32 s63, 0x20000
    s_mov_b32 s64, s36
    s_mov_b32 s65, s37
    s_mov_b32 s66, 2359296
    s_mov_b32 s67, 0x20000
    s_mov_b32 s68, s40
    s_mov_b32 s69, s41
    s_mov_b32 s70, 268435456
    s_mov_b32 s71, 0x20000
    s_mov_b32 s72, s38
    s_mov_b32 s73, s39
    s_mov_b32 s74, 256
    s_mov_b32 s75, 0x20000
    s_mov_b32 s26, s15
    s_lshl_b32 s11, s8, 2
    s_add_u32 s11, s11, s6
    s_lshl_b32 s11, s11, 18
    s_lshl_b32 s10, s7, 22
    s_add_u32 s10, s10, s11
    s_add_u32 s10, s10, s76
    s_lshl_b32 s94, s9, 3
    s_add_u32 s94, s94, s7
    s_lshl_b32 s11, s94, 2
    s_add_u32 s11, s11, s8
    s_lshl_b32 s98, s11, 18
    s_add_u32 s98, s98, s76
    s_and_b32 s98, s2, 7
    s_lshl_b32 s98, s98, 3
    s_add_u32 s98, s98, s7
    s_lshl_b32 s98, s98, 17
    s_add_u32 s98, s98, s76
    s_lshl_b32 s99, s11, 2
    s_add_u32 s99, s99, s4
    s_lshl_b32 s99, s99, 7
    s_add_u32 s99, s99, 67108864
    s_and_b32 s40, s7, 1
    s_add_u32 s11, s7, s6
    s_xor_b32 s12, s11, 0
    s_and_b32 s12, s12, 3
    s_lshl_b32 s12, s12, 15
    s_add_u32 s30, s10, s12
    s_xor_b32 s12, s11, 1
    s_and_b32 s12, s12, 3
    s_lshl_b32 s12, s12, 15
    s_add_u32 s31, s10, s12
    s_xor_b32 s12, s11, 2
    s_and_b32 s12, s12, 3
    s_lshl_b32 s12, s12, 15
    s_add_u32 s32, s10, s12
    s_xor_b32 s12, s11, 3
    s_and_b32 s12, s12, 3
    s_lshl_b32 s12, s12, 15
    s_add_u32 s33, s10, s12
    v_lshrrev_b32 v3, 4, v2
    v_and_b32 v7, 15, v2
    v_xor_b32 v4, v3, v7
    v_lshlrev_b32 v5, 1, v3
    v_xor_b32 v5, v5, v7
    v_lshlrev_b32 v3, 8, v3
    v_lshl_add_u32 v4, v4, 4, v3
    v_lshl_add_u32 v5, v5, 4, v3
    v_lshrrev_b32 v3, 4, v2
    v_bfe_u32 v7, v2, 1, 3
    v_xor_b32 v3, v3, v7
    v_and_b32 v7, 15, v2
    v_lshlrev_b32 v7, 7, v7
    v_lshl_add_u32 v7, v3, 4, v7
    v_add_u32 v204, s77, v7
    v_xor_b32 v205, 64, v204
    v_lshrrev_b32 v3, 2, v2
    v_and_b32 v7, 7, v3
    v_lshlrev_b32 v3, 8, v3
    v_lshl_add_u32 v3, v7, 5, v3
    v_and_b32 v7, 3, v2
    v_lshl_add_u32 v3, v7, 3, v3
    v_add_u32 v8, 0, v3
    v_xor_b32 v9, 32, v8
    v_xor_b32 v10, 64, v8
    v_xor_b32 v11, 96, v8
    v_xor_b32 v12, 128, v8
    v_xor_b32 v13, 160, v8
    v_xor_b32 v14, 192, v8
    v_xor_b32 v15, 224, v8
    v_lshlrev_b32 v2, 4, v2
    s_lshl_b32 s11, s7, 2
    s_add_u32 s11, s11, s4
    s_lshl_b32 s12, s6, 6
    s_sub_u32 s12, s12, 32
    s_cselect_b32 s12, 256, s12
    s_add_u32 s11, s11, s12
    s_lshl_b32 s11, s11, 14
    v_and_b32 v3, 48, v2
    s_and_b32 s12, s80, 8191
    s_add_u32 s11, s11, s12
    v_lshrrev_b32 v7, 5, v3
    v_and_b32 v3, 16, v3
    v_lshlrev_b32 v3, 3, v3
    v_lshl_add_u32 v3, v7, 13, v3
    buffer_load_dword v214, v3, s[56:59], s11 offen offset:0 nt
    buffer_load_dword v214, v3, s[56:59], s11 offen offset:0
    s_lshl_b32 s11, s81, 7
    s_add_u32 s11, s11, s79
    s_add_u32 m0, s77, 98304
    s_nop 0
    buffer_load_dwordx4 v200, s[44:47], s11 offen offset:0 lds
    buffer_load_dwordx4 v201, s[44:47], s11 offen offset:1024 lds
    buffer_load_dwordx4 v202, s[44:47], s11 offen offset:2048 lds
    buffer_load_dwordx4 v203, s[44:47], s11 offen offset:3072 lds
    s_lshl_b32 s12, s81, 19
    s_add_u32 s12, s12, s80
    s_add_u32 m0, s78, 114688
    s_nop 0
    buffer_load_dwordx4 v6, s[56:59], s12 offen lds
    s_add_u32 s13, s12, 262144
    s_add_u32 m0, s78, 122880
    s_nop 0
    buffer_load_dwordx4 v6, s[56:59], s13 offen lds
    v_xor_b32 v6, 128, v6
    s_add_u32 s13, s12, 65536
    s_add_u32 m0, s78, 115712
    s_nop 0
    buffer_load_dwordx4 v6, s[56:59], s13 offen lds
    s_add_u32 s13, s12, 327680
    s_add_u32 m0, s78, 123904
    s_nop 0
    buffer_load_dwordx4 v6, s[56:59], s13 offen lds
    v_xor_b32 v6, 128, v6
    s_add_u32 s81, s81, 1
    s_cmp_eq_u32 s81, 9
    s_cselect_b32 s81, 0, s81
    s_lshl_b32 s11, s81, 7
    s_add_u32 s11, s11, s79
    s_add_u32 m0, s77, 32768
    s_nop 0
    buffer_load_dwordx4 v200, s[44:47], s11 offen offset:0 lds
    buffer_load_dwordx4 v201, s[44:47], s11 offen offset:1024 lds
    buffer_load_dwordx4 v202, s[44:47], s11 offen offset:2048 lds
    buffer_load_dwordx4 v203, s[44:47], s11 offen offset:3072 lds
    s_lshl_b32 s16, s6, 15
    s_add_u32 s16, s16, s98
    s_add_u32 s17, s16, 4096
    v_add_u32 v206, 0, v204
    v_add_u32 v207, 0, v205
    v_add_u32 v208, 98304, v204
    v_add_u32 v209, 98304, v205
    v_add_u32 v210, 32768, v204
    v_add_u32 v211, 32768, v205
    s_waitcnt vmcnt(14) lgkmcnt(0)
    s_barrier
    ds_read_b128 v[136:139], v206 offset:0
    ds_read_b128 v[140:143], v206 offset:2048
    ds_read_b128 v[144:147], v207 offset:0
    ds_read_b128 v[148:151], v207 offset:2048
    s_lshl_b32 s12, s81, 19
    s_add_u32 s12, s12, s80
    s_add_u32 m0, s78, 49152
    s_nop 0
    buffer_load_dwordx4 v6, s[56:59], s12 offen lds
    s_add_u32 s13, s12, 262144
    s_add_u32 m0, s78, 57344
    s_nop 0
    buffer_load_dwordx4 v6, s[56:59], s13 offen lds
    v_xor_b32 v6, 128, v6
    s_add_u32 s13, s12, 65536
    s_add_u32 m0, s78, 50176
    s_nop 0
    buffer_load_dwordx4 v6, s[56:59], s13 offen lds
    s_add_u32 s13, s12, 327680
    s_add_u32 m0, s78, 58368
    s_nop 0
    buffer_load_dwordx4 v6, s[56:59], s13 offen lds
    v_xor_b32 v6, 128, v6
    s_add_u32 s81, s81, 1
    s_cmp_eq_u32 s81, 9
    s_cselect_b32 s81, 0, s81
    s_add_u32 s13, s30, 0
    s_add_u32 m0, s76, 131072
    s_nop 0
    buffer_load_dwordx4 v4, s[48:51], s13 offen offset:0 nt lds
    v_xor_b32 v4, 64, v4
    buffer_load_dwordx4 v4, s[48:51], s13 offen offset:1024 nt lds
    v_xor_b32 v4, 128, v4
    buffer_load_dwordx4 v4, s[48:51], s13 offen offset:3072 nt lds
    v_xor_b32 v4, 64, v4
    buffer_load_dwordx4 v4, s[48:51], s13 offen offset:2048 nt lds
    s_waitcnt vmcnt(12) lgkmcnt(0)
    s_barrier
    ds_read_b128 v[152:155], v208 offset:0
    ds_read_b128 v[156:159], v208 offset:2048
    ds_read_b128 v[160:163], v209 offset:0
    ds_read_b128 v[164:167], v209 offset:2048
    s_lshl_b32 s11, s81, 7
    s_add_u32 s11, s11, s79
    s_add_u32 m0, s77, 0
    s_nop 0
    buffer_load_dwordx4 v200, s[44:47], s11 offen offset:0 lds
    buffer_load_dwordx4 v201, s[44:47], s11 offen offset:1024 lds
    buffer_load_dwordx4 v202, s[44:47], s11 offen offset:2048 lds
    buffer_load_dwordx4 v203, s[44:47], s11 offen offset:3072 lds
    s_lshl_b32 s12, s81, 19
    s_add_u32 s12, s12, s80
    s_add_u32 m0, s78, 16384
    s_nop 0
    buffer_load_dwordx4 v6, s[56:59], s12 offen lds
    s_add_u32 s13, s12, 262144
    s_add_u32 m0, s78, 24576
    s_nop 0
    buffer_load_dwordx4 v6, s[56:59], s13 offen lds
    v_xor_b32 v6, 128, v6
    s_add_u32 s13, s12, 65536
    s_add_u32 m0, s78, 17408
    s_nop 0
    buffer_load_dwordx4 v6, s[56:59], s13 offen lds
    s_add_u32 s13, s12, 327680
    s_add_u32 m0, s78, 25600
    s_nop 0
    buffer_load_dwordx4 v6, s[56:59], s13 offen lds
    v_xor_b32 v6, 128, v6
    s_add_u32 s81, s81, 1
    s_cmp_eq_u32 s81, 9
    s_cselect_b32 s81, 0, s81
    s_waitcnt vmcnt(12) lgkmcnt(0)
    s_barrier
    ds_read_b128 v[168:171], v210 offset:0
    ds_read_b128 v[172:175], v210 offset:2048
    ds_read_b128 v[176:179], v211 offset:0
    ds_read_b128 v[180:183], v211 offset:2048
    s_add_u32 s13, s30, 4096
    s_add_u32 m0, s76, 135168
    s_nop 0
    buffer_load_dwordx4 v4, s[48:51], s13 offen offset:2048 nt lds
    v_xor_b32 v4, 64, v4
    buffer_load_dwordx4 v4, s[48:51], s13 offen offset:3072 nt lds
    v_xor_b32 v4, 128, v4
    buffer_load_dwordx4 v4, s[48:51], s13 offen offset:1024 nt lds
    v_xor_b32 v4, 64, v4
    buffer_load_dwordx4 v4, s[48:51], s13 offen offset:0 nt lds
    s_lshl_b32 s11, s81, 7
    s_add_u32 s11, s11, s79
    s_add_u32 m0, s77, 98304
    s_nop 0
    buffer_load_dwordx4 v200, s[44:47], s11 offen offset:0 lds
    buffer_load_dwordx4 v201, s[44:47], s11 offen offset:1024 lds
    buffer_load_dwordx4 v202, s[44:47], s11 offen offset:2048 lds
    buffer_load_dwordx4 v203, s[44:47], s11 offen offset:3072 lds
    s_lshl_b32 s12, s81, 19
    s_add_u32 s12, s12, s80
    s_add_u32 m0, s78, 114688
    s_nop 0
    buffer_load_dwordx4 v6, s[56:59], s12 offen lds
    s_add_u32 s13, s12, 262144
    s_add_u32 m0, s78, 122880
    s_nop 0
    buffer_load_dwordx4 v6, s[56:59], s13 offen lds
    v_xor_b32 v6, 128, v6
    s_add_u32 s13, s12, 65536
    s_add_u32 m0, s78, 115712
    s_nop 0
    buffer_load_dwordx4 v6, s[56:59], s13 offen lds
    s_add_u32 s13, s12, 327680
    s_add_u32 m0, s78, 123904
    s_nop 0
    buffer_load_dwordx4 v6, s[56:59], s13 offen lds
    v_xor_b32 v6, 128, v6
    s_add_u32 s81, s81, 1
    s_cmp_eq_u32 s81, 9
    s_cselect_b32 s81, 0, s81
    s_waitcnt vmcnt(12) lgkmcnt(0)
    s_barrier
    ds_read_b128 v[184:187], v206 offset:0
    ds_read_b128 v[188:191], v206 offset:2048
    ds_read_b128 v[192:195], v207 offset:0
    ds_read_b128 v[196:199], v207 offset:2048
    s_add_u32 s13, s30, 0
    s_add_u32 m0, s76, 65536
    s_nop 0
    buffer_load_dwordx4 v5, s[52:55], s13 offen offset:0 nt lds
    buffer_load_dwordx4 v5, s[52:55], s13 offen offset:2048 nt lds
    v_xor_b32 v5, 128, v5
    buffer_load_dwordx4 v5, s[52:55], s13 offen offset:1024 nt lds
    buffer_load_dwordx4 v5, s[52:55], s13 offen offset:3072 nt lds
    s_lshl_b32 s11, s81, 7
    s_add_u32 s11, s11, s79
    s_add_u32 m0, s77, 32768
    s_nop 0
    buffer_load_dwordx4 v200, s[44:47], s11 offen offset:0 lds
    buffer_load_dwordx4 v201, s[44:47], s11 offen offset:1024 lds
    buffer_load_dwordx4 v202, s[44:47], s11 offen offset:2048 lds
    buffer_load_dwordx4 v203, s[44:47], s11 offen offset:3072 lds
    s_lshl_b32 s12, s81, 19
    s_add_u32 s12, s12, s80
    s_add_u32 m0, s78, 49152
    s_nop 0
    buffer_load_dwordx4 v6, s[56:59], s12 offen lds
    s_add_u32 s13, s12, 262144
    s_add_u32 m0, s78, 57344
    s_nop 0
    buffer_load_dwordx4 v6, s[56:59], s13 offen lds
    v_xor_b32 v6, 128, v6
    s_add_u32 s13, s12, 65536
    s_add_u32 m0, s78, 50176
    s_nop 0
    buffer_load_dwordx4 v6, s[56:59], s13 offen lds
    s_add_u32 s13, s12, 327680
    s_add_u32 m0, s78, 58368
    s_nop 0
    buffer_load_dwordx4 v6, s[56:59], s13 offen lds
    v_xor_b32 v6, 128, v6
    s_add_u32 s81, s81, 1
    s_cmp_eq_u32 s81, 9
    s_cselect_b32 s81, 0, s81
    s_waitcnt vmcnt(12) lgkmcnt(0)
    s_barrier
    ds_read_b128 v[16:19], v208 offset:0
    ds_read_b128 v[20:23], v208 offset:2048
    ds_read_b128 v[24:27], v209 offset:0
    ds_read_b128 v[28:31], v209 offset:2048
    s_add_u32 s13, s30, 4096
    s_add_u32 m0, s76, 69632
    s_nop 0
    buffer_load_dwordx4 v5, s[52:55], s13 offen offset:1024 nt lds
    buffer_load_dwordx4 v5, s[52:55], s13 offen offset:3072 nt lds
    v_xor_b32 v5, 128, v5
    buffer_load_dwordx4 v5, s[52:55], s13 offen offset:0 nt lds
    buffer_load_dwordx4 v5, s[52:55], s13 offen offset:2048 nt lds
    s_lshl_b32 s11, s81, 7
    s_add_u32 s11, s11, s79
    s_add_u32 m0, s77, 0
    s_nop 0
    buffer_load_dwordx4 v200, s[44:47], s11 offen offset:0 lds
    buffer_load_dwordx4 v201, s[44:47], s11 offen offset:1024 lds
    buffer_load_dwordx4 v202, s[44:47], s11 offen offset:2048 lds
    buffer_load_dwordx4 v203, s[44:47], s11 offen offset:3072 lds
    s_lshl_b32 s12, s81, 19
    s_add_u32 s12, s12, s80
    s_add_u32 m0, s78, 16384
    s_nop 0
    buffer_load_dwordx4 v6, s[56:59], s12 offen lds
    s_add_u32 s13, s12, 262144
    s_add_u32 m0, s78, 24576
    s_nop 0
    buffer_load_dwordx4 v6, s[56:59], s13 offen lds
    v_xor_b32 v6, 128, v6
    s_add_u32 s13, s12, 65536
    s_add_u32 m0, s78, 17408
    s_nop 0
    buffer_load_dwordx4 v6, s[56:59], s13 offen lds
    s_add_u32 s13, s12, 327680
    s_add_u32 m0, s78, 25600
    s_nop 0
    buffer_load_dwordx4 v6, s[56:59], s13 offen lds
    v_xor_b32 v6, 128, v6
    s_add_u32 s81, s81, 1
    s_cmp_eq_u32 s81, 9
    s_cselect_b32 s81, 0, s81
    s_waitcnt vmcnt(12) lgkmcnt(0)
    s_barrier
    ds_read_b128 v[32:35], v210 offset:0
    ds_read_b128 v[36:39], v210 offset:2048
    ds_read_b128 v[232:235], v211 offset:0
    ds_read_b128 v[236:239], v211 offset:2048
    s_lshl_b32 s11, s81, 7
    s_add_u32 s11, s11, s79
    s_add_u32 m0, s77, 98304
    s_nop 0
    buffer_load_dwordx4 v200, s[44:47], s11 offen offset:0 lds
    buffer_load_dwordx4 v201, s[44:47], s11 offen offset:1024 lds
    buffer_load_dwordx4 v202, s[44:47], s11 offen offset:2048 lds
    buffer_load_dwordx4 v203, s[44:47], s11 offen offset:3072 lds
    s_lshl_b32 s12, s81, 19
    s_add_u32 s12, s12, s80
    s_add_u32 m0, s78, 114688
    s_nop 0
    buffer_load_dwordx4 v6, s[56:59], s12 offen lds
    s_add_u32 s13, s12, 262144
    s_add_u32 m0, s78, 122880
    s_nop 0
    buffer_load_dwordx4 v6, s[56:59], s13 offen lds
    v_xor_b32 v6, 128, v6
    s_add_u32 s13, s12, 65536
    s_add_u32 m0, s78, 115712
    s_nop 0
    buffer_load_dwordx4 v6, s[56:59], s13 offen lds
    s_add_u32 s13, s12, 327680
    s_add_u32 m0, s78, 123904
    s_nop 0
    buffer_load_dwordx4 v6, s[56:59], s13 offen lds
    v_xor_b32 v6, 128, v6
    s_add_u32 s81, s81, 1
    s_cmp_eq_u32 s81, 9
    s_cselect_b32 s81, 0, s81
    s_waitcnt vmcnt(8) lgkmcnt(0)
    s_barrier
    ds_read_b128 v[240:243], v206 offset:0
    ds_read_b128 v[244:247], v206 offset:2048
    ds_read_b128 v[248:251], v207 offset:0
    ds_read_b128 v[252:255], v207 offset:2048
    s_lshl_b32 s11, s81, 7
    s_add_u32 s11, s11, s79
    s_add_u32 m0, s77, 32768
    s_nop 0
    buffer_load_dwordx4 v200, s[44:47], s11 offen offset:0 lds
    buffer_load_dwordx4 v201, s[44:47], s11 offen offset:1024 lds
    buffer_load_dwordx4 v202, s[44:47], s11 offen offset:2048 lds
    buffer_load_dwordx4 v203, s[44:47], s11 offen offset:3072 lds
    s_lshl_b32 s12, s81, 19
    s_add_u32 s12, s12, s80
    s_add_u32 m0, s78, 49152
    s_nop 0
    buffer_load_dwordx4 v6, s[56:59], s12 offen lds
    s_add_u32 s13, s12, 262144
    s_add_u32 m0, s78, 57344
    s_nop 0
    buffer_load_dwordx4 v6, s[56:59], s13 offen lds
    v_xor_b32 v6, 128, v6
    s_add_u32 s13, s12, 65536
    s_add_u32 m0, s78, 50176
    s_nop 0
    buffer_load_dwordx4 v6, s[56:59], s13 offen lds
    s_add_u32 s13, s12, 327680
    s_add_u32 m0, s78, 58368
    s_nop 0
    buffer_load_dwordx4 v6, s[56:59], s13 offen lds
    v_xor_b32 v6, 128, v6
    s_add_u32 s81, s81, 1
    s_cmp_eq_u32 s81, 9
    s_cselect_b32 s81, 0, s81
    s_lshl_b32 s11, s7, 2
    s_add_u32 s11, s11, s4
    s_lshl_b32 s12, s6, 6
    s_sub_u32 s12, s12, 32
    s_cselect_b32 s12, 256, s12
    s_add_u32 s11, s11, s12
    s_lshl_b32 s11, s11, 14
    v_and_b32 v3, 48, v2
    s_and_b32 s12, s80, 8191
    s_add_u32 s11, s11, s12
    v_lshrrev_b32 v7, 5, v3
    v_and_b32 v3, 16, v3
    v_lshlrev_b32 v3, 3, v3
    v_lshl_add_u32 v3, v7, 13, v3
    buffer_load_dword v214, v3, s[56:59], s11 offen offset:256 nt
    buffer_load_dword v214, v3, s[56:59], s11 offen offset:256
    s_waitcnt vmcnt(10) lgkmcnt(0)
    s_barrier
    ds_read_b128 v[40:43], v208 offset:0
    ds_read_b128 v[44:47], v208 offset:2048
    ds_read_b128 v[48:51], v209 offset:0
    ds_read_b128 v[52:55], v209 offset:2048
    s_lshl_b32 s12, s26, 19
    s_add_u32 s12, s12, s80
    s_add_u32 s12, s12, 256
    s_add_u32 m0, s78, 0
    s_nop 0
    buffer_load_dwordx4 v6, s[56:59], s12 offen nt lds
    s_add_u32 s13, s12, 262144
    s_add_u32 m0, s78, 8192
    s_nop 0
    buffer_load_dwordx4 v6, s[56:59], s13 offen nt lds
    v_xor_b32 v6, 128, v6
    s_add_u32 s13, s12, 65536
    s_add_u32 m0, s78, 1024
    s_nop 0
    buffer_load_dwordx4 v6, s[56:59], s13 offen nt lds
    s_add_u32 s13, s12, 327680
    s_add_u32 m0, s78, 9216
    s_nop 0
    buffer_load_dwordx4 v6, s[56:59], s13 offen nt lds
    v_xor_b32 v6, 128, v6
    buffer_load_dword v214, v213, s[56:59], s12 offen
    s_add_u32 s26, s26, 1
    s_cmp_eq_u32 s26, 9
    s_cselect_b32 s26, 0, s26
    s_lshl_b32 s12, s26, 19
    s_add_u32 s12, s12, s80
    s_add_u32 s12, s12, 256
    s_add_u32 m0, s78, 16384
    s_nop 0
    buffer_load_dwordx4 v6, s[56:59], s12 offen lds
    s_add_u32 s13, s12, 262144
    s_add_u32 m0, s78, 24576
    s_nop 0
    buffer_load_dwordx4 v6, s[56:59], s13 offen lds
    v_xor_b32 v6, 128, v6
    s_add_u32 s13, s12, 65536
    s_add_u32 m0, s78, 17408
    s_nop 0
    buffer_load_dwordx4 v6, s[56:59], s13 offen lds
    s_add_u32 s13, s12, 327680
    s_add_u32 m0, s78, 25600
    s_nop 0
    buffer_load_dwordx4 v6, s[56:59], s13 offen lds
    v_xor_b32 v6, 128, v6
    s_add_u32 s26, s26, 1
    s_cmp_eq_u32 s26, 9
    s_cselect_b32 s26, 0, s26
    s_waitcnt vmcnt(11) lgkmcnt(0)
    s_barrier
    ds_read_b128 v[56:59], v210 offset:0
    ds_read_b128 v[60:63], v210 offset:2048
    ds_read_b128 v[64:67], v211 offset:0
    ds_read_b128 v[68:71], v211 offset:2048
    s_add_u32 s13, s31, 0
    s_add_u32 m0, s76, 98304
    s_nop 0
    buffer_load_dwordx4 v4, s[48:51], s13 offen offset:0 nt lds
    v_xor_b32 v4, 64, v4
    buffer_load_dwordx4 v4, s[48:51], s13 offen offset:1024 nt lds
    v_xor_b32 v4, 128, v4
    buffer_load_dwordx4 v4, s[48:51], s13 offen offset:3072 nt lds
    v_xor_b32 v4, 64, v4
    buffer_load_dwordx4 v4, s[48:51], s13 offen offset:2048 nt lds
    s_add_u32 s13, s31, 4096
    s_add_u32 m0, s76, 102400
    s_nop 0
    buffer_load_dwordx4 v4, s[48:51], s13 offen offset:2048 nt lds
    v_xor_b32 v4, 64, v4
    buffer_load_dwordx4 v4, s[48:51], s13 offen offset:3072 nt lds
    v_xor_b32 v4, 128, v4
    buffer_load_dwordx4 v4, s[48:51], s13 offen offset:1024 nt lds
    v_xor_b32 v4, 64, v4
    buffer_load_dwordx4 v4, s[48:51], s13 offen offset:0 nt lds
    s_waitcnt vmcnt(8) lgkmcnt(0)
    s_barrier
    ds_read_b64_tr_b16 v[200:201], v8 offset:0
    ds_read_b64_tr_b16 v[202:203], v8 offset:4096
    ds_read_b64_tr_b16 v[204:205], v9 offset:0
    ds_read_b64_tr_b16 v[206:207], v9 offset:4096
    ds_read_b64_tr_b16 v[208:209], v10 offset:0
    ds_read_b64_tr_b16 v[210:211], v10 offset:4096
    ds_read_b64_tr_b16 v[212:213], v11 offset:0
    ds_read_b64_tr_b16 v[214:215], v11 offset:4096
    ds_read_b64_tr_b16 v[216:217], v12 offset:0
    ds_read_b64_tr_b16 v[218:219], v12 offset:4096
    ds_read_b64_tr_b16 v[220:221], v13 offset:0
    ds_read_b64_tr_b16 v[222:223], v13 offset:4096
    ds_read_b64_tr_b16 v[224:225], v14 offset:0
    ds_read_b64_tr_b16 v[226:227], v14 offset:4096
    s_lshl_b32 s12, s26, 19
    s_add_u32 s12, s12, s80
    s_add_u32 s12, s12, 256
    s_add_u32 m0, s78, 32768
    s_nop 0
    buffer_load_dwordx4 v6, s[56:59], s12 offen lds
    s_add_u32 s13, s12, 262144
    s_add_u32 m0, s78, 40960
    s_nop 0
    buffer_load_dwordx4 v6, s[56:59], s13 offen lds
    v_xor_b32 v6, 128, v6
    s_add_u32 s13, s12, 65536
    s_add_u32 m0, s78, 33792
    s_nop 0
    buffer_load_dwordx4 v6, s[56:59], s13 offen lds
    s_add_u32 s13, s12, 327680
    s_add_u32 m0, s78, 41984
    s_nop 0
    buffer_load_dwordx4 v6, s[56:59], s13 offen lds
    v_xor_b32 v6, 128, v6
    s_add_u32 s26, s26, 1
    s_cmp_eq_u32 s26, 9
    s_cselect_b32 s26, 0, s26
    s_lshl_b32 s12, s26, 19
    s_add_u32 s12, s12, s80
    s_add_u32 s12, s12, 256
    s_add_u32 m0, s78, 49152
    s_nop 0
    buffer_load_dwordx4 v6, s[56:59], s12 offen lds
    s_add_u32 s13, s12, 262144
    s_add_u32 m0, s78, 57344
    s_nop 0
    buffer_load_dwordx4 v6, s[56:59], s13 offen lds
    v_xor_b32 v6, 128, v6
    s_add_u32 s13, s12, 65536
    s_add_u32 m0, s78, 50176
    s_nop 0
    buffer_load_dwordx4 v6, s[56:59], s13 offen lds
    s_add_u32 s13, s12, 327680
    s_add_u32 m0, s78, 58368
    s_nop 0
    buffer_load_dwordx4 v6, s[56:59], s13 offen lds
    v_xor_b32 v6, 128, v6
    s_add_u32 s26, s26, 1
    s_cmp_eq_u32 s26, 9
    s_cselect_b32 s26, 0, s26
    s_lshl_b32 s11, s6, 4
    s_add_u32 s11, s11, s7
    s_lshl_b32 s11, s11, 2
    s_add_u32 s11, s11, s4
    s_mul_i32 s11, s11, 4608
    s_mul_i32 s12, s8, 1179648
    s_add_u32 s11, s11, s12
    v_lshlrev_b32 v3, 3, v2
    v_min_u32 v3, 4480, v3
    buffer_load_dword v7, v3, s[60:63], s11 offen nt
    buffer_load_dword v7, v3, s[60:63], s11 offen
    s_lshl_b32 s11, s6, 4
    s_add_u32 s11, s11, s7
    s_lshl_b32 s11, s11, 2
    s_add_u32 s11, s11, s4
    s_mul_i32 s11, s11, 4608
    s_mul_i32 s12, s8, 1179648
    s_add_u32 s11, s11, s12
    v_lshlrev_b32 v3, 3, v2
    v_min_u32 v3, 4480, v3
    s_add_u32 s11, s11, 147456
    buffer_load_dword v7, v3, s[60:63], s11 offen nt
    buffer_load_dword v7, v3, s[60:63], s11 offen
    s_setprio 3
    s_waitcnt lgkmcnt(10)
    v_mfma_f32_16x16x32_bf16 v[72:75], v[200:203], v[136:139], 0
    ds_read_b64_tr_b16 v[228:229], v15 offset:0
    v_mfma_f32_16x16x32_bf16 v[76:79], v[200:203], v[140:143], 0
    ds_read_b64_tr_b16 v[230:231], v15 offset:4096
    v_mfma_f32_16x16x32_bf16 v[80:83], v[204:207], v[136:139], 0
    ds_read_b64_tr_b16 v[200:201], v8 offset:8192
    v_mfma_f32_16x16x32_bf16 v[84:87], v[204:207], v[140:143], 0
    ds_read_b64_tr_b16 v[202:203], v8 offset:12288
    s_waitcnt lgkmcnt(10)
    v_mfma_f32_16x16x32_bf16 v[88:91], v[208:211], v[136:139], 0
    ds_read_b64_tr_b16 v[204:205], v9 offset:8192
    v_mfma_f32_16x16x32_bf16 v[92:95], v[208:211], v[140:143], 0
    ds_read_b64_tr_b16 v[206:207], v9 offset:12288
    v_mfma_f32_16x16x32_bf16 v[96:99], v[212:215], v[136:139], 0
    ds_read_b64_tr_b16 v[208:209], v10 offset:8192
    v_mfma_f32_16x16x32_bf16 v[100:103], v[212:215], v[140:143], 0
    ds_read_b64_tr_b16 v[210:211], v10 offset:12288
    s_waitcnt lgkmcnt(10)
    v_mfma_f32_16x16x32_bf16 v[104:107], v[216:219], v[136:139], 0
    ds_read_b64_tr_b16 v[212:213], v11 offset:8192
    v_mfma_f32_16x16x32_bf16 v[108:111], v[216:219], v[140:143], 0
    ds_read_b64_tr_b16 v[214:215], v11 offset:12288
    v_mfma_f32_16x16x32_bf16 v[112:115], v[220:223], v[136:139], 0
    ds_read_b64_tr_b16 v[216:217], v12 offset:8192
    v_mfma_f32_16x16x32_bf16 v[116:119], v[220:223], v[140:143], 0
    ds_read_b64_tr_b16 v[218:219], v12 offset:12288
    s_waitcnt lgkmcnt(10)
    v_mfma_f32_16x16x32_bf16 v[120:123], v[224:227], v[136:139], 0
    ds_read_b64_tr_b16 v[220:221], v13 offset:8192
    v_mfma_f32_16x16x32_bf16 v[124:127], v[224:227], v[140:143], 0
    ds_read_b64_tr_b16 v[222:223], v13 offset:12288
    v_mfma_f32_16x16x32_bf16 v[128:131], v[228:231], v[136:139], 0
    ds_read_b64_tr_b16 v[224:225], v14 offset:8192
    v_mfma_f32_16x16x32_bf16 v[132:135], v[228:231], v[140:143], 0
    ds_read_b64_tr_b16 v[226:227], v14 offset:12288
    s_waitcnt lgkmcnt(10)
    v_mfma_f32_16x16x32_bf16 v[72:75], v[200:203], v[144:147], v[72:75]
    ds_read_b64_tr_b16 v[228:229], v15 offset:8192
    v_mfma_f32_16x16x32_bf16 v[76:79], v[200:203], v[148:151], v[76:79]
    ds_read_b64_tr_b16 v[230:231], v15 offset:12288
    v_mfma_f32_16x16x32_bf16 v[80:83], v[204:207], v[144:147], v[80:83]
    ds_read_b64_tr_b16 v[200:201], v8 offset:16384
    v_mfma_f32_16x16x32_bf16 v[84:87], v[204:207], v[148:151], v[84:87]
    ds_read_b64_tr_b16 v[202:203], v8 offset:20480
    s_waitcnt lgkmcnt(10)
    v_mfma_f32_16x16x32_bf16 v[88:91], v[208:211], v[144:147], v[88:91]
    ds_read_b64_tr_b16 v[204:205], v9 offset:16384
    v_mfma_f32_16x16x32_bf16 v[92:95], v[208:211], v[148:151], v[92:95]
    ds_read_b64_tr_b16 v[206:207], v9 offset:20480
    v_mfma_f32_16x16x32_bf16 v[96:99], v[212:215], v[144:147], v[96:99]
    ds_read_b64_tr_b16 v[208:209], v10 offset:16384
    v_mfma_f32_16x16x32_bf16 v[100:103], v[212:215], v[148:151], v[100:103]
    ds_read_b64_tr_b16 v[210:211], v10 offset:20480
    s_waitcnt lgkmcnt(10)
    v_mfma_f32_16x16x32_bf16 v[104:107], v[216:219], v[144:147], v[104:107]
    ds_read_b64_tr_b16 v[212:213], v11 offset:16384
    v_mfma_f32_16x16x32_bf16 v[108:111], v[216:219], v[148:151], v[108:111]
    ds_read_b64_tr_b16 v[214:215], v11 offset:20480
    v_mfma_f32_16x16x32_bf16 v[112:115], v[220:223], v[144:147], v[112:115]
    ds_read_b64_tr_b16 v[216:217], v12 offset:16384
    v_mfma_f32_16x16x32_bf16 v[116:119], v[220:223], v[148:151], v[116:119]
    ds_read_b64_tr_b16 v[218:219], v12 offset:20480
    s_waitcnt lgkmcnt(10)
    v_mfma_f32_16x16x32_bf16 v[120:123], v[224:227], v[144:147], v[120:123]
    ds_read_b64_tr_b16 v[220:221], v13 offset:16384
    v_mfma_f32_16x16x32_bf16 v[124:127], v[224:227], v[148:151], v[124:127]
    ds_read_b64_tr_b16 v[222:223], v13 offset:20480
    v_mfma_f32_16x16x32_bf16 v[128:131], v[228:231], v[144:147], v[128:131]
    ds_read_b64_tr_b16 v[224:225], v14 offset:16384
    v_mfma_f32_16x16x32_bf16 v[132:135], v[228:231], v[148:151], v[132:135]
    ds_read_b64_tr_b16 v[226:227], v14 offset:20480
    s_waitcnt lgkmcnt(10)
    v_mfma_f32_16x16x32_bf16 v[72:75], v[200:203], v[152:155], v[72:75]
    ds_read_b64_tr_b16 v[228:229], v15 offset:16384
    v_mfma_f32_16x16x32_bf16 v[76:79], v[200:203], v[156:159], v[76:79]
    ds_read_b64_tr_b16 v[230:231], v15 offset:20480
    v_mfma_f32_16x16x32_bf16 v[80:83], v[204:207], v[152:155], v[80:83]
    ds_read_b64_tr_b16 v[200:201], v8 offset:24576
    v_mfma_f32_16x16x32_bf16 v[84:87], v[204:207], v[156:159], v[84:87]
    ds_read_b64_tr_b16 v[202:203], v8 offset:28672
    s_waitcnt lgkmcnt(10)
    v_mfma_f32_16x16x32_bf16 v[88:91], v[208:211], v[152:155], v[88:91]
    ds_read_b64_tr_b16 v[204:205], v9 offset:24576
    v_mfma_f32_16x16x32_bf16 v[92:95], v[208:211], v[156:159], v[92:95]
    ds_read_b64_tr_b16 v[206:207], v9 offset:28672
    v_mfma_f32_16x16x32_bf16 v[96:99], v[212:215], v[152:155], v[96:99]
    ds_read_b64_tr_b16 v[208:209], v10 offset:24576
    v_mfma_f32_16x16x32_bf16 v[100:103], v[212:215], v[156:159], v[100:103]
    ds_read_b64_tr_b16 v[210:211], v10 offset:28672
    s_waitcnt lgkmcnt(10)
    v_mfma_f32_16x16x32_bf16 v[104:107], v[216:219], v[152:155], v[104:107]
    ds_read_b64_tr_b16 v[212:213], v11 offset:24576
    v_mfma_f32_16x16x32_bf16 v[108:111], v[216:219], v[156:159], v[108:111]
    ds_read_b64_tr_b16 v[214:215], v11 offset:28672
    v_mfma_f32_16x16x32_bf16 v[112:115], v[220:223], v[152:155], v[112:115]
    ds_read_b64_tr_b16 v[216:217], v12 offset:24576
    v_mfma_f32_16x16x32_bf16 v[116:119], v[220:223], v[156:159], v[116:119]
    ds_read_b64_tr_b16 v[218:219], v12 offset:28672
    s_waitcnt lgkmcnt(10)
    v_mfma_f32_16x16x32_bf16 v[120:123], v[224:227], v[152:155], v[120:123]
    ds_read_b64_tr_b16 v[220:221], v13 offset:24576
    v_mfma_f32_16x16x32_bf16 v[124:127], v[224:227], v[156:159], v[124:127]
    ds_read_b64_tr_b16 v[222:223], v13 offset:28672
    v_mfma_f32_16x16x32_bf16 v[128:131], v[228:231], v[152:155], v[128:131]
    ds_read_b64_tr_b16 v[224:225], v14 offset:24576
    v_mfma_f32_16x16x32_bf16 v[132:135], v[228:231], v[156:159], v[132:135]
    ds_read_b64_tr_b16 v[226:227], v14 offset:28672
    s_waitcnt lgkmcnt(10)
    v_mfma_f32_16x16x32_bf16 v[72:75], v[200:203], v[160:163], v[72:75]
    ds_read_b64_tr_b16 v[228:229], v15 offset:24576
    v_mfma_f32_16x16x32_bf16 v[76:79], v[200:203], v[164:167], v[76:79]
    ds_read_b64_tr_b16 v[230:231], v15 offset:28672
    v_mfma_f32_16x16x32_bf16 v[80:83], v[204:207], v[160:163], v[80:83]
    v_mfma_f32_16x16x32_bf16 v[84:87], v[204:207], v[164:167], v[84:87]
    s_waitcnt lgkmcnt(8)
    v_mfma_f32_16x16x32_bf16 v[88:91], v[208:211], v[160:163], v[88:91]
    v_mfma_f32_16x16x32_bf16 v[92:95], v[208:211], v[164:167], v[92:95]
    v_mfma_f32_16x16x32_bf16 v[96:99], v[212:215], v[160:163], v[96:99]
    v_mfma_f32_16x16x32_bf16 v[100:103], v[212:215], v[164:167], v[100:103]
    s_waitcnt lgkmcnt(4)
    v_mfma_f32_16x16x32_bf16 v[104:107], v[216:219], v[160:163], v[104:107]
    v_mfma_f32_16x16x32_bf16 v[108:111], v[216:219], v[164:167], v[108:111]
    v_mfma_f32_16x16x32_bf16 v[112:115], v[220:223], v[160:163], v[112:115]
    v_mfma_f32_16x16x32_bf16 v[116:119], v[220:223], v[164:167], v[116:119]
    s_waitcnt lgkmcnt(0)
    v_mfma_f32_16x16x32_bf16 v[120:123], v[224:227], v[160:163], v[120:123]
    v_mfma_f32_16x16x32_bf16 v[124:127], v[224:227], v[164:167], v[124:127]
    v_mfma_f32_16x16x32_bf16 v[128:131], v[228:231], v[160:163], v[128:131]
    v_mfma_f32_16x16x32_bf16 v[132:135], v[228:231], v[164:167], v[132:135]
    s_setprio 3
    s_waitcnt vmcnt(8) lgkmcnt(0)
    s_barrier
    ds_read_b64_tr_b16 v[200:201], v8 offset:32768
    ds_read_b64_tr_b16 v[202:203], v8 offset:36864
    ds_read_b64_tr_b16 v[204:205], v9 offset:32768
    ds_read_b64_tr_b16 v[206:207], v9 offset:36864
    ds_read_b64_tr_b16 v[208:209], v10 offset:32768
    ds_read_b64_tr_b16 v[210:211], v10 offset:36864
    ds_read_b64_tr_b16 v[212:213], v11 offset:32768
    ds_read_b64_tr_b16 v[214:215], v11 offset:36864
    ds_read_b64_tr_b16 v[216:217], v12 offset:32768
    ds_read_b64_tr_b16 v[218:219], v12 offset:36864
    ds_read_b64_tr_b16 v[220:221], v13 offset:32768
    ds_read_b64_tr_b16 v[222:223], v13 offset:36864
    ds_read_b64_tr_b16 v[224:225], v14 offset:32768
    ds_read_b64_tr_b16 v[226:227], v14 offset:36864
    s_add_u32 s13, s31, 0
    s_add_u32 m0, s76, 131072
    s_nop 0
    buffer_load_dwordx4 v5, s[52:55], s13 offen offset:0 nt lds
    buffer_load_dwordx4 v5, s[52:55], s13 offen offset:2048 nt lds
    v_xor_b32 v5, 128, v5
    buffer_load_dwordx4 v5, s[52:55], s13 offen offset:1024 nt lds
    buffer_load_dwordx4 v5, s[52:55], s13 offen offset:3072 nt lds
    s_add_u32 s13, s31, 4096
    s_add_u32 m0, s76, 135168
    s_nop 0
    buffer_load_dwordx4 v5, s[52:55], s13 offen offset:1024 nt lds
    buffer_load_dwordx4 v5, s[52:55], s13 offen offset:3072 nt lds
    v_xor_b32 v5, 128, v5
    buffer_load_dwordx4 v5, s[52:55], s13 offen offset:0 nt lds
    buffer_load_dwordx4 v5, s[52:55], s13 offen offset:2048 nt lds
    s_setprio 3
    s_waitcnt lgkmcnt(10)
    v_mfma_f32_16x16x32_bf16 v[72:75], v[200:203], v[168:171], v[72:75]
    ds_read_b64_tr_b16 v[228:229], v15 offset:32768
    v_mfma_f32_16x16x32_bf16 v[76:79], v[200:203], v[172:175], v[76:79]
    ds_read_b64_tr_b16 v[230:231], v15 offset:36864
    v_mfma_f32_16x16x32_bf16 v[80:83], v[204:207], v[168:171], v[80:83]
    ds_read_b64_tr_b16 v[200:201], v8 offset:40960
    v_mfma_f32_16x16x32_bf16 v[84:87], v[204:207], v[172:175], v[84:87]
    ds_read_b64_tr_b16 v[202:203], v8 offset:45056
    s_waitcnt lgkmcnt(10)
    v_mfma_f32_16x16x32_bf16 v[88:91], v[208:211], v[168:171], v[88:91]
    ds_read_b64_tr_b16 v[204:205], v9 offset:40960
    v_mfma_f32_16x16x32_bf16 v[92:95], v[208:211], v[172:175], v[92:95]
    ds_read_b64_tr_b16 v[206:207], v9 offset:45056
    v_mfma_f32_16x16x32_bf16 v[96:99], v[212:215], v[168:171], v[96:99]
    ds_read_b64_tr_b16 v[208:209], v10 offset:40960
    v_mfma_f32_16x16x32_bf16 v[100:103], v[212:215], v[172:175], v[100:103]
    ds_read_b64_tr_b16 v[210:211], v10 offset:45056
    s_waitcnt lgkmcnt(10)
    v_mfma_f32_16x16x32_bf16 v[104:107], v[216:219], v[168:171], v[104:107]
    ds_read_b64_tr_b16 v[212:213], v11 offset:40960
    v_mfma_f32_16x16x32_bf16 v[108:111], v[216:219], v[172:175], v[108:111]
    ds_read_b64_tr_b16 v[214:215], v11 offset:45056
    v_mfma_f32_16x16x32_bf16 v[112:115], v[220:223], v[168:171], v[112:115]
    ds_read_b64_tr_b16 v[216:217], v12 offset:40960
    v_mfma_f32_16x16x32_bf16 v[116:119], v[220:223], v[172:175], v[116:119]
    ds_read_b64_tr_b16 v[218:219], v12 offset:45056
    s_waitcnt lgkmcnt(10)
    v_mfma_f32_16x16x32_bf16 v[120:123], v[224:227], v[168:171], v[120:123]
    ds_read_b64_tr_b16 v[220:221], v13 offset:40960
    v_mfma_f32_16x16x32_bf16 v[124:127], v[224:227], v[172:175], v[124:127]
    ds_read_b64_tr_b16 v[222:223], v13 offset:45056
    v_mfma_f32_16x16x32_bf16 v[128:131], v[228:231], v[168:171], v[128:131]
    ds_read_b64_tr_b16 v[224:225], v14 offset:40960
    v_mfma_f32_16x16x32_bf16 v[132:135], v[228:231], v[172:175], v[132:135]
    ds_read_b64_tr_b16 v[226:227], v14 offset:45056
    s_waitcnt lgkmcnt(10)
    v_mfma_f32_16x16x32_bf16 v[72:75], v[200:203], v[176:179], v[72:75]
    ds_read_b64_tr_b16 v[228:229], v15 offset:40960
    v_mfma_f32_16x16x32_bf16 v[76:79], v[200:203], v[180:183], v[76:79]
    ds_read_b64_tr_b16 v[230:231], v15 offset:45056
    v_mfma_f32_16x16x32_bf16 v[80:83], v[204:207], v[176:179], v[80:83]
    v_mfma_f32_16x16x32_bf16 v[84:87], v[204:207], v[180:183], v[84:87]
    s_waitcnt lgkmcnt(8)
    v_mfma_f32_16x16x32_bf16 v[88:91], v[208:211], v[176:179], v[88:91]
    v_mfma_f32_16x16x32_bf16 v[92:95], v[208:211], v[180:183], v[92:95]
    v_mfma_f32_16x16x32_bf16 v[96:99], v[212:215], v[176:179], v[96:99]
    v_mfma_f32_16x16x32_bf16 v[100:103], v[212:215], v[180:183], v[100:103]
    s_waitcnt lgkmcnt(4)
    v_mfma_f32_16x16x32_bf16 v[104:107], v[216:219], v[176:179], v[104:107]
    v_mfma_f32_16x16x32_bf16 v[108:111], v[216:219], v[180:183], v[108:111]
    v_mfma_f32_16x16x32_bf16 v[112:115], v[220:223], v[176:179], v[112:115]
    v_mfma_f32_16x16x32_bf16 v[116:119], v[220:223], v[180:183], v[116:119]
    s_waitcnt lgkmcnt(0)
    v_mfma_f32_16x16x32_bf16 v[120:123], v[224:227], v[176:179], v[120:123]
    v_mfma_f32_16x16x32_bf16 v[124:127], v[224:227], v[180:183], v[124:127]
    v_mfma_f32_16x16x32_bf16 v[128:131], v[228:231], v[176:179], v[128:131]
    v_mfma_f32_16x16x32_bf16 v[132:135], v[228:231], v[180:183], v[132:135]
    s_setprio 3
    s_lshl_b32 s12, s26, 19
    s_add_u32 s12, s12, s80
    s_add_u32 s12, s12, 256
    s_add_u32 m0, s78, 0
    s_nop 0
    buffer_load_dwordx4 v6, s[56:59], s12 offen lds
    s_add_u32 s13, s12, 262144
    s_add_u32 m0, s78, 8192
    s_nop 0
    buffer_load_dwordx4 v6, s[56:59], s13 offen lds
    v_xor_b32 v6, 128, v6
    s_add_u32 s13, s12, 65536
    s_add_u32 m0, s78, 1024
    s_nop 0
    buffer_load_dwordx4 v6, s[56:59], s13 offen lds
    s_add_u32 s13, s12, 327680
    s_add_u32 m0, s78, 9216
    s_nop 0
    buffer_load_dwordx4 v6, s[56:59], s13 offen lds
    v_xor_b32 v6, 128, v6
    s_add_u32 s26, s26, 1
    s_cmp_eq_u32 s26, 9
    s_cselect_b32 s26, 0, s26
    s_waitcnt vmcnt(16) lgkmcnt(0)
    s_barrier
    ds_read_b64_tr_b16 v[200:201], v8 offset:49152
    ds_read_b64_tr_b16 v[202:203], v8 offset:53248
    ds_read_b64_tr_b16 v[204:205], v9 offset:49152
    ds_read_b64_tr_b16 v[206:207], v9 offset:53248
    ds_read_b64_tr_b16 v[208:209], v10 offset:49152
    ds_read_b64_tr_b16 v[210:211], v10 offset:53248
    ds_read_b64_tr_b16 v[212:213], v11 offset:49152
    ds_read_b64_tr_b16 v[214:215], v11 offset:53248
    ds_read_b64_tr_b16 v[216:217], v12 offset:49152
    ds_read_b64_tr_b16 v[218:219], v12 offset:53248
    ds_read_b64_tr_b16 v[220:221], v13 offset:49152
    ds_read_b64_tr_b16 v[222:223], v13 offset:53248
    ds_read_b64_tr_b16 v[224:225], v14 offset:49152
    ds_read_b64_tr_b16 v[226:227], v14 offset:53248
    s_lshl_b32 s11, s94, 3
    buffer_load_dwordx2 v[136:137], off, s[72:75], s11 sc1
    s_add_u32 s13, s32, 0
    s_add_u32 m0, s76, 65536
    s_nop 0
    buffer_load_dwordx4 v4, s[48:51], s13 offen offset:0 nt lds
    v_xor_b32 v4, 64, v4
    buffer_load_dwordx4 v4, s[48:51], s13 offen offset:1024 nt lds
    v_xor_b32 v4, 128, v4
    buffer_load_dwordx4 v4, s[48:51], s13 offen offset:3072 nt lds
    v_xor_b32 v4, 64, v4
    buffer_load_dwordx4 v4, s[48:51], s13 offen offset:2048 nt lds
    s_add_u32 s13, s32, 4096
    s_add_u32 m0, s76, 69632
    s_nop 0
    buffer_load_dwordx4 v4, s[48:51], s13 offen offset:2048 nt lds
    v_xor_b32 v4, 64, v4
    buffer_load_dwordx4 v4, s[48:51], s13 offen offset:3072 nt lds
    v_xor_b32 v4, 128, v4
    buffer_load_dwordx4 v4, s[48:51], s13 offen offset:1024 nt lds
    v_xor_b32 v4, 64, v4
    buffer_load_dwordx4 v4, s[48:51], s13 offen offset:0 nt lds
    s_setprio 3
    s_waitcnt lgkmcnt(10)
    v_mfma_f32_16x16x32_bf16 v[72:75], v[200:203], v[184:187], v[72:75]
    ds_read_b64_tr_b16 v[228:229], v15 offset:49152
    v_mfma_f32_16x16x32_bf16 v[76:79], v[200:203], v[188:191], v[76:79]
    ds_read_b64_tr_b16 v[230:231], v15 offset:53248
    v_mfma_f32_16x16x32_bf16 v[80:83], v[204:207], v[184:187], v[80:83]
    ds_read_b64_tr_b16 v[200:201], v8 offset:57344
    v_mfma_f32_16x16x32_bf16 v[84:87], v[204:207], v[188:191], v[84:87]
    ds_read_b64_tr_b16 v[202:203], v8 offset:61440
    s_waitcnt lgkmcnt(10)
    v_mfma_f32_16x16x32_bf16 v[88:91], v[208:211], v[184:187], v[88:91]
    ds_read_b64_tr_b16 v[204:205], v9 offset:57344
    v_mfma_f32_16x16x32_bf16 v[92:95], v[208:211], v[188:191], v[92:95]
    ds_read_b64_tr_b16 v[206:207], v9 offset:61440
    v_mfma_f32_16x16x32_bf16 v[96:99], v[212:215], v[184:187], v[96:99]
    ds_read_b64_tr_b16 v[208:209], v10 offset:57344
    v_mfma_f32_16x16x32_bf16 v[100:103], v[212:215], v[188:191], v[100:103]
    ds_read_b64_tr_b16 v[210:211], v10 offset:61440
    s_waitcnt lgkmcnt(10)
    v_mfma_f32_16x16x32_bf16 v[104:107], v[216:219], v[184:187], v[104:107]
    ds_read_b64_tr_b16 v[212:213], v11 offset:57344
    v_mfma_f32_16x16x32_bf16 v[108:111], v[216:219], v[188:191], v[108:111]
    ds_read_b64_tr_b16 v[214:215], v11 offset:61440
    v_mfma_f32_16x16x32_bf16 v[112:115], v[220:223], v[184:187], v[112:115]
    ds_read_b64_tr_b16 v[216:217], v12 offset:57344
    v_mfma_f32_16x16x32_bf16 v[116:119], v[220:223], v[188:191], v[116:119]
    ds_read_b64_tr_b16 v[218:219], v12 offset:61440
    s_waitcnt lgkmcnt(10)
    v_mfma_f32_16x16x32_bf16 v[120:123], v[224:227], v[184:187], v[120:123]
    ds_read_b64_tr_b16 v[220:221], v13 offset:57344
    v_mfma_f32_16x16x32_bf16 v[124:127], v[224:227], v[188:191], v[124:127]
    ds_read_b64_tr_b16 v[222:223], v13 offset:61440
    v_mfma_f32_16x16x32_bf16 v[128:131], v[228:231], v[184:187], v[128:131]
    ds_read_b64_tr_b16 v[224:225], v14 offset:57344
    v_mfma_f32_16x16x32_bf16 v[132:135], v[228:231], v[188:191], v[132:135]
    ds_read_b64_tr_b16 v[226:227], v14 offset:61440
    s_waitcnt lgkmcnt(10)
    v_mfma_f32_16x16x32_bf16 v[72:75], v[200:203], v[192:195], v[72:75]
    ds_read_b64_tr_b16 v[228:229], v15 offset:57344
    v_mfma_f32_16x16x32_bf16 v[76:79], v[200:203], v[196:199], v[76:79]
    ds_read_b64_tr_b16 v[230:231], v15 offset:61440
    v_mfma_f32_16x16x32_bf16 v[80:83], v[204:207], v[192:195], v[80:83]
    v_mfma_f32_16x16x32_bf16 v[84:87], v[204:207], v[196:199], v[84:87]
    s_waitcnt lgkmcnt(8)
    v_mfma_f32_16x16x32_bf16 v[88:91], v[208:211], v[192:195], v[88:91]
    v_mfma_f32_16x16x32_bf16 v[92:95], v[208:211], v[196:199], v[92:95]
    v_mfma_f32_16x16x32_bf16 v[96:99], v[212:215], v[192:195], v[96:99]
    v_mfma_f32_16x16x32_bf16 v[100:103], v[212:215], v[196:199], v[100:103]
    s_waitcnt lgkmcnt(4)
    v_mfma_f32_16x16x32_bf16 v[104:107], v[216:219], v[192:195], v[104:107]
    v_mfma_f32_16x16x32_bf16 v[108:111], v[216:219], v[196:199], v[108:111]
    v_mfma_f32_16x16x32_bf16 v[112:115], v[220:223], v[192:195], v[112:115]
    v_mfma_f32_16x16x32_bf16 v[116:119], v[220:223], v[196:199], v[116:119]
    s_waitcnt lgkmcnt(0)
    v_mfma_f32_16x16x32_bf16 v[120:123], v[224:227], v[192:195], v[120:123]
    v_mfma_f32_16x16x32_bf16 v[124:127], v[224:227], v[196:199], v[124:127]
    v_mfma_f32_16x16x32_bf16 v[128:131], v[228:231], v[192:195], v[128:131]
    v_mfma_f32_16x16x32_bf16 v[132:135], v[228:231], v[196:199], v[132:135]
    s_setprio 3
    s_lshl_b32 s12, s26, 19
    s_add_u32 s12, s12, s80
    s_add_u32 s12, s12, 256
    s_add_u32 m0, s78, 16384
    s_nop 0
    buffer_load_dwordx4 v6, s[56:59], s12 offen lds
    s_add_u32 s13, s12, 262144
    s_add_u32 m0, s78, 24576
    s_nop 0
    buffer_load_dwordx4 v6, s[56:59], s13 offen lds
    v_xor_b32 v6, 128, v6
    s_add_u32 s13, s12, 65536
    s_add_u32 m0, s78, 17408
    s_nop 0
    buffer_load_dwordx4 v6, s[56:59], s13 offen lds
    s_add_u32 s13, s12, 327680
    s_add_u32 m0, s78, 25600
    s_nop 0
    buffer_load_dwordx4 v6, s[56:59], s13 offen lds
    v_xor_b32 v6, 128, v6
    s_add_u32 s26, s26, 1
    s_cmp_eq_u32 s26, 9
    s_cselect_b32 s26, 0, s26
    s_waitcnt vmcnt(13) lgkmcnt(0)
    s_barrier
    ds_read_b64_tr_b16 v[200:201], v8 offset:0
    ds_read_b64_tr_b16 v[202:203], v8 offset:4096
    ds_read_b64_tr_b16 v[204:205], v9 offset:0
    ds_read_b64_tr_b16 v[206:207], v9 offset:4096
    ds_read_b64_tr_b16 v[208:209], v10 offset:0
    ds_read_b64_tr_b16 v[210:211], v10 offset:4096
    ds_read_b64_tr_b16 v[212:213], v11 offset:0
    ds_read_b64_tr_b16 v[214:215], v11 offset:4096
    ds_read_b64_tr_b16 v[216:217], v12 offset:0
    ds_read_b64_tr_b16 v[218:219], v12 offset:4096
    ds_read_b64_tr_b16 v[220:221], v13 offset:0
    ds_read_b64_tr_b16 v[222:223], v13 offset:4096
    ds_read_b64_tr_b16 v[224:225], v14 offset:0
    ds_read_b64_tr_b16 v[226:227], v14 offset:4096
    s_add_u32 s13, s32, 0
    s_add_u32 m0, s76, 98304
    s_nop 0
    buffer_load_dwordx4 v5, s[52:55], s13 offen offset:0 nt lds
    buffer_load_dwordx4 v5, s[52:55], s13 offen offset:2048 nt lds
    v_xor_b32 v5, 128, v5
    buffer_load_dwordx4 v5, s[52:55], s13 offen offset:1024 nt lds
    buffer_load_dwordx4 v5, s[52:55], s13 offen offset:3072 nt lds
    s_add_u32 s13, s32, 4096
    s_add_u32 m0, s76, 102400
    s_nop 0
    buffer_load_dwordx4 v5, s[52:55], s13 offen offset:1024 nt lds
    buffer_load_dwordx4 v5, s[52:55], s13 offen offset:3072 nt lds
    v_xor_b32 v5, 128, v5
    buffer_load_dwordx4 v5, s[52:55], s13 offen offset:0 nt lds
    buffer_load_dwordx4 v5, s[52:55], s13 offen offset:2048 nt lds
    s_setprio 3
    s_waitcnt lgkmcnt(10)
    v_mfma_f32_16x16x32_bf16 v[72:75], v[200:203], v[16:19], v[72:75]
    ds_read_b64_tr_b16 v[228:229], v15 offset:0
    v_mfma_f32_16x16x32_bf16 v[76:79], v[200:203], v[20:23], v[76:79]
    ds_read_b64_tr_b16 v[230:231], v15 offset:4096
    v_mfma_f32_16x16x32_bf16 v[80:83], v[204:207], v[16:19], v[80:83]
    ds_read_b64_tr_b16 v[200:201], v8 offset:8192
    v_mfma_f32_16x16x32_bf16 v[84:87], v[204:207], v[20:23], v[84:87]
    ds_read_b64_tr_b16 v[202:203], v8 offset:12288
    s_waitcnt lgkmcnt(10)
    v_mfma_f32_16x16x32_bf16 v[88:91], v[208:211], v[16:19], v[88:91]
    ds_read_b64_tr_b16 v[204:205], v9 offset:8192
    v_mfma_f32_16x16x32_bf16 v[92:95], v[208:211], v[20:23], v[92:95]
    ds_read_b64_tr_b16 v[206:207], v9 offset:12288
    v_mfma_f32_16x16x32_bf16 v[96:99], v[212:215], v[16:19], v[96:99]
    ds_read_b64_tr_b16 v[208:209], v10 offset:8192
    v_mfma_f32_16x16x32_bf16 v[100:103], v[212:215], v[20:23], v[100:103]
    ds_read_b64_tr_b16 v[210:211], v10 offset:12288
    s_waitcnt lgkmcnt(10)
    v_mfma_f32_16x16x32_bf16 v[104:107], v[216:219], v[16:19], v[104:107]
    ds_read_b64_tr_b16 v[212:213], v11 offset:8192
    v_mfma_f32_16x16x32_bf16 v[108:111], v[216:219], v[20:23], v[108:111]
    ds_read_b64_tr_b16 v[214:215], v11 offset:12288
    v_mfma_f32_16x16x32_bf16 v[112:115], v[220:223], v[16:19], v[112:115]
    ds_read_b64_tr_b16 v[216:217], v12 offset:8192
    v_mfma_f32_16x16x32_bf16 v[116:119], v[220:223], v[20:23], v[116:119]
    ds_read_b64_tr_b16 v[218:219], v12 offset:12288
    s_waitcnt lgkmcnt(10)
    v_mfma_f32_16x16x32_bf16 v[120:123], v[224:227], v[16:19], v[120:123]
    ds_read_b64_tr_b16 v[220:221], v13 offset:8192
    v_mfma_f32_16x16x32_bf16 v[124:127], v[224:227], v[20:23], v[124:127]
    ds_read_b64_tr_b16 v[222:223], v13 offset:12288
    v_mfma_f32_16x16x32_bf16 v[128:131], v[228:231], v[16:19], v[128:131]
    ds_read_b64_tr_b16 v[224:225], v14 offset:8192
    v_mfma_f32_16x16x32_bf16 v[132:135], v[228:231], v[20:23], v[132:135]
    ds_read_b64_tr_b16 v[226:227], v14 offset:12288
    s_waitcnt lgkmcnt(10)
    v_mfma_f32_16x16x32_bf16 v[72:75], v[200:203], v[24:27], v[72:75]
    ds_read_b64_tr_b16 v[228:229], v15 offset:8192
    v_mfma_f32_16x16x32_bf16 v[76:79], v[200:203], v[28:31], v[76:79]
    ds_read_b64_tr_b16 v[230:231], v15 offset:12288
    v_mfma_f32_16x16x32_bf16 v[80:83], v[204:207], v[24:27], v[80:83]
    v_mfma_f32_16x16x32_bf16 v[84:87], v[204:207], v[28:31], v[84:87]
    s_waitcnt lgkmcnt(8)
    v_mfma_f32_16x16x32_bf16 v[88:91], v[208:211], v[24:27], v[88:91]
    v_mfma_f32_16x16x32_bf16 v[92:95], v[208:211], v[28:31], v[92:95]
    v_mfma_f32_16x16x32_bf16 v[96:99], v[212:215], v[24:27], v[96:99]
    v_mfma_f32_16x16x32_bf16 v[100:103], v[212:215], v[28:31], v[100:103]
    s_waitcnt lgkmcnt(4)
    v_mfma_f32_16x16x32_bf16 v[104:107], v[216:219], v[24:27], v[104:107]
    v_mfma_f32_16x16x32_bf16 v[108:111], v[216:219], v[28:31], v[108:111]
    v_mfma_f32_16x16x32_bf16 v[112:115], v[220:223], v[24:27], v[112:115]
    v_mfma_f32_16x16x32_bf16 v[116:119], v[220:223], v[28:31], v[116:119]
    s_waitcnt lgkmcnt(0)
    v_mfma_f32_16x16x32_bf16 v[120:123], v[224:227], v[24:27], v[120:123]
    v_mfma_f32_16x16x32_bf16 v[124:127], v[224:227], v[28:31], v[124:127]
    v_mfma_f32_16x16x32_bf16 v[128:131], v[228:231], v[24:27], v[128:131]
    v_mfma_f32_16x16x32_bf16 v[132:135], v[228:231], v[28:31], v[132:135]
    s_setprio 3
    s_lshl_b32 s12, s26, 19
    s_add_u32 s12, s12, s80
    s_add_u32 s12, s12, 256
    s_add_u32 m0, s78, 32768
    s_nop 0
    buffer_load_dwordx4 v6, s[56:59], s12 offen lds
    s_add_u32 s13, s12, 262144
    s_add_u32 m0, s78, 40960
    s_nop 0
    buffer_load_dwordx4 v6, s[56:59], s13 offen lds
    v_xor_b32 v6, 128, v6
    s_add_u32 s13, s12, 65536
    s_add_u32 m0, s78, 33792
    s_nop 0
    buffer_load_dwordx4 v6, s[56:59], s13 offen lds
    s_add_u32 s13, s12, 327680
    s_add_u32 m0, s78, 41984
    s_nop 0
    buffer_load_dwordx4 v6, s[56:59], s13 offen lds
    v_xor_b32 v6, 128, v6
    s_add_u32 s26, s26, 1
    s_cmp_eq_u32 s26, 9
    s_cselect_b32 s26, 0, s26
    s_lshl_b32 s11, s6, 4
    s_add_u32 s11, s11, s7
    s_lshl_b32 s11, s11, 2
    s_add_u32 s11, s11, s4
    s_mul_i32 s11, s11, 4608
    s_mul_i32 s12, s8, 1179648
    s_add_u32 s11, s11, s12
    v_lshlrev_b32 v3, 3, v2
    v_min_u32 v3, 4480, v3
    buffer_load_dword v7, v3, s[60:63], s11 offen
    s_lshl_b32 s11, s6, 4
    s_add_u32 s11, s11, s7
    s_lshl_b32 s11, s11, 2
    s_add_u32 s11, s11, s4
    s_mul_i32 s11, s11, 4608
    s_mul_i32 s12, s8, 1179648
    s_add_u32 s11, s11, s12
    v_lshlrev_b32 v3, 3, v2
    v_min_u32 v3, 4480, v3
    s_add_u32 s11, s11, 147456
    buffer_load_dword v7, v3, s[60:63], s11 offen
    s_waitcnt vmcnt(14) lgkmcnt(0)
    s_barrier
    ds_read_b64_tr_b16 v[200:201], v8 offset:16384
    ds_read_b64_tr_b16 v[202:203], v8 offset:20480
    ds_read_b64_tr_b16 v[204:205], v9 offset:16384
    ds_read_b64_tr_b16 v[206:207], v9 offset:20480
    ds_read_b64_tr_b16 v[208:209], v10 offset:16384
    ds_read_b64_tr_b16 v[210:211], v10 offset:20480
    ds_read_b64_tr_b16 v[212:213], v11 offset:16384
    ds_read_b64_tr_b16 v[214:215], v11 offset:20480
    ds_read_b64_tr_b16 v[216:217], v12 offset:16384
    ds_read_b64_tr_b16 v[218:219], v12 offset:20480
    ds_read_b64_tr_b16 v[220:221], v13 offset:16384
    ds_read_b64_tr_b16 v[222:223], v13 offset:20480
    ds_read_b64_tr_b16 v[224:225], v14 offset:16384
    ds_read_b64_tr_b16 v[226:227], v14 offset:20480
    s_add_u32 s13, s33, 0
    s_add_u32 m0, s76, 131072
    s_nop 0
    buffer_load_dwordx4 v4, s[48:51], s13 offen offset:0 nt lds
    v_xor_b32 v4, 64, v4
    buffer_load_dwordx4 v4, s[48:51], s13 offen offset:1024 nt lds
    v_xor_b32 v4, 128, v4
    buffer_load_dwordx4 v4, s[48:51], s13 offen offset:3072 nt lds
    v_xor_b32 v4, 64, v4
    buffer_load_dwordx4 v4, s[48:51], s13 offen offset:2048 nt lds
    s_add_u32 s13, s33, 4096
    s_add_u32 m0, s76, 135168
    s_nop 0
    buffer_load_dwordx4 v4, s[48:51], s13 offen offset:2048 nt lds
    v_xor_b32 v4, 64, v4
    buffer_load_dwordx4 v4, s[48:51], s13 offen offset:3072 nt lds
    v_xor_b32 v4, 128, v4
    buffer_load_dwordx4 v4, s[48:51], s13 offen offset:1024 nt lds
    v_xor_b32 v4, 64, v4
    buffer_load_dwordx4 v4, s[48:51], s13 offen offset:0 nt lds
    s_setprio 3
    s_waitcnt lgkmcnt(10)
    v_mfma_f32_16x16x32_bf16 v[72:75], v[200:203], v[32:35], v[72:75]
    ds_read_b64_tr_b16 v[228:229], v15 offset:16384
    v_mfma_f32_16x16x32_bf16 v[76:79], v[200:203], v[36:39], v[76:79]
    ds_read_b64_tr_b16 v[230:231], v15 offset:20480
    v_mfma_f32_16x16x32_bf16 v[80:83], v[204:207], v[32:35], v[80:83]
    ds_read_b64_tr_b16 v[200:201], v8 offset:24576
    v_mfma_f32_16x16x32_bf16 v[84:87], v[204:207], v[36:39], v[84:87]
    ds_read_b64_tr_b16 v[202:203], v8 offset:28672
    s_waitcnt lgkmcnt(10)
    v_mfma_f32_16x16x32_bf16 v[88:91], v[208:211], v[32:35], v[88:91]
    ds_read_b64_tr_b16 v[204:205], v9 offset:24576
    v_mfma_f32_16x16x32_bf16 v[92:95], v[208:211], v[36:39], v[92:95]
    ds_read_b64_tr_b16 v[206:207], v9 offset:28672
    v_mfma_f32_16x16x32_bf16 v[96:99], v[212:215], v[32:35], v[96:99]
    ds_read_b64_tr_b16 v[208:209], v10 offset:24576
    v_mfma_f32_16x16x32_bf16 v[100:103], v[212:215], v[36:39], v[100:103]
    ds_read_b64_tr_b16 v[210:211], v10 offset:28672
    s_waitcnt lgkmcnt(10)
    v_mfma_f32_16x16x32_bf16 v[104:107], v[216:219], v[32:35], v[104:107]
    ds_read_b64_tr_b16 v[212:213], v11 offset:24576
    v_mfma_f32_16x16x32_bf16 v[108:111], v[216:219], v[36:39], v[108:111]
    ds_read_b64_tr_b16 v[214:215], v11 offset:28672
    v_mfma_f32_16x16x32_bf16 v[112:115], v[220:223], v[32:35], v[112:115]
    ds_read_b64_tr_b16 v[216:217], v12 offset:24576
    v_mfma_f32_16x16x32_bf16 v[116:119], v[220:223], v[36:39], v[116:119]
    ds_read_b64_tr_b16 v[218:219], v12 offset:28672
    s_waitcnt lgkmcnt(10)
    v_mfma_f32_16x16x32_bf16 v[120:123], v[224:227], v[32:35], v[120:123]
    ds_read_b64_tr_b16 v[220:221], v13 offset:24576
    v_mfma_f32_16x16x32_bf16 v[124:127], v[224:227], v[36:39], v[124:127]
    ds_read_b64_tr_b16 v[222:223], v13 offset:28672
    v_mfma_f32_16x16x32_bf16 v[128:131], v[228:231], v[32:35], v[128:131]
    ds_read_b64_tr_b16 v[224:225], v14 offset:24576
    v_mfma_f32_16x16x32_bf16 v[132:135], v[228:231], v[36:39], v[132:135]
    ds_read_b64_tr_b16 v[226:227], v14 offset:28672
    s_waitcnt lgkmcnt(10)
    v_mfma_f32_16x16x32_bf16 v[72:75], v[200:203], v[232:235], v[72:75]
    ds_read_b64_tr_b16 v[228:229], v15 offset:24576
    v_mfma_f32_16x16x32_bf16 v[76:79], v[200:203], v[236:239], v[76:79]
    ds_read_b64_tr_b16 v[230:231], v15 offset:28672
    v_mfma_f32_16x16x32_bf16 v[80:83], v[204:207], v[232:235], v[80:83]
    v_mfma_f32_16x16x32_bf16 v[84:87], v[204:207], v[236:239], v[84:87]
    s_waitcnt lgkmcnt(8)
    v_mfma_f32_16x16x32_bf16 v[88:91], v[208:211], v[232:235], v[88:91]
    v_mfma_f32_16x16x32_bf16 v[92:95], v[208:211], v[236:239], v[92:95]
    v_mfma_f32_16x16x32_bf16 v[96:99], v[212:215], v[232:235], v[96:99]
    v_mfma_f32_16x16x32_bf16 v[100:103], v[212:215], v[236:239], v[100:103]
    s_waitcnt lgkmcnt(4)
    v_mfma_f32_16x16x32_bf16 v[104:107], v[216:219], v[232:235], v[104:107]
    v_mfma_f32_16x16x32_bf16 v[108:111], v[216:219], v[236:239], v[108:111]
    v_mfma_f32_16x16x32_bf16 v[112:115], v[220:223], v[232:235], v[112:115]
    v_mfma_f32_16x16x32_bf16 v[116:119], v[220:223], v[236:239], v[116:119]
    s_waitcnt lgkmcnt(0)
    v_mfma_f32_16x16x32_bf16 v[120:123], v[224:227], v[232:235], v[120:123]
    v_mfma_f32_16x16x32_bf16 v[124:127], v[224:227], v[236:239], v[124:127]
    v_mfma_f32_16x16x32_bf16 v[128:131], v[228:231], v[232:235], v[128:131]
    v_mfma_f32_16x16x32_bf16 v[132:135], v[228:231], v[236:239], v[132:135]
    s_setprio 3
    s_lshl_b32 s12, s26, 19
    s_add_u32 s12, s12, s80
    s_add_u32 s12, s12, 256
    s_add_u32 m0, s78, 0
    s_nop 0
    buffer_load_dwordx4 v6, s[56:59], s12 offen lds
    s_add_u32 s13, s12, 262144
    s_add_u32 m0, s78, 8192
    s_nop 0
    buffer_load_dwordx4 v6, s[56:59], s13 offen lds
    v_xor_b32 v6, 128, v6
    s_add_u32 s13, s12, 65536
    s_add_u32 m0, s78, 1024
    s_nop 0
    buffer_load_dwordx4 v6, s[56:59], s13 offen lds
    s_add_u32 s13, s12, 327680
    s_add_u32 m0, s78, 9216
    s_nop 0
    buffer_load_dwordx4 v6, s[56:59], s13 offen lds
    v_xor_b32 v6, 128, v6
    s_add_u32 s26, s26, 1
    s_cmp_eq_u32 s26, 9
    s_cselect_b32 s26, 0, s26
    v_mov_b32 v136, v136
    s_mov_b32 s96, 200000
L_nonrh:
    v_readfirstlane_b32 s92, v136
    v_readfirstlane_b32 s93, v137
    s_nop 0
    s_cmp_lg_u32 s92, 0
    s_cbranch_scc1 L_nonokh
    s_sub_u32 s96, s96, 1
    s_cbranch_scc1 L_nonokh
    s_lshl_b32 s11, s94, 3
    buffer_load_dwordx2 v[136:137], off, s[72:75], s11 sc1
    s_waitcnt vmcnt(0)
    s_branch L_nonrh
L_nonokh:
    s_getreg_b32 s35, hwreg(HW_REG_XCC_ID, 0, 4)
    s_lshl_b32 s35, s35, 28
    s_xor_b32 s12, s93, s35
    s_lshl_b32 s11, s6, 3
    s_add_u32 s11, s11, s99
    v_mov_b32 v136, s92
    v_mov_b32 v137, s12
    s_mov_b64 exec, 1
    buffer_store_dwordx2 v[136:137], off, s[68:71], s11 offset:96 sc1
    s_mov_b64 exec, -1
    s_waitcnt vmcnt(15) lgkmcnt(0)
    s_barrier
    ds_read_b64_tr_b16 v[200:201], v8 offset:32768
    ds_read_b64_tr_b16 v[202:203], v8 offset:36864
    ds_read_b64_tr_b16 v[204:205], v9 offset:32768
    ds_read_b64_tr_b16 v[206:207], v9 offset:36864
    ds_read_b64_tr_b16 v[208:209], v10 offset:32768
    ds_read_b64_tr_b16 v[210:211], v10 offset:36864
    ds_read_b64_tr_b16 v[212:213], v11 offset:32768
    ds_read_b64_tr_b16 v[214:215], v11 offset:36864
    ds_read_b64_tr_b16 v[216:217], v12 offset:32768
    ds_read_b64_tr_b16 v[218:219], v12 offset:36864
    ds_read_b64_tr_b16 v[220:221], v13 offset:32768
    ds_read_b64_tr_b16 v[222:223], v13 offset:36864
    ds_read_b64_tr_b16 v[224:225], v14 offset:32768
    ds_read_b64_tr_b16 v[226:227], v14 offset:36864
    s_add_u32 s13, s33, 0
    s_add_u32 m0, s76, 65536
    s_nop 0
    buffer_load_dwordx4 v5, s[52:55], s13 offen offset:0 nt lds
    buffer_load_dwordx4 v5, s[52:55], s13 offen offset:2048 nt lds
    v_xor_b32 v5, 128, v5
    buffer_load_dwordx4 v5, s[52:55], s13 offen offset:1024 nt lds
    buffer_load_dwordx4 v5, s[52:55], s13 offen offset:3072 nt lds
    s_add_u32 s13, s33, 4096
    s_add_u32 m0, s76, 69632
    s_nop 0
    buffer_load_dwordx4 v5, s[52:55], s13 offen offset:1024 nt lds
    buffer_load_dwordx4 v5, s[52:55], s13 offen offset:3072 nt lds
    v_xor_b32 v5, 128, v5
    buffer_load_dwordx4 v5, s[52:55], s13 offen offset:0 nt lds
    buffer_load_dwordx4 v5, s[52:55], s13 offen offset:2048 nt lds
    s_setprio 3
    s_waitcnt lgkmcnt(10)
    v_mfma_f32_16x16x32_bf16 v[72:75], v[200:203], v[240:243], v[72:75]
    ds_read_b64_tr_b16 v[228:229], v15 offset:32768
    v_mfma_f32_16x16x32_bf16 v[76:79], v[200:203], v[244:247], v[76:79]
    ds_read_b64_tr_b16 v[230:231], v15 offset:36864
    v_mfma_f32_16x16x32_bf16 v[80:83], v[204:207], v[240:243], v[80:83]
    ds_read_b64_tr_b16 v[200:201], v8 offset:40960
    v_mfma_f32_16x16x32_bf16 v[84:87], v[204:207], v[244:247], v[84:87]
    ds_read_b64_tr_b16 v[202:203], v8 offset:45056
    s_waitcnt lgkmcnt(10)
    v_mfma_f32_16x16x32_bf16 v[88:91], v[208:211], v[240:243], v[88:91]
    ds_read_b64_tr_b16 v[204:205], v9 offset:40960
    v_mfma_f32_16x16x32_bf16 v[92:95], v[208:211], v[244:247], v[92:95]
    ds_read_b64_tr_b16 v[206:207], v9 offset:45056
    v_mfma_f32_16x16x32_bf16 v[96:99], v[212:215], v[240:243], v[96:99]
    ds_read_b64_tr_b16 v[208:209], v10 offset:40960
    v_mfma_f32_16x16x32_bf16 v[100:103], v[212:215], v[244:247], v[100:103]
    ds_read_b64_tr_b16 v[210:211], v10 offset:45056
    s_waitcnt lgkmcnt(10)
    v_mfma_f32_16x16x32_bf16 v[104:107], v[216:219], v[240:243], v[104:107]
    ds_read_b64_tr_b16 v[212:213], v11 offset:40960
    v_mfma_f32_16x16x32_bf16 v[108:111], v[216:219], v[244:247], v[108:111]
    ds_read_b64_tr_b16 v[214:215], v11 offset:45056
    v_mfma_f32_16x16x32_bf16 v[112:115], v[220:223], v[240:243], v[112:115]
    ds_read_b64_tr_b16 v[216:217], v12 offset:40960
    v_mfma_f32_16x16x32_bf16 v[116:119], v[220:223], v[244:247], v[116:119]
    ds_read_b64_tr_b16 v[218:219], v12 offset:45056
    s_waitcnt lgkmcnt(10)
    v_mfma_f32_16x16x32_bf16 v[120:123], v[224:227], v[240:243], v[120:123]
    ds_read_b64_tr_b16 v[220:221], v13 offset:40960
    v_mfma_f32_16x16x32_bf16 v[124:127], v[224:227], v[244:247], v[124:127]
    ds_read_b64_tr_b16 v[222:223], v13 offset:45056
    v_mfma_f32_16x16x32_bf16 v[128:131], v[228:231], v[240:243], v[128:131]
    ds_read_b64_tr_b16 v[224:225], v14 offset:40960
    v_mfma_f32_16x16x32_bf16 v[132:135], v[228:231], v[244:247], v[132:135]
    ds_read_b64_tr_b16 v[226:227], v14 offset:45056
    s_waitcnt lgkmcnt(10)
    v_mfma_f32_16x16x32_bf16 v[72:75], v[200:203], v[248:251], v[72:75]
    ds_read_b64_tr_b16 v[228:229], v15 offset:40960
    v_mfma_f32_16x16x32_bf16 v[76:79], v[200:203], v[252:255], v[76:79]
    ds_read_b64_tr_b16 v[230:231], v15 offset:45056
    v_mfma_f32_16x16x32_bf16 v[80:83], v[204:207], v[248:251], v[80:83]
    v_mfma_f32_16x16x32_bf16 v[84:87], v[204:207], v[252:255], v[84:87]
    s_waitcnt lgkmcnt(8)
    v_mfma_f32_16x16x32_bf16 v[88:91], v[208:211], v[248:251], v[88:91]
    v_mfma_f32_16x16x32_bf16 v[92:95], v[208:211], v[252:255], v[92:95]
    v_mfma_f32_16x16x32_bf16 v[96:99], v[212:215], v[248:251], v[96:99]
    v_mfma_f32_16x16x32_bf16 v[100:103], v[212:215], v[252:255], v[100:103]
    s_waitcnt lgkmcnt(4)
    v_mfma_f32_16x16x32_bf16 v[104:107], v[216:219], v[248:251], v[104:107]
    v_mfma_f32_16x16x32_bf16 v[108:111], v[216:219], v[252:255], v[108:111]
    v_mfma_f32_16x16x32_bf16 v[112:115], v[220:223], v[248:251], v[112:115]
    v_mfma_f32_16x16x32_bf16 v[116:119], v[220:223], v[252:255], v[116:119]
    s_waitcnt lgkmcnt(0)
    v_mfma_f32_16x16x32_bf16 v[120:123], v[224:227], v[248:251], v[120:123]
    v_mfma_f32_16x16x32_bf16 v[124:127], v[224:227], v[252:255], v[124:127]
    v_mfma_f32_16x16x32_bf16 v[128:131], v[228:231], v[248:251], v[128:131]
    v_mfma_f32_16x16x32_bf16 v[132:135], v[228:231], v[252:255], v[132:135]
    s_setprio 3
    s_lshl_b32 s12, s26, 19
    s_add_u32 s12, s12, s80
    s_add_u32 s12, s12, 256
    s_add_u32 m0, s78, 16384
    s_nop 0
    buffer_load_dwordx4 v6, s[56:59], s12 offen lds
    s_add_u32 s13, s12, 262144
    s_add_u32 m0, s78, 24576
    s_nop 0
    buffer_load_dwordx4 v6, s[56:59], s13 offen lds
    v_xor_b32 v6, 128, v6
    s_add_u32 s13, s12, 65536
    s_add_u32 m0, s78, 17408
    s_nop 0
    buffer_load_dwordx4 v6, s[56:59], s13 offen lds
    s_add_u32 s13, s12, 327680
    s_add_u32 m0, s78, 25600
    s_nop 0
    buffer_load_dwordx4 v6, s[56:59], s13 offen lds
    v_xor_b32 v6, 128, v6
    s_add_u32 s26, s26, 1
    s_cmp_eq_u32 s26, 9
    s_cselect_b32 s26, 0, s26
    v_mov_b32 v24, 0
    v_mov_b32 v25, 0
    v_mov_b32 v26, 0
    v_mov_b32 v27, 0
    v_mov_b32 v28, 0
    v_mov_b32 v29, 0
    v_mov_b32 v30, 0
    v_mov_b32 v31, 0
    v_mov_b32 v32, 0x3f803f80
    v_mov_b32 v33, 0x3f803f80
    v_mov_b32 v34, 0x3f803f80
    v_mov_b32 v35, 0x3f803f80
    s_waitcnt vmcnt(13) lgkmcnt(0)
    s_barrier
    ds_read_b64_tr_b16 v[200:201], v8 offset:0
    ds_read_b64_tr_b16 v[202:203], v8 offset:4096
    ds_read_b64_tr_b16 v[204:205], v9 offset:0
    ds_read_b64_tr_b16 v[206:207], v9 offset:4096
    ds_read_b64_tr_b16 v[208:209], v10 offset:0
    ds_read_b64_tr_b16 v[210:211], v10 offset:4096
    ds_read_b64_tr_b16 v[212:213], v11 offset:0
    ds_read_b64_tr_b16 v[214:215], v11 offset:4096
    ds_read_b64_tr_b16 v[216:217], v12 offset:0
    ds_read_b64_tr_b16 v[218:219], v12 offset:4096
    ds_read_b64_tr_b16 v[220:221], v13 offset:0
    ds_read_b64_tr_b16 v[222:223], v13 offset:4096
    ds_read_b64_tr_b16 v[224:225], v14 offset:0
    ds_read_b64_tr_b16 v[226:227], v14 offset:4096
    v_lshrrev_b32 v241, 4, v2
    v_mul_u32_u24 v240, 3641, v241
    v_mov_b32 v3, 864
    v_mad_u32_u16 v232, v240, v3, v2 op_sel:[1,0,0,0]
    v_add_u32 v233, 233024, v240
    v_mad_u32_u16 v233, v233, v3, v2 op_sel:[1,0,0,0]
    v_add_u32 v234, 466048, v240
    v_mad_u32_u16 v234, v234, v3, v2 op_sel:[1,0,0,0]
    v_add_u32 v235, 699072, v240
    v_mad_u32_u16 v235, v235, v3, v2 op_sel:[1,0,0,0]
    v_add_u32 v236, 932096, v240
    v_mad_u32_u16 v236, v236, v3, v2 op_sel:[1,0,0,0]
    v_add_u32 v237, 1165120, v240
    v_mad_u32_u16 v237, v237, v3, v2 op_sel:[1,0,0,0]
    v_add_u32 v238, 1398144, v240
    v_mad_u32_u16 v238, v238, v3, v2 op_sel:[1,0,0,0]
    v_add_u32 v239, 1631168, v240
    v_mad_u32_u16 v239, v239, v3, v2 op_sel:[1,0,0,0]
    v_add_u32 v240, 1864192, v240
    v_mad_u32_u16 v240, v240, v3, v2 op_sel:[1,0,0,0]
    s_mul_i32 s100, s8, 1179648
    s_mul_i32 s11, s6, 288
    s_add_u32 s100, s100, s11
    s_cmp_ge_u32 s4, 3
    s_cbranch_scc1 L_wo_1
    s_lshl_b32 s11, s6, 2
    s_add_u32 s11, s11, s4
    s_add_u32 s11, s11, 0
    s_and_b32 s12, s11, 12
    s_and_b32 s11, s11, 15
    s_add_u32 s11, s11, s12
    s_mul_i32 s11, s11, 36864
    s_add_u32 s11, s11, s100
    s_mov_b32 s12, 37888
    s_cmp_eq_u32 s4, 1
    s_cselect_b32 s12, 47104, s12
    s_cmp_eq_u32 s4, 2
    s_cselect_b32 s12, 56320, s12
    s_add_u32 m0, s12, 0
    s_nop 0
    buffer_load_dwordx4 v232, s[60:63], s11 offen offset:0 nt lds
    buffer_load_dwordx4 v233, s[60:63], s11 offen offset:1024 nt lds
    buffer_load_dwordx4 v234, s[60:63], s11 offen offset:2048 nt lds
    buffer_load_dwordx4 v235, s[60:63], s11 offen offset:3072 nt lds
    s_add_u32 s11, s11, 4096
    s_add_u32 m0, s12, 4096
    s_nop 0
    buffer_load_dwordx4 v236, s[60:63], s11 offen offset:0 nt lds
    buffer_load_dwordx4 v237, s[60:63], s11 offen offset:1024 nt lds
    buffer_load_dwordx4 v238, s[60:63], s11 offen offset:2048 nt lds
    buffer_load_dwordx4 v239, s[60:63], s11 offen offset:3072 nt lds
    s_add_u32 s11, s11, 4096
    s_add_u32 m0, s12, 8192
    s_nop 0
    buffer_load_dwordx4 v240, s[60:63], s11 offen offset:0 nt lds
L_wo_1:
    s_setprio 3
    s_waitcnt lgkmcnt(10)
    v_mfma_f32_16x16x32_bf16 v[72:75], v[200:203], v[40:43], v[72:75]
    ds_read_b64_tr_b16 v[228:229], v15 offset:0
    v_mfma_f32_16x16x32_bf16 v[76:79], v[200:203], v[44:47], v[76:79]
    ds_read_b64_tr_b16 v[230:231], v15 offset:4096
    v_mfma_f32_16x16x32_bf16 v[80:83], v[204:207], v[40:43], v[80:83]
    ds_read_b64_tr_b16 v[200:201], v8 offset:8192
    v_mfma_f32_16x16x32_bf16 v[84:87], v[204:207], v[44:47], v[84:87]
    ds_read_b64_tr_b16 v[202:203], v8 offset:12288
    s_waitcnt lgkmcnt(10)
    v_mfma_f32_16x16x32_bf16 v[88:91], v[208:211], v[40:43], v[88:91]
    ds_read_b64_tr_b16 v[204:205], v9 offset:8192
    v_mfma_f32_16x16x32_bf16 v[92:95], v[208:211], v[44:47], v[92:95]
    ds_read_b64_tr_b16 v[206:207], v9 offset:12288
    v_mfma_f32_16x16x32_bf16 v[96:99], v[212:215], v[40:43], v[96:99]
    ds_read_b64_tr_b16 v[208:209], v10 offset:8192
    v_mfma_f32_16x16x32_bf16 v[100:103], v[212:215], v[44:47], v[100:103]
    ds_read_b64_tr_b16 v[210:211], v10 offset:12288
    s_waitcnt lgkmcnt(10)
    v_mfma_f32_16x16x32_bf16 v[104:107], v[216:219], v[40:43], v[104:107]
    ds_read_b64_tr_b16 v[212:213], v11 offset:8192
    v_mfma_f32_16x16x32_bf16 v[108:111], v[216:219], v[44:47], v[108:111]
    ds_read_b64_tr_b16 v[214:215], v11 offset:12288
    v_mfma_f32_16x16x32_bf16 v[112:115], v[220:223], v[40:43], v[112:115]
    ds_read_b64_tr_b16 v[216:217], v12 offset:8192
    v_mfma_f32_16x16x32_bf16 v[116:119], v[220:223], v[44:47], v[116:119]
    ds_read_b64_tr_b16 v[218:219], v12 offset:12288
    s_waitcnt lgkmcnt(10)
    v_mfma_f32_16x16x32_bf16 v[120:123], v[224:227], v[40:43], v[120:123]
    ds_read_b64_tr_b16 v[220:221], v13 offset:8192
    v_mfma_f32_16x16x32_bf16 v[124:127], v[224:227], v[44:47], v[124:127]
    ds_read_b64_tr_b16 v[222:223], v13 offset:12288
    v_mfma_f32_16x16x32_bf16 v[128:131], v[228:231], v[40:43], v[128:131]
    ds_read_b64_tr_b16 v[224:225], v14 offset:8192
    v_mfma_f32_16x16x32_bf16 v[132:135], v[228:231], v[44:47], v[132:135]
    ds_read_b64_tr_b16 v[226:227], v14 offset:12288
    s_waitcnt lgkmcnt(10)
    v_mfma_f32_16x16x32_bf16 v[72:75], v[200:203], v[48:51], v[72:75]
    ds_read_b64_tr_b16 v[228:229], v15 offset:8192
    v_mfma_f32_16x16x32_bf16 v[76:79], v[200:203], v[52:55], v[76:79]
    ds_read_b64_tr_b16 v[230:231], v15 offset:12288
    v_mfma_f32_16x16x32_bf16 v[80:83], v[204:207], v[48:51], v[80:83]
    v_mfma_f32_16x16x32_bf16 v[84:87], v[204:207], v[52:55], v[84:87]
    s_waitcnt lgkmcnt(8)
    v_mfma_f32_16x16x32_bf16 v[88:91], v[208:211], v[48:51], v[88:91]
    v_mfma_f32_16x16x32_bf16 v[92:95], v[208:211], v[52:55], v[92:95]
    v_mfma_f32_16x16x32_bf16 v[96:99], v[212:215], v[48:51], v[96:99]
    v_mfma_f32_16x16x32_bf16 v[100:103], v[212:215], v[52:55], v[100:103]
    s_waitcnt lgkmcnt(4)
    v_mfma_f32_16x16x32_bf16 v[104:107], v[216:219], v[48:51], v[104:107]
    v_mfma_f32_16x16x32_bf16 v[108:111], v[216:219], v[52:55], v[108:111]
    v_mfma_f32_16x16x32_bf16 v[112:115], v[220:223], v[48:51], v[112:115]
    v_mfma_f32_16x16x32_bf16 v[116:119], v[220:223], v[52:55], v[116:119]
    s_waitcnt lgkmcnt(0)
    v_mfma_f32_16x16x32_bf16 v[120:123], v[224:227], v[48:51], v[120:123]
    v_mfma_f32_16x16x32_bf16 v[124:127], v[224:227], v[52:55], v[124:127]
    v_mfma_f32_16x16x32_bf16 v[128:131], v[228:231], v[48:51], v[128:131]
    v_mfma_f32_16x16x32_bf16 v[132:135], v[228:231], v[52:55], v[132:135]
    s_setprio 3
    s_add_u32 s13, s30, 131072
    s_add_u32 m0, s76, 98304
    s_nop 0
    buffer_load_dwordx4 v4, s[48:51], s13 offen offset:0 nt lds
    v_xor_b32 v4, 64, v4
    buffer_load_dwordx4 v4, s[48:51], s13 offen offset:1024 nt lds
    v_xor_b32 v4, 128, v4
    buffer_load_dwordx4 v4, s[48:51], s13 offen offset:3072 nt lds
    v_xor_b32 v4, 64, v4
    buffer_load_dwordx4 v4, s[48:51], s13 offen offset:2048 nt lds
    s_add_u32 s13, s30, 135168
    s_add_u32 m0, s76, 102400
    s_nop 0
    buffer_load_dwordx4 v4, s[48:51], s13 offen offset:2048 nt lds
    v_xor_b32 v4, 64, v4
    buffer_load_dwordx4 v4, s[48:51], s13 offen offset:3072 nt lds
    v_xor_b32 v4, 128, v4
    buffer_load_dwordx4 v4, s[48:51], s13 offen offset:1024 nt lds
    v_xor_b32 v4, 64, v4
    buffer_load_dwordx4 v4, s[48:51], s13 offen offset:0 nt lds
    s_lshl_b32 s11, s6, 4
    s_add_u32 s11, s11, s7
    s_lshl_b32 s11, s11, 2
    s_add_u32 s11, s11, s4
    s_mul_i32 s11, s11, 4608
    s_mul_i32 s12, s8, 1179648
    s_add_u32 s11, s11, s12
    v_lshlrev_b32 v3, 3, v2
    v_min_u32 v3, 4480, v3
    s_add_u32 s11, s11, 147456
    buffer_load_dword v250, v3, s[60:63], s11 offen
    s_waitcnt vmcnt(9) lgkmcnt(0)
    s_barrier
    ds_read_b64_tr_b16 v[200:201], v8 offset:16384
    ds_read_b64_tr_b16 v[202:203], v8 offset:20480
    ds_read_b64_tr_b16 v[204:205], v9 offset:16384
    ds_read_b64_tr_b16 v[206:207], v9 offset:20480
    ds_read_b64_tr_b16 v[208:209], v10 offset:16384
    ds_read_b64_tr_b16 v[210:211], v10 offset:20480
    ds_read_b64_tr_b16 v[212:213], v11 offset:16384
    ds_read_b64_tr_b16 v[214:215], v11 offset:20480
    ds_read_b64_tr_b16 v[216:217], v12 offset:16384
    ds_read_b64_tr_b16 v[218:219], v12 offset:20480
    ds_read_b64_tr_b16 v[220:221], v13 offset:16384
    ds_read_b64_tr_b16 v[222:223], v13 offset:20480
    ds_read_b64_tr_b16 v[224:225], v14 offset:16384
    ds_read_b64_tr_b16 v[226:227], v14 offset:20480
    v_lshrrev_b32 v3, 1, v2
    v_and_b32 v3, 24, v3
    buffer_load_dwordx2 v[244:245], v3, s[68:71], s99 offen offset:96 sc1
    s_add_u32 s13, s31, 131072
    s_add_u32 m0, s76, 131072
    s_nop 0
    buffer_load_dwordx4 v4, s[48:51], s13 offen offset:0 nt lds
    v_xor_b32 v4, 64, v4
    buffer_load_dwordx4 v4, s[48:51], s13 offen offset:1024 nt lds
    v_xor_b32 v4, 128, v4
    buffer_load_dwordx4 v4, s[48:51], s13 offen offset:3072 nt lds
    v_xor_b32 v4, 64, v4
    buffer_load_dwordx4 v4, s[48:51], s13 offen offset:2048 nt lds
    s_add_u32 s13, s31, 135168
    s_add_u32 m0, s76, 135168
    s_nop 0
    buffer_load_dwordx4 v4, s[48:51], s13 offen offset:2048 nt lds
    v_xor_b32 v4, 64, v4
    buffer_load_dwordx4 v4, s[48:51], s13 offen offset:3072 nt lds
    v_xor_b32 v4, 128, v4
    buffer_load_dwordx4 v4, s[48:51], s13 offen offset:1024 nt lds
    v_xor_b32 v4, 64, v4
    buffer_load_dwordx4 v4, s[48:51], s13 offen offset:0 nt lds
    s_setprio 3
    s_waitcnt lgkmcnt(10)
    v_mfma_f32_16x16x32_bf16 v[72:75], v[200:203], v[56:59], v[72:75]
    ds_read_b64_tr_b16 v[228:229], v15 offset:16384
    v_mfma_f32_16x16x32_bf16 v[76:79], v[200:203], v[60:63], v[76:79]
    ds_read_b64_tr_b16 v[230:231], v15 offset:20480
    v_mfma_f32_16x16x32_bf16 v[80:83], v[204:207], v[56:59], v[80:83]
    ds_read_b64_tr_b16 v[200:201], v8 offset:24576
    v_mfma_f32_16x16x32_bf16 v[84:87], v[204:207], v[60:63], v[84:87]
    ds_read_b64_tr_b16 v[202:203], v8 offset:28672
    s_waitcnt lgkmcnt(10)
    v_mfma_f32_16x16x32_bf16 v[88:91], v[208:211], v[56:59], v[88:91]
    ds_read_b64_tr_b16 v[204:205], v9 offset:24576
    v_mfma_f32_16x16x32_bf16 v[92:95], v[208:211], v[60:63], v[92:95]
    ds_read_b64_tr_b16 v[206:207], v9 offset:28672
    v_mfma_f32_16x16x32_bf16 v[96:99], v[212:215], v[56:59], v[96:99]
    ds_read_b64_tr_b16 v[208:209], v10 offset:24576
    v_mfma_f32_16x16x32_bf16 v[100:103], v[212:215], v[60:63], v[100:103]
    ds_read_b64_tr_b16 v[210:211], v10 offset:28672
    s_waitcnt lgkmcnt(10)
    v_mfma_f32_16x16x32_bf16 v[104:107], v[216:219], v[56:59], v[104:107]
    ds_read_b64_tr_b16 v[212:213], v11 offset:24576
    v_mfma_f32_16x16x32_bf16 v[108:111], v[216:219], v[60:63], v[108:111]
    ds_read_b64_tr_b16 v[214:215], v11 offset:28672
    v_mfma_f32_16x16x32_bf16 v[112:115], v[220:223], v[56:59], v[112:115]
    ds_read_b64_tr_b16 v[216:217], v12 offset:24576
    v_mfma_f32_16x16x32_bf16 v[116:119], v[220:223], v[60:63], v[116:119]
    ds_read_b64_tr_b16 v[218:219], v12 offset:28672
    s_waitcnt lgkmcnt(10)
    v_mfma_f32_16x16x32_bf16 v[120:123], v[224:227], v[56:59], v[120:123]
    ds_read_b64_tr_b16 v[220:221], v13 offset:24576
    v_mfma_f32_16x16x32_bf16 v[124:127], v[224:227], v[60:63], v[124:127]
    ds_read_b64_tr_b16 v[222:223], v13 offset:28672
    v_mfma_f32_16x16x32_bf16 v[128:131], v[228:231], v[56:59], v[128:131]
    ds_read_b64_tr_b16 v[224:225], v14 offset:24576
    v_mfma_f32_16x16x32_bf16 v[132:135], v[228:231], v[60:63], v[132:135]
    ds_read_b64_tr_b16 v[226:227], v14 offset:28672
    s_waitcnt lgkmcnt(10)
    v_mfma_f32_16x16x32_bf16 v[72:75], v[200:203], v[64:67], v[72:75]
    ds_read_b64_tr_b16 v[228:229], v15 offset:24576
    v_mfma_f32_16x16x32_bf16 v[76:79], v[200:203], v[68:71], v[76:79]
    ds_read_b64_tr_b16 v[230:231], v15 offset:28672
    v_mfma_f32_16x16x32_bf16 v[80:83], v[204:207], v[64:67], v[80:83]
    v_mfma_f32_16x16x32_bf16 v[84:87], v[204:207], v[68:71], v[84:87]
    s_waitcnt lgkmcnt(8)
    v_mfma_f32_16x16x32_bf16 v[88:91], v[208:211], v[64:67], v[88:91]
    v_mfma_f32_16x16x32_bf16 v[92:95], v[208:211], v[68:71], v[92:95]
    v_mfma_f32_16x16x32_bf16 v[96:99], v[212:215], v[64:67], v[96:99]
    v_mfma_f32_16x16x32_bf16 v[100:103], v[212:215], v[68:71], v[100:103]
    s_waitcnt lgkmcnt(4)
    v_mfma_f32_16x16x32_bf16 v[104:107], v[216:219], v[64:67], v[104:107]
    v_mfma_f32_16x16x32_bf16 v[108:111], v[216:219], v[68:71], v[108:111]
    v_mfma_f32_16x16x32_bf16 v[112:115], v[220:223], v[64:67], v[112:115]
    v_mfma_f32_16x16x32_bf16 v[116:119], v[220:223], v[68:71], v[116:119]
    s_waitcnt lgkmcnt(0)
    v_mfma_f32_16x16x32_bf16 v[120:123], v[224:227], v[64:67], v[120:123]
    v_mfma_f32_16x16x32_bf16 v[124:127], v[224:227], v[68:71], v[124:127]
    v_mfma_f32_16x16x32_bf16 v[128:131], v[228:231], v[64:67], v[128:131]
    v_mfma_f32_16x16x32_bf16 v[132:135], v[228:231], v[68:71], v[132:135]
    s_setprio 3
    s_waitcnt vmcnt(8)
    v_mov_b32 v244, v244
    s_mov_b32 s96, 200000
L_xc:
    v_xor_b32 v245, s93, v245
    v_xor_b32 v244, s92, v244
    v_and_b32 v246, 0x0fffffff, v245
    v_or_b32 v244, v244, v246
    v_cmp_ne_u32 s[28:29], 0, v244
    s_nop 1
    s_cmp_eq_u64 s[28:29], 0
    s_cbranch_scc1 L_xcok
    s_sub_u32 s96, s96, 1
    s_cbranch_scc1 L_xcok
    v_lshrrev_b32 v3, 1, v2
    v_and_b32 v3, 24, v3
    buffer_load_dwordx2 v[244:245], v3, s[68:71], s99 offen offset:96 sc1
    s_waitcnt vmcnt(0)
    s_branch L_xc
L_xcok:
    v_cmp_ne_u32 s[28:29], s35, v245
    s_nop 1
    s_cmp_eq_u64 s[28:29], 0
    s_cselect_b32 s34, 0, 8388608
    s_lshl_b32 s11, s4, 4
    v_mov_b32 v244, s92
    v_mov_b32 v245, s93
    v_mov_b32 v246, s34
    v_mov_b32 v247, 0
    v_mov_b32 v3, s11
    ds_write_b128 v3, v[244:247]
    s_mov_b32 s96, 200000
    v_lshrrev_b32 v38, 4, v2
    v_bfe_u32 v3, v38, 4, 1
    v_lshlrev_b32 v3, 1, v3
    v_bfe_u32 v39, v38, 5, 1
    v_or_b32 v3, v3, v39
    v_and_b32 v39, 15, v38
    v_xor_b32 v3, v3, v39
    v_lshlrev_b32 v39, 8, v39
    v_lshl_add_u32 v3, v3, 4, v39
    v_add_u32 v4, 98304, v3
    v_xor_b32 v5, 64, v4
    v_xor_b32 v6, 128, v4
    v_xor_b32 v7, 192, v4
    s_branch L_qepi
L_lo0:
    s_getpc_b64 s[42:43]
L_pc:
    s_bfe_u32 s11, s2, 0x40003
    s_lshl_b32 s11, s11, 2
    s_add_u32 s11, s11, s4
    s_lshl_b32 s11, s11, 10
    v_lshl_add_u32 v3, v2, 4, s11
    s_sub_u32 s42, s42, L_pc-L_start
    s_subb_u32 s43, s43, 0
    v_min_u32 v3, L_codeend-L_start-16, v3
    global_load_dwordx4 v[40:43], v3, s[42:43]
    v_lshrrev_b32 v38, 4, v2
    v_bfe_u32 v39, v2, 1, 3
    v_xor_b32 v38, v38, v39
    v_and_b32 v39, 15, v2
    v_lshlrev_b32 v39, 7, v39
    v_lshl_add_u32 v39, v38, 4, v39
    v_add_u32 v248, s77, v39
    v_xor_b32 v249, 64, v248
    v_add_u32 v248, 0, v248
    v_add_u32 v249, 0, v249
    v_lshrrev_b32 v38, 2, v2
    v_and_b32 v39, 7, v38
    v_lshlrev_b32 v38, 8, v38
    v_lshl_add_u32 v38, v39, 5, v38
    v_and_b32 v39, 3, v2
    v_lshl_add_u32 v38, v39, 3, v38
    v_add_u32 v8, 0, v38
    v_xor_b32 v9, 32, v8
    v_xor_b32 v10, 64, v8
    v_xor_b32 v11, 96, v8
    v_xor_b32 v12, 128, v8
    v_xor_b32 v13, 160, v8
    v_xor_b32 v14, 192, v8
    v_xor_b32 v15, 224, v8
    v_bfe_u32 v38, v2, 4, 1
    v_lshlrev_b32 v38, 1, v38
    v_bfe_u32 v39, v2, 5, 1
    v_or_b32 v38, v38, v39
    v_and_b32 v39, 15, v2
    v_xor_b32 v38, v38, v39
    v_lshlrev_b32 v39, 8, v39
    v_lshl_add_u32 v38, v38, 4, v39
    v_add_u32 v4, 131072, v38
    v_xor_b32 v5, 64, v4
    v_xor_b32 v6, 128, v4
    v_xor_b32 v7, 192, v4
    v_lshlrev_b32 v2, 4, v2
    s_waitcnt lgkmcnt(0)
    s_cmp_eq_u32 s9, 0
    s_cselect_b32 s48, s18, s28
    s_cselect_b32 s49, s19, s29
    s_mov_b32 s50, 33554432
    s_mov_b32 s51, 0x20000
    s_cselect_b32 s52, s20, s30
    s_cselect_b32 s53, s21, s31
    s_mov_b32 s54, 33554432
    s_mov_b32 s55, 0x20000
    s_cselect_b32 s60, s24, s34
    s_cselect_b32 s61, s25, s35
    s_mov_b32 s62, 4718592
    s_mov_b32 s63, 0x20000
    s_mov_b32 s64, s36
    s_mov_b32 s65, s37
    s_mov_b32 s66, 2359296
    s_mov_b32 s67, 0x20000
    s_mov_b32 s68, s40
    s_mov_b32 s69, s41
    s_mov_b32 s70, 268435456
    s_mov_b32 s71, 0x20000
    s_mov_b32 s72, s38
    s_mov_b32 s73, s39
    s_mov_b32 s74, 256
    s_mov_b32 s75, 0x20000
    s_lshl_b32 s11, s8, 2
    s_add_u32 s11, s11, s6
    s_lshl_b32 s11, s11, 18
    s_lshl_b32 s10, s7, 22
    s_add_u32 s10, s10, s11
    s_add_u32 s10, s10, s76
    s_lshl_b32 s94, s9, 3
    s_add_u32 s94, s94, s7
    s_lshl_b32 s11, s94, 2
    s_add_u32 s11, s11, s8
    s_lshl_b32 s98, s11, 18
    s_add_u32 s98, s98, s76
    s_and_b32 s98, s2, 7
    s_lshl_b32 s98, s98, 3
    s_add_u32 s98, s98, s7
    s_lshl_b32 s98, s98, 17
    s_add_u32 s98, s98, s76
    s_lshl_b32 s99, s11, 2
    s_add_u32 s99, s99, s4
    s_lshl_b32 s99, s99, 7
    s_add_u32 s99, s99, 67108864
    s_and_b32 s40, s7, 1
    s_add_u32 s11, s7, s6
    s_xor_b32 s12, s11, 0
    s_and_b32 s12, s12, 3
    s_lshl_b32 s12, s12, 15
    s_add_u32 s30, s10, s12
    s_xor_b32 s12, s11, 1
    s_and_b32 s12, s12, 3
    s_lshl_b32 s12, s12, 15
    s_add_u32 s31, s10, s12
    s_xor_b32 s12, s11, 2
    s_and_b32 s12, s12, 3
    s_lshl_b32 s12, s12, 15
    s_add_u32 s32, s10, s12
    s_xor_b32 s12, s11, 3
    s_and_b32 s12, s12, 3
    s_lshl_b32 s12, s12, 15
    s_add_u32 s33, s10, s12
    s_or_b32 s11, s8, s6
    s_or_b32 s11, s11, s4
    s_cmp_lg_u32 s11, 0
    s_cbranch_scc1 L_nonw
    s_memrealtime s[92:93]
    s_lshl_b32 s11, s94, 3
    s_waitcnt lgkmcnt(0)
    s_or_b32 s92, s92, 1
    v_mov_b32 v38, s92
    v_mov_b32 v39, s93
    s_mov_b64 exec, 1
    buffer_store_dwordx2 v[38:39], off, s[72:75], s11 sc1
    s_mov_b64 exec, -1
L_nonw:
    s_lshl_b32 s41, s94, 2
    s_add_u32 s41, s41, s6
    s_lshl_b32 s41, s41, 2
    s_add_u32 s41, s41, s4
    s_lshl_b32 s41, s41, 8
    s_add_u32 s41, s41, 68157440
    v_mov_b32 v136, 0
    v_mov_b32 v137, 0
    v_mov_b32 v138, 0
    v_mov_b32 v139, 0
    v_mov_b32 v140, 0
    v_mov_b32 v141, 0
    v_mov_b32 v142, 0
    v_mov_b32 v143, 0
    v_mov_b32 v144, 0
    v_mov_b32 v145, 0
    v_mov_b32 v146, 0
    v_mov_b32 v147, 0
    v_mov_b32 v148, 0
    v_mov_b32 v149, 0
    v_mov_b32 v150, 0
    v_mov_b32 v151, 0
    v_mov_b32 v152, 0
    v_mov_b32 v153, 0
    v_mov_b32 v154, 0
    v_mov_b32 v155, 0
    v_mov_b32 v156, 0
    v_mov_b32 v157, 0
    v_mov_b32 v158, 0
    v_mov_b32 v159, 0
    v_mov_b32 v160, 0
    v_mov_b32 v161, 0
    v_mov_b32 v162, 0
    v_mov_b32 v163, 0
    v_mov_b32 v164, 0
    v_mov_b32 v165, 0
    v_mov_b32 v166, 0
    v_mov_b32 v167, 0
    v_mov_b32 v168, 0
    v_mov_b32 v169, 0
    v_mov_b32 v170, 0
    v_mov_b32 v171, 0
    v_mov_b32 v172, 0
    v_mov_b32 v173, 0
    v_mov_b32 v174, 0
    v_mov_b32 v175, 0
    v_mov_b32 v176, 0
    v_mov_b32 v177, 0
    v_mov_b32 v178, 0
    v_mov_b32 v179, 0
    v_mov_b32 v180, 0
    v_mov_b32 v181, 0
    v_mov_b32 v182, 0
    v_mov_b32 v183, 0
    v_mov_b32 v184, 0
    v_mov_b32 v185, 0
    v_mov_b32 v186, 0
    v_mov_b32 v187, 0
    v_mov_b32 v188, 0
    v_mov_b32 v189, 0
    v_mov_b32 v190, 0
    v_mov_b32 v191, 0
    v_mov_b32 v192, 0
    v_mov_b32 v193, 0
    v_mov_b32 v194, 0
    v_mov_b32 v195, 0
    v_mov_b32 v196, 0
    v_mov_b32 v197, 0
    v_mov_b32 v198, 0
    v_mov_b32 v199, 0
    v_mov_b32 v24, 0
    v_mov_b32 v25, 0
    v_mov_b32 v26, 0
    v_mov_b32 v27, 0
    v_mov_b32 v28, 0
    v_mov_b32 v29, 0
    v_mov_b32 v30, 0
    v_mov_b32 v31, 0
    v_mov_b32 v32, 0x3f803f80
    v_mov_b32 v33, 0x3f803f80
    v_mov_b32 v34, 0x3f803f80
    v_mov_b32 v35, 0x3f803f80
    v_mov_b32 v72, 0
    v_mov_b32 v73, 0
    v_mov_b32 v74, 0
    v_mov_b32 v75, 0
    v_mov_b32 v76, 0
    v_mov_b32 v77, 0
    v_mov_b32 v78, 0
    v_mov_b32 v79, 0
    v_mov_b32 v80, 0
    v_mov_b32 v81, 0
    v_mov_b32 v82, 0
    v_mov_b32 v83, 0
    v_mov_b32 v84, 0
    v_mov_b32 v85, 0
    v_mov_b32 v86, 0
    v_mov_b32 v87, 0
    v_mov_b32 v88, 0
    v_mov_b32 v89, 0
    v_mov_b32 v90, 0
    v_mov_b32 v91, 0
    v_mov_b32 v92, 0
    v_mov_b32 v93, 0
    v_mov_b32 v94, 0
    v_mov_b32 v95, 0
    v_mov_b32 v96, 0
    v_mov_b32 v97, 0
    v_mov_b32 v98, 0
    v_mov_b32 v99, 0
    v_mov_b32 v100, 0
    v_mov_b32 v101, 0
    v_mov_b32 v102, 0
    v_mov_b32 v103, 0
    v_mov_b32 v104, 0
    v_mov_b32 v105, 0
    v_mov_b32 v106, 0
    v_mov_b32 v107, 0
    v_mov_b32 v108, 0
    v_mov_b32 v109, 0
    v_mov_b32 v110, 0
    v_mov_b32 v111, 0
    v_mov_b32 v112, 0
    v_mov_b32 v113, 0
    v_mov_b32 v114, 0
    v_mov_b32 v115, 0
    v_mov_b32 v116, 0
    v_mov_b32 v117, 0
    v_mov_b32 v118, 0
    v_mov_b32 v119, 0
    v_mov_b32 v120, 0
    v_mov_b32 v121, 0
    v_mov_b32 v122, 0
    v_mov_b32 v123, 0
    v_mov_b32 v124, 0
    v_mov_b32 v125, 0
    v_mov_b32 v126, 0
    v_mov_b32 v127, 0
    v_mov_b32 v128, 0
    v_mov_b32 v129, 0
    v_mov_b32 v130, 0
    v_mov_b32 v131, 0
    v_mov_b32 v132, 0
    v_mov_b32 v133, 0
    v_mov_b32 v134, 0
    v_mov_b32 v135, 0
    s_mov_b32 s16, 98304
    s_mov_b32 s17, 4294901760
    s_mov_b32 s18, 4294934528
    s_mov_b32 s15, 0
    s_mov_b32 s95, 0xf2ff2f
    s_setprio 1
    s_waitcnt vmcnt(0) lgkmcnt(0)
    s_barrier
    s_cmp_lg_u32 s4, s8
    s_cbranch_scc1 L_hw
    v_lshrrev_b32 v44, 3, v2
    v_and_b32 v44, 124, v44
    buffer_store_dword v136, v44, s[68:71], s41 offen sc1
L_hw:
    s_lshl_b32 s11, s8, 4
    s_add_u32 s41, s41, s11
    ds_read_b128 v[232:235], v248 offset:0
    ds_read_b128 v[236:239], v248 offset:2048
    ds_read_b64_tr_b16 v[200:201], v8 offset:16384
    ds_read_b64_tr_b16 v[202:203], v8 offset:20480
    ds_read_b64_tr_b16 v[204:205], v9 offset:16384
    ds_read_b64_tr_b16 v[206:207], v9 offset:20480
    ds_read_b64_tr_b16 v[208:209], v10 offset:16384
    ds_read_b64_tr_b16 v[210:211], v10 offset:20480
    ds_read_b64_tr_b16 v[212:213], v11 offset:16384
    ds_read_b64_tr_b16 v[214:215], v11 offset:20480
    ds_read_b64_tr_b16 v[216:217], v12 offset:16384
    ds_read_b64_tr_b16 v[218:219], v12 offset:20480
    ds_read_b64_tr_b16 v[220:221], v13 offset:16384
    ds_read_b64_tr_b16 v[222:223], v13 offset:20480
    ds_read_b64_tr_b16 v[224:225], v14 offset:16384
    ds_read_b64_tr_b16 v[226:227], v14 offset:20480
L_q1:
    s_waitcnt lgkmcnt(10)
    v_mfma_f32_16x16x32_bf16 v[72:75], v[200:203], v[232:235], v[72:75]
    ds_read_b64_tr_b16 v[228:229], v15 offset:16384
    s_cmp_eq_u32 s15, 8
    s_cselect_b32 s11, 32768, s16
    v_mfma_f32_16x16x32_bf16 v[76:79], v[200:203], v[236:239], v[76:79]
    ds_read_b64_tr_b16 v[230:231], v15 offset:20480
    v_mfma_f32_16x16x32_bf16 v[80:83], v[204:207], v[232:235], v[80:83]
    ds_read_b64_tr_b16 v[200:201], v8 offset:24576
    ds_read_b128 v[240:243], v249 offset:0
    v_mfma_f32_16x16x32_bf16 v[84:87], v[204:207], v[236:239], v[84:87]
    ds_read_b64_tr_b16 v[202:203], v8 offset:28672
    s_waitcnt lgkmcnt(11)
    v_mfma_f32_16x16x32_bf16 v[88:91], v[208:211], v[232:235], v[88:91]
    ds_read_b64_tr_b16 v[204:205], v9 offset:24576
    ds_read_b128 v[244:247], v249 offset:2048
    v_add_u32 v8, s11, v8
    v_mfma_f32_16x16x32_bf16 v[92:95], v[208:211], v[236:239], v[92:95]
    ds_read_b64_tr_b16 v[206:207], v9 offset:28672
    v_mfma_f32_16x16x32_bf16 v[96:99], v[212:215], v[232:235], v[96:99]
    ds_read_b64_tr_b16 v[208:209], v10 offset:24576
    v_add_u32 v9, s11, v9
    v_mfma_f32_16x16x32_bf16 v[100:103], v[212:215], v[236:239], v[100:103]
    ds_read_b64_tr_b16 v[210:211], v10 offset:28672
    s_waitcnt lgkmcnt(12)
    v_mfma_f32_16x16x32_bf16 v[104:107], v[216:219], v[232:235], v[104:107]
    ds_read_b64_tr_b16 v[212:213], v11 offset:24576
    v_add_u32 v10, s11, v10
    v_mfma_f32_16x16x32_bf16 v[108:111], v[216:219], v[236:239], v[108:111]
    ds_read_b64_tr_b16 v[214:215], v11 offset:28672
    v_mfma_f32_16x16x32_bf16 v[112:115], v[220:223], v[232:235], v[112:115]
    ds_read_b64_tr_b16 v[216:217], v12 offset:24576
    v_add_u32 v11, s11, v11
    v_mfma_f32_16x16x32_bf16 v[116:119], v[220:223], v[236:239], v[116:119]
    ds_read_b64_tr_b16 v[218:219], v12 offset:28672
    s_waitcnt lgkmcnt(12)
    v_mfma_f32_16x16x32_bf16 v[120:123], v[224:227], v[232:235], v[120:123]
    ds_read_b64_tr_b16 v[220:221], v13 offset:24576
    v_add_u32 v12, s11, v12
    v_mfma_f32_16x16x32_bf16 v[124:127], v[224:227], v[236:239], v[124:127]
    ds_read_b64_tr_b16 v[222:223], v13 offset:28672
    v_mfma_f32_16x16x32_bf16 v[128:131], v[228:231], v[232:235], v[128:131]
    ds_read_b64_tr_b16 v[224:225], v14 offset:24576
    v_add_u32 v13, s11, v13
    v_mfma_f32_16x16x32_bf16 v[132:135], v[228:231], v[236:239], v[132:135]
    ds_read_b64_tr_b16 v[226:227], v14 offset:28672
    s_waitcnt lgkmcnt(10)
    v_mfma_f32_16x16x32_bf16 v[72:75], v[200:203], v[240:243], v[72:75]
    ds_read_b64_tr_b16 v[228:229], v15 offset:24576
    v_add_u32 v14, s11, v14
    v_mfma_f32_16x16x32_bf16 v[76:79], v[200:203], v[244:247], v[76:79]
    ds_read_b64_tr_b16 v[230:231], v15 offset:28672
    v_mfma_f32_16x16x32_bf16 v[80:83], v[204:207], v[240:243], v[80:83]
    v_add_u32 v15, s11, v15
    v_add_u32 v248, s11, v248
    v_add_u32 v249, s11, v249
    v_mfma_f32_16x16x32_bf16 v[84:87], v[204:207], v[244:247], v[84:87]
    s_waitcnt lgkmcnt(8)
    v_mfma_f32_16x16x32_bf16 v[88:91], v[208:211], v[240:243], v[88:91]
    s_mov_b32 s12, s16
    s_mov_b32 s16, s17
    s_mov_b32 s17, s18
    v_mfma_f32_16x16x32_bf16 v[92:95], v[208:211], v[244:247], v[92:95]
    v_mfma_f32_16x16x32_bf16 v[96:99], v[212:215], v[240:243], v[96:99]
    s_mov_b32 s18, s12
    s_add_u32 s15, s15, 1
    v_mfma_f32_16x16x32_bf16 v[100:103], v[212:215], v[244:247], v[100:103]
    s_waitcnt lgkmcnt(0)
    s_cmp_eq_u32 s15, 9
    s_cbranch_scc1 L_q1s
    s_waitcnt lgkmcnt(0)
    s_barrier
L_q1s:
    ds_read_b128 v[232:235], v248 offset:0
    ds_read_b128 v[236:239], v248 offset:2048
    ds_read_b64_tr_b16 v[200:201], v8 offset:16384
    ds_read_b64_tr_b16 v[202:203], v8 offset:20480
    ds_read_b64_tr_b16 v[204:205], v9 offset:16384
    ds_read_b64_tr_b16 v[206:207], v9 offset:20480
    ds_read_b64_tr_b16 v[208:209], v10 offset:16384
    ds_read_b64_tr_b16 v[210:211], v10 offset:20480
    v_mfma_f32_16x16x32_bf16 v[104:107], v[216:219], v[240:243], v[104:107]
    ds_read_b64_tr_b16 v[212:213], v11 offset:16384
    v_mfma_f32_16x16x32_bf16 v[108:111], v[216:219], v[244:247], v[108:111]
    ds_read_b64_tr_b16 v[214:215], v11 offset:20480
    v_mfma_f32_16x16x32_bf16 v[112:115], v[220:223], v[240:243], v[112:115]
    ds_read_b64_tr_b16 v[216:217], v12 offset:16384
    v_mfma_f32_16x16x32_bf16 v[116:119], v[220:223], v[244:247], v[116:119]
    ds_read_b64_tr_b16 v[218:219], v12 offset:20480
    v_mfma_f32_16x16x32_bf16 v[120:123], v[224:227], v[240:243], v[120:123]
    ds_read_b64_tr_b16 v[220:221], v13 offset:16384
    v_mfma_f32_16x16x32_bf16 v[124:127], v[224:227], v[244:247], v[124:127]
    ds_read_b64_tr_b16 v[222:223], v13 offset:20480
    v_mfma_f32_16x16x32_bf16 v[128:131], v[228:231], v[240:243], v[128:131]
    ds_read_b64_tr_b16 v[224:225], v14 offset:16384
    s_cmp_lt_u32 s15, 9
    v_mfma_f32_16x16x32_bf16 v[132:135], v[228:231], v[244:247], v[132:135]
    ds_read_b64_tr_b16 v[226:227], v14 offset:20480
    s_cbranch_scc1 L_q1
L_qepi:
    s_setprio 2
    s_nop 7
    s_mov_b32 s14, 0x3e0293ee
    v_mul_f32 v72, s14, v72
    v_mul_f32 v73, s14, v73
    v_mul_f32 v74, s14, v74
    v_mul_f32 v75, s14, v75
    v_mul_f32 v80, s14, v80
    v_mul_f32 v81, s14, v81
    v_mul_f32 v82, s14, v82
    v_mul_f32 v83, s14, v83
    v_cvt_pk_bf16_f32 v40, v72, v73
    v_cvt_pk_bf16_f32 v41, v74, v75
    v_cvt_pk_bf16_f32 v42, v80, v81
    v_cvt_pk_bf16_f32 v43, v82, v83
    v_mul_f32 v76, s14, v76
    v_mul_f32 v77, s14, v77
    v_mul_f32 v78, s14, v78
    v_mul_f32 v79, s14, v79
    v_mul_f32 v84, s14, v84
    v_mul_f32 v85, s14, v85
    v_mul_f32 v86, s14, v86
    v_mul_f32 v87, s14, v87
    v_cvt_pk_bf16_f32 v44, v76, v77
    v_cvt_pk_bf16_f32 v45, v78, v79
    v_cvt_pk_bf16_f32 v46, v84, v85
    v_cvt_pk_bf16_f32 v47, v86, v87
    v_mul_f32 v88, s14, v88
    v_mul_f32 v89, s14, v89
    v_mul_f32 v90, s14, v90
    v_mul_f32 v91, s14, v91
    v_mul_f32 v96, s14, v96
    v_mul_f32 v97, s14, v97
    v_mul_f32 v98, s14, v98
    v_mul_f32 v99, s14, v99
    v_cvt_pk_bf16_f32 v48, v88, v89
    v_cvt_pk_bf16_f32 v49, v90, v91
    v_cvt_pk_bf16_f32 v50, v96, v97
    v_cvt_pk_bf16_f32 v51, v98, v99
    v_mul_f32 v92, s14, v92
    v_mul_f32 v93, s14, v93
    v_mul_f32 v94, s14, v94
    v_mul_f32 v95, s14, v95
    v_mul_f32 v100, s14, v100
    v_mul_f32 v101, s14, v101
    v_mul_f32 v102, s14, v102
    v_mul_f32 v103, s14, v103
    v_cvt_pk_bf16_f32 v52, v92, v93
    v_cvt_pk_bf16_f32 v53, v94, v95
    v_cvt_pk_bf16_f32 v54, v100, v101
    v_cvt_pk_bf16_f32 v55, v102, v103
    v_mul_f32 v104, s14, v104
    v_mul_f32 v105, s14, v105
    v_mul_f32 v106, s14, v106
    v_mul_f32 v107, s14, v107
    v_mul_f32 v112, s14, v112
    v_mul_f32 v113, s14, v113
    v_mul_f32 v114, s14, v114
    v_mul_f32 v115, s14, v115
    v_cvt_pk_bf16_f32 v56, v104, v105
    v_cvt_pk_bf16_f32 v57, v106, v107
    v_cvt_pk_bf16_f32 v58, v112, v113
    v_cvt_pk_bf16_f32 v59, v114, v115
    v_mul_f32 v108, s14, v108
    v_mul_f32 v109, s14, v109
    v_mul_f32 v110, s14, v110
    v_mul_f32 v111, s14, v111
    v_mul_f32 v116, s14, v116
    v_mul_f32 v117, s14, v117
    v_mul_f32 v118, s14, v118
    v_mul_f32 v119, s14, v119
    v_cvt_pk_bf16_f32 v60, v108, v109
    v_cvt_pk_bf16_f32 v61, v110, v111
    v_cvt_pk_bf16_f32 v62, v116, v117
    v_cvt_pk_bf16_f32 v63, v118, v119
    v_mul_f32 v120, s14, v120
    v_mul_f32 v121, s14, v121
    v_mul_f32 v122, s14, v122
    v_mul_f32 v123, s14, v123
    v_mul_f32 v128, s14, v128
    v_mul_f32 v129, s14, v129
    v_mul_f32 v130, s14, v130
    v_mul_f32 v131, s14, v131
    v_cvt_pk_bf16_f32 v64, v120, v121
    v_cvt_pk_bf16_f32 v65, v122, v123
    v_cvt_pk_bf16_f32 v66, v128, v129
    v_cvt_pk_bf16_f32 v67, v130, v131
    v_mul_f32 v124, s14, v124
    v_mul_f32 v125, s14, v125
    v_mul_f32 v126, s14, v126
    v_mul_f32 v127, s14, v127
    v_mul_f32 v132, s14, v132
    v_mul_f32 v133, s14, v133
    v_mul_f32 v134, s14, v134
    v_mul_f32 v135, s14, v135
    v_cvt_pk_bf16_f32 v68, v124, v125
    v_cvt_pk_bf16_f32 v69, v126, v127
    v_cvt_pk_bf16_f32 v70, v132, v133
    v_cvt_pk_bf16_f32 v71, v134, v135
    s_waitcnt vmcnt(18) lgkmcnt(0)
    s_barrier
L_qk:
    ds_read_b128 v[200:203], v4 offset:0
    ds_read_b128 v[204:207], v5 offset:0
    ds_read_b128 v[208:211], v6 offset:0
    ds_read_b128 v[212:215], v7 offset:0
    ds_read_b128 v[216:219], v4 offset:4096
    ds_read_b128 v[220:223], v5 offset:4096
    ds_read_b128 v[224:227], v6 offset:4096
    ds_read_b128 v[228:231], v7 offset:4096
    v_permlane16_swap_b32 v40, v42
    v_permlane16_swap_b32 v41, v43
    v_permlane16_swap_b32 v44, v46
    v_permlane16_swap_b32 v45, v47
    v_permlane16_swap_b32 v48, v50
    v_permlane16_swap_b32 v49, v51
    v_permlane16_swap_b32 v52, v54
    v_permlane16_swap_b32 v53, v55
    v_permlane16_swap_b32 v56, v58
    v_permlane16_swap_b32 v57, v59
    v_permlane16_swap_b32 v60, v62
    v_permlane16_swap_b32 v61, v63
    v_permlane16_swap_b32 v64, v66
    v_permlane16_swap_b32 v65, v67
    v_permlane16_swap_b32 v68, v70
    v_permlane16_swap_b32 v69, v71
    s_waitcnt lgkmcnt(7)
    v_mfma_f32_16x16x32_bf16 v[72:75], v[200:203], v[40:43], 0
    v_mfma_f32_16x16x32_bf16 v[80:83], v[200:203], v[44:47], 0
    s_waitcnt lgkmcnt(6)
    v_mfma_f32_16x16x32_bf16 v[72:75], v[204:207], v[48:51], v[72:75]
    v_mfma_f32_16x16x32_bf16 v[80:83], v[204:207], v[52:55], v[80:83]
    s_waitcnt lgkmcnt(5)
    v_mfma_f32_16x16x32_bf16 v[72:75], v[208:211], v[56:59], v[72:75]
    v_mfma_f32_16x16x32_bf16 v[80:83], v[208:211], v[60:63], v[80:83]
    s_waitcnt lgkmcnt(4)
    v_mfma_f32_16x16x32_bf16 v[72:75], v[212:215], v[64:67], v[72:75]
    v_mfma_f32_16x16x32_bf16 v[80:83], v[212:215], v[68:71], v[80:83]
    s_waitcnt lgkmcnt(3)
    v_mfma_f32_16x16x32_bf16 v[76:79], v[216:219], v[40:43], 0
    v_mfma_f32_16x16x32_bf16 v[84:87], v[216:219], v[44:47], 0
    s_waitcnt lgkmcnt(2)
    v_mfma_f32_16x16x32_bf16 v[76:79], v[220:223], v[48:51], v[76:79]
    v_mfma_f32_16x16x32_bf16 v[84:87], v[220:223], v[52:55], v[84:87]
    s_waitcnt lgkmcnt(1)
    v_mfma_f32_16x16x32_bf16 v[76:79], v[224:227], v[56:59], v[76:79]
    v_mfma_f32_16x16x32_bf16 v[84:87], v[224:227], v[60:63], v[84:87]
    s_waitcnt lgkmcnt(0)
    v_mfma_f32_16x16x32_bf16 v[76:79], v[228:231], v[64:67], v[76:79]
    v_mfma_f32_16x16x32_bf16 v[84:87], v[228:231], v[68:71], v[84:87]
    v_max_f32 v36, v72, v73
    v_max_f32 v37, v80, v81
    v_max3_f32 v36, v74, v75, v36
    v_max3_f32 v37, v82, v83, v37
    s_nop 2
    v_max3_f32 v36, v76, v77, v36
    v_max3_f32 v37, v84, v85, v37
    v_max3_f32 v36, v78, v79, v36
    v_max3_f32 v37, v86, v87, v37
    v_mov_b32 v38, v36
    v_mov_b32 v39, v37
    s_nop 0
    v_permlane16_swap_b32 v36, v38
    v_permlane16_swap_b32 v37, v39
    v_max_f32 v36, v36, v38
    v_max_f32 v37, v37, v39
    v_mov_b32 v38, v36
    v_mov_b32 v39, v37
    s_nop 0
    v_permlane32_swap_b32 v36, v38
    v_permlane32_swap_b32 v37, v39
    v_max_f32 v36, v36, v38
    v_max_f32 v37, v37, v39
    s_mov_b32 s14, 0xc1800000
    v_sub_f32 v16, s14, v36
    v_sub_f32 v17, s14, v36
    v_sub_f32 v18, s14, v36
    v_sub_f32 v19, s14, v36
    v_sub_f32 v20, s14, v37
    v_sub_f32 v21, s14, v37
    v_sub_f32 v22, s14, v37
    v_sub_f32 v23, s14, v37
    s_mov_b32 s15, 0
    s_mov_b32 s27, -1
    s_cmp_eq_u32 s5, 1
    s_cbranch_scc1 L_k2
L_att:
    s_waitcnt lgkmcnt(5)
    v_mfma_f32_16x16x32_bf16 v[72:75], v[200:203], v[40:43], v[16:19]
    v_mfma_f32_16x16x32_bf16 v[80:83], v[200:203], v[44:47], v[20:23]
    ds_read_b128 v[228:231], v7 offset:4096
    v_mfma_f32_16x16x32_bf16 v[72:75], v[204:207], v[48:51], v[72:75]
    v_mfma_f32_16x16x32_bf16 v[80:83], v[204:207], v[52:55], v[80:83]
    ds_read_b128 v[200:203], v4 offset:8192
    s_waitcnt lgkmcnt(5)
    v_mfma_f32_16x16x32_bf16 v[72:75], v[208:211], v[56:59], v[72:75]
    v_mfma_f32_16x16x32_bf16 v[80:83], v[208:211], v[60:63], v[80:83]
    ds_read_b128 v[204:207], v5 offset:8192
    v_mfma_f32_16x16x32_bf16 v[72:75], v[212:215], v[64:67], v[72:75]
    v_mfma_f32_16x16x32_bf16 v[80:83], v[212:215], v[68:71], v[80:83]
    ds_read_b128 v[208:211], v6 offset:8192
    s_waitcnt lgkmcnt(5)
    v_mfma_f32_16x16x32_bf16 v[76:79], v[216:219], v[40:43], v[16:19]
    v_mfma_f32_16x16x32_bf16 v[84:87], v[216:219], v[44:47], v[20:23]
    ds_read_b128 v[212:215], v7 offset:8192
    v_mfma_f32_16x16x32_bf16 v[76:79], v[220:223], v[48:51], v[76:79]
    v_mfma_f32_16x16x32_bf16 v[84:87], v[220:223], v[52:55], v[84:87]
    ds_read_b128 v[216:219], v4 offset:12288
    s_waitcnt lgkmcnt(5)
    v_mfma_f32_16x16x32_bf16 v[76:79], v[224:227], v[56:59], v[76:79]
    v_mfma_f32_16x16x32_bf16 v[84:87], v[224:227], v[60:63], v[84:87]
    ds_read_b128 v[220:223], v5 offset:12288
    v_mfma_f32_16x16x32_bf16 v[76:79], v[228:231], v[64:67], v[76:79]
    v_mfma_f32_16x16x32_bf16 v[84:87], v[228:231], v[68:71], v[84:87]
    ds_read_b128 v[224:227], v6 offset:12288
    s_waitcnt lgkmcnt(5)
    v_mfma_f32_16x16x32_bf16 v[88:91], v[200:203], v[40:43], v[16:19]
    v_mfma_f32_16x16x32_bf16 v[96:99], v[200:203], v[44:47], v[20:23]
    ds_read_b128 v[228:231], v7 offset:12288
    v_mfma_f32_16x16x32_bf16 v[88:91], v[204:207], v[48:51], v[88:91]
    v_mfma_f32_16x16x32_bf16 v[96:99], v[204:207], v[52:55], v[96:99]
    ds_read_b128 v[200:203], v4 offset:16384
    s_waitcnt lgkmcnt(5)
    v_mfma_f32_16x16x32_bf16 v[88:91], v[208:211], v[56:59], v[88:91]
    v_max_f32 v36, v72, v73
    v_max_f32 v37, v80, v81
    v_max3_f32 v36, v74, v75, v36
    v_mfma_f32_16x16x32_bf16 v[96:99], v[208:211], v[60:63], v[96:99]
    ds_read_b128 v[204:207], v5 offset:16384
    v_max3_f32 v37, v82, v83, v37
    v_max3_f32 v36, v76, v77, v36
    v_mfma_f32_16x16x32_bf16 v[88:91], v[212:215], v[64:67], v[88:91]
    v_max3_f32 v37, v84, v85, v37
    v_max3_f32 v36, v78, v79, v36
    v_max3_f32 v37, v86, v87, v37
    v_mfma_f32_16x16x32_bf16 v[96:99], v[212:215], v[68:71], v[96:99]
    ds_read_b128 v[208:211], v6 offset:16384
    s_waitcnt lgkmcnt(5)
    v_mfma_f32_16x16x32_bf16 v[92:95], v[216:219], v[40:43], v[16:19]
    v_exp_f32 v72, v72
    v_mfma_f32_16x16x32_bf16 v[100:103], v[216:219], v[44:47], v[20:23]
    ds_read_b128 v[212:215], v7 offset:16384
    v_exp_f32 v73, v73
    v_mfma_f32_16x16x32_bf16 v[92:95], v[220:223], v[48:51], v[92:95]
    v_exp_f32 v74, v74
    v_mfma_f32_16x16x32_bf16 v[100:103], v[220:223], v[52:55], v[100:103]
    ds_read_b128 v[216:219], v4 offset:20480
    s_waitcnt lgkmcnt(5)
    v_mfma_f32_16x16x32_bf16 v[92:95], v[224:227], v[56:59], v[92:95]
    v_exp_f32 v75, v75
    v_mfma_f32_16x16x32_bf16 v[100:103], v[224:227], v[60:63], v[100:103]
    ds_read_b128 v[220:223], v5 offset:20480
    v_exp_f32 v76, v76
    v_mfma_f32_16x16x32_bf16 v[92:95], v[228:231], v[64:67], v[92:95]
    v_exp_f32 v77, v77
    v_mfma_f32_16x16x32_bf16 v[100:103], v[228:231], v[68:71], v[100:103]
    ds_read_b128 v[224:227], v6 offset:20480
    s_waitcnt lgkmcnt(5)
    v_mfma_f32_16x16x32_bf16 v[104:107], v[200:203], v[40:43], v[16:19]
    v_exp_f32 v78, v78
    v_mfma_f32_16x16x32_bf16 v[112:115], v[200:203], v[44:47], v[20:23]
    ds_read_b128 v[228:231], v7 offset:20480
    v_exp_f32 v79, v79
    v_mfma_f32_16x16x32_bf16 v[104:107], v[204:207], v[48:51], v[104:107]
    v_exp_f32 v80, v80
    v_mfma_f32_16x16x32_bf16 v[112:115], v[204:207], v[52:55], v[112:115]
    ds_read_b128 v[200:203], v4 offset:24576
    s_waitcnt lgkmcnt(5)
    v_mfma_f32_16x16x32_bf16 v[104:107], v[208:211], v[56:59], v[104:107]
    v_exp_f32 v81, v81
    v_cvt_pk_bf16_f32 v72, v72, v73
    v_mfma_f32_16x16x32_bf16 v[112:115], v[208:211], v[60:63], v[112:115]
    ds_read_b128 v[204:207], v5 offset:24576
    v_cvt_pk_bf16_f32 v73, v74, v75
    v_cvt_pk_bf16_f32 v74, v76, v77
    v_mfma_f32_16x16x32_bf16 v[104:107], v[212:215], v[64:67], v[104:107]
    v_cvt_pk_bf16_f32 v75, v78, v79
    v_exp_f32 v82, v82
    v_mfma_f32_16x16x32_bf16 v[112:115], v[212:215], v[68:71], v[112:115]
    ds_read_b128 v[208:211], v6 offset:24576
    s_waitcnt lgkmcnt(5)
    v_mfma_f32_16x16x32_bf16 v[108:111], v[216:219], v[40:43], v[16:19]
    v_exp_f32 v83, v83
    v_mfma_f32_16x16x32_bf16 v[116:119], v[216:219], v[44:47], v[20:23]
    ds_read_b128 v[212:215], v7 offset:24576
    v_exp_f32 v84, v84
    v_mfma_f32_16x16x32_bf16 v[108:111], v[220:223], v[48:51], v[108:111]
    v_exp_f32 v85, v85
    v_mfma_f32_16x16x32_bf16 v[116:119], v[220:223], v[52:55], v[116:119]
    ds_read_b128 v[216:219], v4 offset:28672
    s_waitcnt lgkmcnt(5)
    v_mfma_f32_16x16x32_bf16 v[108:111], v[224:227], v[56:59], v[108:111]
    v_exp_f32 v86, v86
    v_mfma_f32_16x16x32_bf16 v[116:119], v[224:227], v[60:63], v[116:119]
    ds_read_b128 v[220:223], v5 offset:28672
    v_exp_f32 v87, v87
    v_mfma_f32_16x16x32_bf16 v[108:111], v[228:231], v[64:67], v[108:111]
    v_cvt_pk_bf16_f32 v80, v80, v81
    v_cvt_pk_bf16_f32 v81, v82, v83
    v_cvt_pk_bf16_f32 v82, v84, v85
    v_mfma_f32_16x16x32_bf16 v[116:119], v[228:231], v[68:71], v[116:119]
    ds_read_b128 v[224:227], v6 offset:28672
    v_cvt_pk_bf16_f32 v83, v86, v87
    s_waitcnt lgkmcnt(5)
    v_mfma_f32_16x16x32_bf16 v[120:123], v[200:203], v[40:43], v[16:19]
    v_max3_f32 v36, v88, v89, v36
    v_max3_f32 v37, v96, v97, v37
    v_max3_f32 v36, v90, v91, v36
    v_mfma_f32_16x16x32_bf16 v[128:131], v[200:203], v[44:47], v[20:23]
    ds_read_b128 v[228:231], v7 offset:28672
    v_max3_f32 v37, v98, v99, v37
    v_max3_f32 v36, v92, v93, v36
    v_mfma_f32_16x16x32_bf16 v[120:123], v[204:207], v[48:51], v[120:123]
    v_max3_f32 v37, v100, v101, v37
    v_max3_f32 v36, v94, v95, v36
    v_max3_f32 v37, v102, v103, v37
    v_mfma_f32_16x16x32_bf16 v[128:131], v[204:207], v[52:55], v[128:131]
    v_exp_f32 v88, v88
    s_waitcnt lgkmcnt(4)
    v_mfma_f32_16x16x32_bf16 v[120:123], v[208:211], v[56:59], v[120:123]
    v_exp_f32 v89, v89
    v_mfma_f32_16x16x32_bf16 v[128:131], v[208:211], v[60:63], v[128:131]
    v_exp_f32 v90, v90
    v_mfma_f32_16x16x32_bf16 v[120:123], v[212:215], v[64:67], v[120:123]
    v_exp_f32 v91, v91
    v_max3_f32 v36, v104, v105, v36
    v_mfma_f32_16x16x32_bf16 v[128:131], v[212:215], v[68:71], v[128:131]
    v_max3_f32 v37, v112, v113, v37
    v_max3_f32 v36, v106, v107, v36
    s_waitcnt lgkmcnt(2)
    v_mfma_f32_16x16x32_bf16 v[124:127], v[216:219], v[40:43], v[16:19]
    v_max3_f32 v37, v114, v115, v37
    v_max3_f32 v36, v108, v109, v36
    v_max3_f32 v37, v116, v117, v37
    v_mfma_f32_16x16x32_bf16 v[132:135], v[216:219], v[44:47], v[20:23]
    v_max3_f32 v36, v110, v111, v36
    v_max3_f32 v37, v118, v119, v37
    v_mfma_f32_16x16x32_bf16 v[124:127], v[220:223], v[48:51], v[124:127]
    v_exp_f32 v92, v92
    v_mfma_f32_16x16x32_bf16 v[132:135], v[220:223], v[52:55], v[132:135]
    v_exp_f32 v93, v93
    s_waitcnt lgkmcnt(0)
    v_mfma_f32_16x16x32_bf16 v[124:127], v[224:227], v[56:59], v[124:127]
    v_exp_f32 v94, v94
    v_mfma_f32_16x16x32_bf16 v[132:135], v[224:227], v[60:63], v[132:135]
    v_exp_f32 v95, v95
    v_mfma_f32_16x16x32_bf16 v[124:127], v[228:231], v[64:67], v[124:127]
    v_exp_f32 v96, v96
    v_mfma_f32_16x16x32_bf16 v[132:135], v[228:231], v[68:71], v[132:135]
    v_exp_f32 v97, v97
    v_cvt_pk_bf16_f32 v88, v88, v89
    v_cvt_pk_bf16_f32 v89, v90, v91
    v_cvt_pk_bf16_f32 v90, v92, v93
    v_cvt_pk_bf16_f32 v91, v94, v95
    v_exp_f32 v98, v98
    v_exp_f32 v99, v99
    v_max3_f32 v36, v120, v121, v36
    v_max3_f32 v37, v128, v129, v37
    v_max3_f32 v36, v122, v123, v36
    v_max3_f32 v37, v130, v131, v37
    v_max3_f32 v36, v124, v125, v36
    v_max3_f32 v37, v132, v133, v37
    v_max3_f32 v36, v126, v127, v36
    v_max3_f32 v37, v134, v135, v37
    v_max_f32 v38, v36, v37
    v_cmp_lt_f32 vcc, 0, v38
    v_exp_f32 v100, v100
    v_exp_f32 v101, v101
    s_nop 1
    s_cbranch_vccnz L_redo
L_noredo:
    s_waitcnt lgkmcnt(0)
    s_barrier
    ds_read_b64_tr_b16 v[200:201], v8 offset:0
    ds_read_b64_tr_b16 v[202:203], v8 offset:4096
    ds_read_b64_tr_b16 v[204:205], v9 offset:0
    ds_read_b64_tr_b16 v[206:207], v9 offset:4096
    ds_read_b64_tr_b16 v[208:209], v10 offset:0
    ds_read_b64_tr_b16 v[210:211], v10 offset:4096
    ds_read_b64_tr_b16 v[212:213], v11 offset:0
    ds_read_b64_tr_b16 v[214:215], v11 offset:4096
    ds_read_b64_tr_b16 v[216:217], v12 offset:0
    ds_read_b64_tr_b16 v[218:219], v12 offset:4096
    ds_read_b64_tr_b16 v[220:221], v13 offset:0
    ds_read_b64_tr_b16 v[222:223], v13 offset:4096
    ds_read_b64_tr_b16 v[224:225], v14 offset:0
    ds_read_b64_tr_b16 v[226:227], v14 offset:4096
    v_exp_f32 v102, v102
    v_exp_f32 v103, v103
    v_cvt_pk_bf16_f32 v96, v96, v97
    v_cvt_pk_bf16_f32 v97, v98, v99
    v_cvt_pk_bf16_f32 v98, v100, v101
    v_cvt_pk_bf16_f32 v99, v102, v103
    v_exp_f32 v104, v104
    v_exp_f32 v105, v105
    v_exp_f32 v106, v106
    v_exp_f32 v107, v107
    v_exp_f32 v108, v108
    v_exp_f32 v109, v109
    v_exp_f32 v110, v110
    v_exp_f32 v111, v111
    v_exp_f32 v112, v112
    v_exp_f32 v113, v113
    v_cvt_pk_bf16_f32 v104, v104, v105
    v_cvt_pk_bf16_f32 v105, v106, v107
    v_cvt_pk_bf16_f32 v106, v108, v109
    v_cvt_pk_bf16_f32 v107, v110, v111
    s_bfe_i32 s11, s95, 0x40000
    s_lshl_b32 s11, s11, 15
    s_bfe_i32 s12, s95, 0x40004
    s_lshl_b32 s12, s12, 15
    s_lshr_b32 s95, s95, 8
    s_waitcnt lgkmcnt(10)
    v_mfma_f32_16x16x32_bf16 v[136:139], v[200:203], v[72:75], v[136:139]
    ds_read_b64_tr_b16 v[228:229], v15 offset:0
    v_exp_f32 v114, v114
    v_mfma_f32_16x16x32_bf16 v[140:143], v[200:203], v[80:83], v[140:143]
    ds_read_b64_tr_b16 v[230:231], v15 offset:4096
    v_exp_f32 v115, v115
    v_mfma_f32_16x16x32_bf16 v[144:147], v[204:207], v[72:75], v[144:147]
    ds_read_b64_tr_b16 v[200:201], v8 offset:8192
    v_exp_f32 v116, v116
    v_mfma_f32_16x16x32_bf16 v[148:151], v[204:207], v[80:83], v[148:151]
    ds_read_b64_tr_b16 v[202:203], v8 offset:12288
    s_waitcnt lgkmcnt(10)
    v_mfma_f32_16x16x32_bf16 v[152:155], v[208:211], v[72:75], v[152:155]
    ds_read_b64_tr_b16 v[204:205], v9 offset:8192
    v_exp_f32 v117, v117
    v_mfma_f32_16x16x32_bf16 v[156:159], v[208:211], v[80:83], v[156:159]
    ds_read_b64_tr_b16 v[206:207], v9 offset:12288
    v_exp_f32 v118, v118
    v_mfma_f32_16x16x32_bf16 v[160:163], v[212:215], v[72:75], v[160:163]
    ds_read_b64_tr_b16 v[208:209], v10 offset:8192
    v_exp_f32 v119, v119
    v_mfma_f32_16x16x32_bf16 v[164:167], v[212:215], v[80:83], v[164:167]
    ds_read_b64_tr_b16 v[210:211], v10 offset:12288
    v_cvt_pk_bf16_f32 v112, v112, v113
    v_mfma_f32_16x16x32_bf16 v[24:27], v[32:35], v[72:75], v[24:27]
    v_cvt_pk_bf16_f32 v113, v114, v115
    v_cvt_pk_bf16_f32 v114, v116, v117
    v_cvt_pk_bf16_f32 v115, v118, v119
    v_mfma_f32_16x16x32_bf16 v[28:31], v[32:35], v[80:83], v[28:31]
    v_exp_f32 v120, v120
    s_waitcnt lgkmcnt(10)
    v_mfma_f32_16x16x32_bf16 v[168:171], v[216:219], v[72:75], v[168:171]
    ds_read_b64_tr_b16 v[212:213], v11 offset:8192
    v_exp_f32 v121, v121
    v_mfma_f32_16x16x32_bf16 v[172:175], v[216:219], v[80:83], v[172:175]
    ds_read_b64_tr_b16 v[214:215], v11 offset:12288
    v_exp_f32 v122, v122
    v_mfma_f32_16x16x32_bf16 v[176:179], v[220:223], v[72:75], v[176:179]
    ds_read_b64_tr_b16 v[216:217], v12 offset:8192
    v_exp_f32 v123, v123
    v_mfma_f32_16x16x32_bf16 v[180:183], v[220:223], v[80:83], v[180:183]
    ds_read_b64_tr_b16 v[218:219], v12 offset:12288
    s_waitcnt lgkmcnt(10)
    v_mfma_f32_16x16x32_bf16 v[184:187], v[224:227], v[72:75], v[184:187]
    ds_read_b64_tr_b16 v[220:221], v13 offset:8192
    v_exp_f32 v124, v124
    v_mfma_f32_16x16x32_bf16 v[188:191], v[224:227], v[80:83], v[188:191]
    ds_read_b64_tr_b16 v[222:223], v13 offset:12288
    v_exp_f32 v125, v125
    v_mfma_f32_16x16x32_bf16 v[192:195], v[228:231], v[72:75], v[192:195]
    ds_read_b64_tr_b16 v[224:225], v14 offset:8192
    v_exp_f32 v126, v126
    v_mfma_f32_16x16x32_bf16 v[196:199], v[228:231], v[80:83], v[196:199]
    ds_read_b64_tr_b16 v[226:227], v14 offset:12288
    s_waitcnt lgkmcnt(10)
    v_mfma_f32_16x16x32_bf16 v[136:139], v[200:203], v[88:91], v[136:139]
    ds_read_b64_tr_b16 v[228:229], v15 offset:8192
    v_exp_f32 v127, v127
    v_mfma_f32_16x16x32_bf16 v[140:143], v[200:203], v[96:99], v[140:143]
    ds_read_b64_tr_b16 v[230:231], v15 offset:12288
    v_exp_f32 v128, v128
    v_mfma_f32_16x16x32_bf16 v[144:147], v[204:207], v[88:91], v[144:147]
    ds_read_b64_tr_b16 v[200:201], v8 offset:16384
    v_exp_f32 v129, v129
    v_mfma_f32_16x16x32_bf16 v[148:151], v[204:207], v[96:99], v[148:151]
    ds_read_b64_tr_b16 v[202:203], v8 offset:20480
    v_cvt_pk_bf16_f32 v120, v120, v121
    s_waitcnt lgkmcnt(10)
    v_mfma_f32_16x16x32_bf16 v[152:155], v[208:211], v[88:91], v[152:155]
    ds_read_b64_tr_b16 v[204:205], v9 offset:16384
    v_cvt_pk_bf16_f32 v121, v122, v123
    v_cvt_pk_bf16_f32 v122, v124, v125
    v_mfma_f32_16x16x32_bf16 v[156:159], v[208:211], v[96:99], v[156:159]
    ds_read_b64_tr_b16 v[206:207], v9 offset:20480
    v_cvt_pk_bf16_f32 v123, v126, v127
    v_mfma_f32_16x16x32_bf16 v[160:163], v[212:215], v[88:91], v[160:163]
    ds_read_b64_tr_b16 v[208:209], v10 offset:16384
    v_exp_f32 v130, v130
    v_mfma_f32_16x16x32_bf16 v[164:167], v[212:215], v[96:99], v[164:167]
    ds_read_b64_tr_b16 v[210:211], v10 offset:20480
    v_mfma_f32_16x16x32_bf16 v[24:27], v[32:35], v[88:91], v[24:27]
    v_exp_f32 v131, v131
    v_mfma_f32_16x16x32_bf16 v[28:31], v[32:35], v[96:99], v[28:31]
    v_exp_f32 v132, v132
    s_waitcnt lgkmcnt(10)
    v_mfma_f32_16x16x32_bf16 v[168:171], v[216:219], v[88:91], v[168:171]
    ds_read_b64_tr_b16 v[212:213], v11 offset:16384
    v_exp_f32 v133, v133
    v_mfma_f32_16x16x32_bf16 v[172:175], v[216:219], v[96:99], v[172:175]
    ds_read_b64_tr_b16 v[214:215], v11 offset:20480
    v_exp_f32 v134, v134
    v_mfma_f32_16x16x32_bf16 v[176:179], v[220:223], v[88:91], v[176:179]
    ds_read_b64_tr_b16 v[216:217], v12 offset:16384
    v_exp_f32 v135, v135
    v_mfma_f32_16x16x32_bf16 v[180:183], v[220:223], v[96:99], v[180:183]
    ds_read_b64_tr_b16 v[218:219], v12 offset:20480
    v_cvt_pk_bf16_f32 v128, v128, v129
    s_waitcnt lgkmcnt(10)
    v_mfma_f32_16x16x32_bf16 v[184:187], v[224:227], v[88:91], v[184:187]
    ds_read_b64_tr_b16 v[220:221], v13 offset:16384
    v_cvt_pk_bf16_f32 v129, v130, v131
    v_cvt_pk_bf16_f32 v130, v132, v133
    v_mfma_f32_16x16x32_bf16 v[188:191], v[224:227], v[96:99], v[188:191]
    ds_read_b64_tr_b16 v[222:223], v13 offset:20480
    v_cvt_pk_bf16_f32 v131, v134, v135
    v_add_u32 v4, s11, v4
    v_mfma_f32_16x16x32_bf16 v[192:195], v[228:231], v[88:91], v[192:195]
    ds_read_b64_tr_b16 v[224:225], v14 offset:16384
    v_add_u32 v5, s11, v5
    v_add_u32 v6, s11, v6
    v_mfma_f32_16x16x32_bf16 v[196:199], v[228:231], v[96:99], v[196:199]
    ds_read_b64_tr_b16 v[226:227], v14 offset:20480
    v_add_u32 v7, s11, v7
    s_waitcnt lgkmcnt(10)
    v_mfma_f32_16x16x32_bf16 v[136:139], v[200:203], v[104:107], v[136:139]
    ds_read_b64_tr_b16 v[228:229], v15 offset:16384
    v_mfma_f32_16x16x32_bf16 v[140:143], v[200:203], v[112:115], v[140:143]
    ds_read_b64_tr_b16 v[230:231], v15 offset:20480
    v_mfma_f32_16x16x32_bf16 v[144:147], v[204:207], v[104:107], v[144:147]
    ds_read_b64_tr_b16 v[200:201], v8 offset:24576
    v_mfma_f32_16x16x32_bf16 v[148:151], v[204:207], v[112:115], v[148:151]
    ds_read_b64_tr_b16 v[202:203], v8 offset:28672
    s_waitcnt lgkmcnt(10)
    v_mfma_f32_16x16x32_bf16 v[152:155], v[208:211], v[104:107], v[152:155]
    ds_read_b64_tr_b16 v[204:205], v9 offset:24576
    v_add_u32 v8, s12, v8
    v_mfma_f32_16x16x32_bf16 v[156:159], v[208:211], v[112:115], v[156:159]
    ds_read_b64_tr_b16 v[206:207], v9 offset:28672
    v_mfma_f32_16x16x32_bf16 v[160:163], v[212:215], v[104:107], v[160:163]
    ds_read_b64_tr_b16 v[208:209], v10 offset:24576
    v_add_u32 v9, s12, v9
    v_mfma_f32_16x16x32_bf16 v[164:167], v[212:215], v[112:115], v[164:167]
    ds_read_b64_tr_b16 v[210:211], v10 offset:28672
    v_mfma_f32_16x16x32_bf16 v[24:27], v[32:35], v[104:107], v[24:27]
    v_mfma_f32_16x16x32_bf16 v[28:31], v[32:35], v[112:115], v[28:31]
    s_waitcnt lgkmcnt(10)
    v_mfma_f32_16x16x32_bf16 v[168:171], v[216:219], v[104:107], v[168:171]
    ds_read_b64_tr_b16 v[212:213], v11 offset:24576
    v_add_u32 v10, s12, v10
    v_mfma_f32_16x16x32_bf16 v[172:175], v[216:219], v[112:115], v[172:175]
    ds_read_b64_tr_b16 v[214:215], v11 offset:28672
    v_mfma_f32_16x16x32_bf16 v[176:179], v[220:223], v[104:107], v[176:179]
    ds_read_b64_tr_b16 v[216:217], v12 offset:24576
    v_add_u32 v11, s12, v11
    v_mfma_f32_16x16x32_bf16 v[180:183], v[220:223], v[112:115], v[180:183]
    ds_read_b64_tr_b16 v[218:219], v12 offset:28672
    s_waitcnt lgkmcnt(10)
    v_mfma_f32_16x16x32_bf16 v[184:187], v[224:227], v[104:107], v[184:187]
    ds_read_b64_tr_b16 v[220:221], v13 offset:24576
    v_add_u32 v12, s12, v12
    v_mfma_f32_16x16x32_bf16 v[188:191], v[224:227], v[112:115], v[188:191]
    ds_read_b64_tr_b16 v[222:223], v13 offset:28672
    v_mfma_f32_16x16x32_bf16 v[192:195], v[228:231], v[104:107], v[192:195]
    ds_read_b64_tr_b16 v[224:225], v14 offset:24576
    v_add_u32 v13, s12, v13
    v_mfma_f32_16x16x32_bf16 v[196:199], v[228:231], v[112:115], v[196:199]
    ds_read_b64_tr_b16 v[226:227], v14 offset:28672
    s_waitcnt lgkmcnt(10)
    v_mfma_f32_16x16x32_bf16 v[136:139], v[200:203], v[120:123], v[136:139]
    ds_read_b64_tr_b16 v[228:229], v15 offset:24576
    v_add_u32 v14, s12, v14
    v_mfma_f32_16x16x32_bf16 v[140:143], v[200:203], v[128:131], v[140:143]
    ds_read_b64_tr_b16 v[230:231], v15 offset:28672
    v_mfma_f32_16x16x32_bf16 v[144:147], v[204:207], v[120:123], v[144:147]
    v_add_u32 v15, s12, v15
    v_mfma_f32_16x16x32_bf16 v[148:151], v[204:207], v[128:131], v[148:151]
    s_waitcnt lgkmcnt(8)
    v_mfma_f32_16x16x32_bf16 v[152:155], v[208:211], v[120:123], v[152:155]
    v_mfma_f32_16x16x32_bf16 v[156:159], v[208:211], v[128:131], v[156:159]
    v_mfma_f32_16x16x32_bf16 v[160:163], v[212:215], v[120:123], v[160:163]
    v_mfma_f32_16x16x32_bf16 v[164:167], v[212:215], v[128:131], v[164:167]
    v_mfma_f32_16x16x32_bf16 v[24:27], v[32:35], v[120:123], v[24:27]
    v_mfma_f32_16x16x32_bf16 v[28:31], v[32:35], v[128:131], v[28:31]
    s_waitcnt lgkmcnt(0)
    s_barrier
    ds_read_b128 v[200:203], v4 offset:0
    ds_read_b128 v[204:207], v5 offset:0
    ds_read_b128 v[208:211], v6 offset:0
    v_mfma_f32_16x16x32_bf16 v[168:171], v[216:219], v[120:123], v[168:171]
    v_mfma_f32_16x16x32_bf16 v[172:175], v[216:219], v[128:131], v[172:175]
    ds_read_b128 v[212:215], v7 offset:0
    v_mfma_f32_16x16x32_bf16 v[176:179], v[220:223], v[120:123], v[176:179]
    v_mfma_f32_16x16x32_bf16 v[180:183], v[220:223], v[128:131], v[180:183]
    ds_read_b128 v[216:219], v4 offset:4096
    v_mfma_f32_16x16x32_bf16 v[184:187], v[224:227], v[120:123], v[184:187]
    v_mfma_f32_16x16x32_bf16 v[188:191], v[224:227], v[128:131], v[188:191]
    ds_read_b128 v[220:223], v5 offset:4096
    v_mfma_f32_16x16x32_bf16 v[192:195], v[228:231], v[120:123], v[192:195]
    v_mfma_f32_16x16x32_bf16 v[196:199], v[228:231], v[128:131], v[196:199]
    ds_read_b128 v[224:227], v6 offset:4096
    s_add_u32 s15, s15, 1
    s_cmp_lt_u32 s15, 4
    s_cbranch_scc1 L_att
    s_lshl_b32 s11, s4, 4
    v_mov_b32 v247, s11
    ds_read_b96 v[244:246], v247
    s_lshl_b32 s11, s6, 15
    s_add_u32 s11, s11, s98
    s_add_u32 s12, s11, 4096
    v_rcp_f32 v36, v24
    v_rcp_f32 v37, v28
    v_mul_f32 v136, v136, v36
    v_mul_f32 v137, v137, v36
    v_mul_f32 v138, v138, v36
    v_mul_f32 v139, v139, v36
    v_mul_f32 v144, v144, v36
    v_mul_f32 v145, v145, v36
    v_mul_f32 v146, v146, v36
    v_mul_f32 v147, v147, v36
    v_cvt_pk_bf16_f32 v40, v136, v137
    v_cvt_pk_bf16_f32 v41, v138, v139
    v_cvt_pk_bf16_f32 v42, v144, v145
    v_cvt_pk_bf16_f32 v43, v146, v147
    v_and_b32 v40, -2, v40
    buffer_store_dwordx4 v[40:43], v2, s[68:71], s11 offen offset:0
    v_mul_f32 v140, v140, v37
    v_mul_f32 v141, v141, v37
    v_mul_f32 v142, v142, v37
    v_mul_f32 v143, v143, v37
    v_mul_f32 v148, v148, v37
    v_mul_f32 v149, v149, v37
    v_mul_f32 v150, v150, v37
    v_mul_f32 v151, v151, v37
    v_cvt_pk_bf16_f32 v44, v140, v141
    v_cvt_pk_bf16_f32 v45, v142, v143
    v_cvt_pk_bf16_f32 v46, v148, v149
    v_cvt_pk_bf16_f32 v47, v150, v151
    v_and_b32 v44, -2, v44
    buffer_store_dwordx4 v[44:47], v2, s[68:71], s11 offen offset:1024
    v_mul_f32 v152, v152, v36
    v_mul_f32 v153, v153, v36
    v_mul_f32 v154, v154, v36
    v_mul_f32 v155, v155, v36
    v_mul_f32 v160, v160, v36
    v_mul_f32 v161, v161, v36
    v_mul_f32 v162, v162, v36
    v_mul_f32 v163, v163, v36
    v_cvt_pk_bf16_f32 v48, v152, v153
    v_cvt_pk_bf16_f32 v49, v154, v155
    v_cvt_pk_bf16_f32 v50, v160, v161
    v_cvt_pk_bf16_f32 v51, v162, v163
    v_and_b32 v48, -2, v48
    buffer_store_dwordx4 v[48:51], v2, s[68:71], s11 offen offset:2048
    v_mul_f32 v156, v156, v37
    v_mul_f32 v157, v157, v37
    v_mul_f32 v158, v158, v37
    v_mul_f32 v159, v159, v37
    v_mul_f32 v164, v164, v37
    v_mul_f32 v165, v165, v37
    v_mul_f32 v166, v166, v37
    v_mul_f32 v167, v167, v37
    v_cvt_pk_bf16_f32 v52, v156, v157
    v_cvt_pk_bf16_f32 v53, v158, v159
    v_cvt_pk_bf16_f32 v54, v164, v165
    v_cvt_pk_bf16_f32 v55, v166, v167
    v_and_b32 v52, -2, v52
    buffer_store_dwordx4 v[52:55], v2, s[68:71], s11 offen offset:3072
    v_mul_f32 v168, v168, v36
    v_mul_f32 v169, v169, v36
    v_mul_f32 v170, v170, v36
    v_mul_f32 v171, v171, v36
    v_mul_f32 v176, v176, v36
    v_mul_f32 v177, v177, v36
    v_mul_f32 v178, v178, v36
    v_mul_f32 v179, v179, v36
    v_cvt_pk_bf16_f32 v56, v168, v169
    v_cvt_pk_bf16_f32 v57, v170, v171
    v_cvt_pk_bf16_f32 v58, v176, v177
    v_cvt_pk_bf16_f32 v59, v178, v179
    v_and_b32 v56, -2, v56
    buffer_store_dwordx4 v[56:59], v2, s[68:71], s12 offen offset:0
    v_mul_f32 v172, v172, v37
    v_mul_f32 v173, v173, v37
    v_mul_f32 v174, v174, v37
    v_mul_f32 v175, v175, v37
    v_mul_f32 v180, v180, v37
    v_mul_f32 v181, v181, v37
    v_mul_f32 v182, v182, v37
    v_mul_f32 v183, v183, v37
    v_cvt_pk_bf16_f32 v60, v172, v173
    v_cvt_pk_bf16_f32 v61, v174, v175
    v_cvt_pk_bf16_f32 v62, v180, v181
    v_cvt_pk_bf16_f32 v63, v182, v183
    v_and_b32 v60, -2, v60
    buffer_store_dwordx4 v[60:63], v2, s[68:71], s12 offen offset:1024
    v_mul_f32 v184, v184, v36
    v_mul_f32 v185, v185, v36
    v_mul_f32 v186, v186, v36
    v_mul_f32 v187, v187, v36
    v_mul_f32 v192, v192, v36
    v_mul_f32 v193, v193, v36
    v_mul_f32 v194, v194, v36
    v_mul_f32 v195, v195, v36
    v_cvt_pk_bf16_f32 v64, v184, v185
    v_cvt_pk_bf16_f32 v65, v186, v187
    v_cvt_pk_bf16_f32 v66, v192, v193
    v_cvt_pk_bf16_f32 v67, v194, v195
    v_and_b32 v64, -2, v64
    buffer_store_dwordx4 v[64:67], v2, s[68:71], s12 offen offset:2048
    v_mul_f32 v188, v188, v37
    v_mul_f32 v189, v189, v37
    v_mul_f32 v190, v190, v37
    v_mul_f32 v191, v191, v37
    v_mul_f32 v196, v196, v37
    v_mul_f32 v197, v197, v37
    v_mul_f32 v198, v198, v37
    v_mul_f32 v199, v199, v37
    v_cvt_pk_bf16_f32 v68, v188, v189
    v_cvt_pk_bf16_f32 v69, v190, v191
    v_cvt_pk_bf16_f32 v70, v196, v197
    v_cvt_pk_bf16_f32 v71, v198, v199
    v_and_b32 v68, -2, v68
    buffer_store_dwordx4 v[68:71], v2, s[68:71], s12 offen offset:3072
    s_waitcnt lgkmcnt(0)
    v_readfirstlane_b32 s92, v244
    v_readfirstlane_b32 s93, v245
    v_readfirstlane_b32 s34, v246
    s_nop 1
    s_cmp_eq_u32 s34, 0
    s_cbranch_scc1 L_ofast
    buffer_store_dwordx4 v[40:43], v2, s[68:71], s11 offen offset:0 sc1
    buffer_store_dwordx4 v[44:47], v2, s[68:71], s11 offen offset:1024 sc1
    buffer_store_dwordx4 v[48:51], v2, s[68:71], s11 offen offset:2048 sc1
    buffer_store_dwordx4 v[52:55], v2, s[68:71], s11 offen offset:3072 sc1
    buffer_store_dwordx4 v[56:59], v2, s[68:71], s12 offen offset:0 sc1
    buffer_store_dwordx4 v[60:63], v2, s[68:71], s12 offen offset:1024 sc1
    buffer_store_dwordx4 v[64:67], v2, s[68:71], s12 offen offset:2048 sc1
    buffer_store_dwordx4 v[68:71], v2, s[68:71], s12 offen offset:3072 sc1
L_ofast:
    v_lshrrev_b32 v17, 6, v2
    v_mul_u32_u24 v17, 288, v17
    v_lshrrev_b32 v3, 1, v2
    v_and_b32 v3, 24, v3
    v_add_u32 v3, 1024, v3
    v_add_u32 v17, v17, v3
    s_setprio 3
    v_lshrrev_b32 v18, 4, v2
    v_lshrrev_b32 v3, 4, v18
    v_and_b32 v7, 15, v18
    v_xor_b32 v4, v3, v7
    v_lshlrev_b32 v5, 1, v3
    v_xor_b32 v5, v5, v7
    v_lshlrev_b32 v3, 8, v3
    v_lshl_add_u32 v4, v4, 4, v3
    v_lshl_add_u32 v5, v5, 4, v3
    v_add_u32 v6, 64512, v17
    v_and_b32 v3, 128, v5
    v_mul_u32_u24 v3, 0x101, v3
    s_and_b32 s11, s30, 0x8000
    s_lshl_b32 s12, s40, 7
    s_or_b32 s11, s11, s12
    v_xor_b32 v5, v5, v3
    v_xor_b32 v5, s11, v5
    s_add_u32 s13, s32, 131072
    s_add_u32 m0, s76, 65536
    s_nop 0
    buffer_load_dwordx4 v4, s[48:51], s13 offen offset:0 nt lds
    v_xor_b32 v4, 64, v4
    buffer_load_dwordx4 v4, s[48:51], s13 offen offset:1024 nt lds
    v_xor_b32 v4, 128, v4
    buffer_load_dwordx4 v4, s[48:51], s13 offen offset:3072 nt lds
    v_xor_b32 v4, 64, v4
    buffer_load_dwordx4 v4, s[48:51], s13 offen offset:2048 nt lds
    s_add_u32 s13, s32, 135168
    s_add_u32 m0, s76, 69632
    s_nop 0
    buffer_load_dwordx4 v4, s[48:51], s13 offen offset:2048 nt lds
    v_xor_b32 v4, 64, v4
    buffer_load_dwordx4 v4, s[48:51], s13 offen offset:3072 nt lds
    v_xor_b32 v4, 128, v4
    buffer_load_dwordx4 v4, s[48:51], s13 offen offset:1024 nt lds
    v_xor_b32 v4, 64, v4
    buffer_load_dwordx4 v4, s[48:51], s13 offen offset:0 nt lds
    v_mul_u32_u24 v16, 3641, v18
    v_mov_b32 v3, 864
    v_mad_u32_u16 v8, v16, v3, v2 op_sel:[1,0,0,0]
    v_add_u32 v9, 233024, v16
    v_mad_u32_u16 v9, v9, v3, v2 op_sel:[1,0,0,0]
    v_add_u32 v10, 466048, v16
    v_mad_u32_u16 v10, v10, v3, v2 op_sel:[1,0,0,0]
    v_add_u32 v11, 699072, v16
    v_mad_u32_u16 v11, v11, v3, v2 op_sel:[1,0,0,0]
    v_add_u32 v12, 932096, v16
    v_mad_u32_u16 v12, v12, v3, v2 op_sel:[1,0,0,0]
    v_add_u32 v13, 1165120, v16
    v_mad_u32_u16 v13, v13, v3, v2 op_sel:[1,0,0,0]
    v_add_u32 v14, 1398144, v16
    v_mad_u32_u16 v14, v14, v3, v2 op_sel:[1,0,0,0]
    v_add_u32 v15, 1631168, v16
    v_mad_u32_u16 v15, v15, v3, v2 op_sel:[1,0,0,0]
    v_add_u32 v16, 1864192, v16
    v_mad_u32_u16 v16, v16, v3, v2 op_sel:[1,0,0,0]
    s_mul_i32 s100, s8, 1179648
    s_mul_i32 s11, s6, 288
    s_add_u32 s100, s100, s11
    s_waitcnt vmcnt(8)
    s_lshl_b32 s11, s6, 3
    s_add_u32 s11, s11, s99
    v_mov_b32 v18, s92
    v_mov_b32 v19, s93
    s_mov_b64 exec, 1
    s_cmp_eq_u32 s34, 0
    s_cbranch_scc0 L_fs_2
    buffer_store_dwordx2 v[18:19], off, s[68:71], s11 offset:0
    s_branch L_fs_3
L_fs_2:
    buffer_store_dwordx2 v[18:19], off, s[68:71], s11 offset:0 sc1
L_fs_3:
    s_mov_b64 exec, -1
    s_lshl_b32 s11, s6, 15
    s_add_u32 s11, s11, s98
    v_lshlrev_b32 v3, 3, v2
    buffer_load_dword v7, v3, s[68:71], s11 offen sc1 nt
    s_waitcnt lgkmcnt(0)
    s_barrier
    v_mov_b32 v136, 0
    v_mov_b32 v137, 0
    v_mov_b32 v138, 0
    v_mov_b32 v139, 0
    v_mov_b32 v140, 0
    v_mov_b32 v141, 0
    v_mov_b32 v142, 0
    v_mov_b32 v143, 0
    v_mov_b32 v144, 0
    v_mov_b32 v145, 0
    v_mov_b32 v146, 0
    v_mov_b32 v147, 0
    v_mov_b32 v148, 0
    v_mov_b32 v149, 0
    v_mov_b32 v150, 0
    v_mov_b32 v151, 0
    v_mov_b32 v152, 0
    v_mov_b32 v153, 0
    v_mov_b32 v154, 0
    v_mov_b32 v155, 0
    v_mov_b32 v156, 0
    v_mov_b32 v157, 0
    v_mov_b32 v158, 0
    v_mov_b32 v159, 0
    v_mov_b32 v160, 0
    v_mov_b32 v161, 0
    v_mov_b32 v162, 0
    v_mov_b32 v163, 0
    v_mov_b32 v164, 0
    v_mov_b32 v165, 0
    v_mov_b32 v166, 0
    v_mov_b32 v167, 0
    v_mov_b32 v168, 0
    v_mov_b32 v169, 0
    v_mov_b32 v170, 0
    v_mov_b32 v171, 0
    v_mov_b32 v172, 0
    v_mov_b32 v173, 0
    v_mov_b32 v174, 0
    v_mov_b32 v175, 0
    v_mov_b32 v176, 0
    v_mov_b32 v177, 0
    v_mov_b32 v178, 0
    v_mov_b32 v179, 0
    v_mov_b32 v180, 0
    v_mov_b32 v181, 0
    v_mov_b32 v182, 0
    v_mov_b32 v183, 0
    v_mov_b32 v184, 0
    v_mov_b32 v185, 0
    v_mov_b32 v186, 0
    v_mov_b32 v187, 0
    v_mov_b32 v188, 0
    v_mov_b32 v189, 0
    v_mov_b32 v190, 0
    v_mov_b32 v191, 0
    v_mov_b32 v192, 0
    v_mov_b32 v193, 0
    v_mov_b32 v194, 0
    v_mov_b32 v195, 0
    v_mov_b32 v196, 0
    v_mov_b32 v197, 0
    v_mov_b32 v198, 0
    v_mov_b32 v199, 0
    v_mov_b32 v232, 0
    v_mov_b32 v233, 0
    v_mov_b32 v234, 0
    v_mov_b32 v235, 0
    v_mov_b32 v236, 0
    v_mov_b32 v237, 0
    v_mov_b32 v238, 0
    v_mov_b32 v239, 0
    s_setprio 3
    ds_read_b64_tr_b16 v[200:201], v17 offset:36864
    ds_read_b64_tr_b16 v[202:203], v17 offset:41472
    ds_read_b64_tr_b16 v[204:205], v17 offset:36896
    ds_read_b64_tr_b16 v[206:207], v17 offset:41504
    ds_read_b64_tr_b16 v[208:209], v17 offset:36928
    ds_read_b64_tr_b16 v[210:211], v17 offset:41536
    ds_read_b64_tr_b16 v[212:213], v17 offset:36960
    ds_read_b64_tr_b16 v[214:215], v17 offset:41568
    ds_read_b64_tr_b16 v[216:217], v17 offset:36992
    ds_read_b64_tr_b16 v[218:219], v17 offset:41600
    ds_read_b64_tr_b16 v[220:221], v17 offset:37024
    ds_read_b64_tr_b16 v[222:223], v17 offset:41632
    ds_read_b64_tr_b16 v[224:225], v17 offset:37056
    ds_read_b64_tr_b16 v[226:227], v17 offset:41664
    s_waitcnt lgkmcnt(10)
    v_mfma_f32_16x16x32_bf16 v[136:139], v[200:203], v[40:43], v[136:139]
    ds_read_b64_tr_b16 v[228:229], v17 offset:37088
    v_mfma_f32_16x16x32_bf16 v[140:143], v[200:203], v[44:47], v[140:143]
    ds_read_b64_tr_b16 v[230:231], v17 offset:41696
    v_mfma_f32_16x16x32_bf16 v[144:147], v[204:207], v[40:43], v[144:147]
    ds_read_b64_tr_b16 v[200:201], v17 offset:37120
    v_mfma_f32_16x16x32_bf16 v[148:151], v[204:207], v[44:47], v[148:151]
    ds_read_b64_tr_b16 v[202:203], v17 offset:41728
    s_waitcnt lgkmcnt(10)
    v_mfma_f32_16x16x32_bf16 v[152:155], v[208:211], v[40:43], v[152:155]
    ds_read_b64_tr_b16 v[204:205], v17 offset:46080
    v_mfma_f32_16x16x32_bf16 v[156:159], v[208:211], v[44:47], v[156:159]
    ds_read_b64_tr_b16 v[206:207], v17 offset:50688
    v_mfma_f32_16x16x32_bf16 v[160:163], v[212:215], v[40:43], v[160:163]
    ds_read_b64_tr_b16 v[208:209], v17 offset:46112
    v_mfma_f32_16x16x32_bf16 v[164:167], v[212:215], v[44:47], v[164:167]
    ds_read_b64_tr_b16 v[210:211], v17 offset:50720
    s_waitcnt lgkmcnt(10)
    v_mfma_f32_16x16x32_bf16 v[168:171], v[216:219], v[40:43], v[168:171]
    ds_read_b64_tr_b16 v[212:213], v17 offset:46144
    v_mfma_f32_16x16x32_bf16 v[172:175], v[216:219], v[44:47], v[172:175]
    ds_read_b64_tr_b16 v[214:215], v17 offset:50752
    v_mfma_f32_16x16x32_bf16 v[176:179], v[220:223], v[40:43], v[176:179]
    ds_read_b64_tr_b16 v[216:217], v17 offset:46176
    v_mfma_f32_16x16x32_bf16 v[180:183], v[220:223], v[44:47], v[180:183]
    ds_read_b64_tr_b16 v[218:219], v17 offset:50784
    s_waitcnt lgkmcnt(10)
    v_mfma_f32_16x16x32_bf16 v[184:187], v[224:227], v[40:43], v[184:187]
    ds_read_b64_tr_b16 v[220:221], v17 offset:46208
    v_mfma_f32_16x16x32_bf16 v[188:191], v[224:227], v[44:47], v[188:191]
    ds_read_b64_tr_b16 v[222:223], v17 offset:50816
    v_mfma_f32_16x16x32_bf16 v[192:195], v[228:231], v[40:43], v[192:195]
    ds_read_b64_tr_b16 v[224:225], v17 offset:46240
    v_mfma_f32_16x16x32_bf16 v[196:199], v[228:231], v[44:47], v[196:199]
    ds_read_b64_tr_b16 v[226:227], v17 offset:50848
    s_waitcnt lgkmcnt(10)
    v_mfma_f32_16x16x32_bf16 v[232:235], v[200:203], v[40:43], v[232:235]
    ds_read_b64_tr_b16 v[228:229], v17 offset:46272
    v_mfma_f32_16x16x32_bf16 v[236:239], v[200:203], v[44:47], v[236:239]
    ds_read_b64_tr_b16 v[230:231], v17 offset:50880
    v_mfma_f32_16x16x32_bf16 v[136:139], v[204:207], v[48:51], v[136:139]
    ds_read_b64_tr_b16 v[200:201], v17 offset:46304
    v_mfma_f32_16x16x32_bf16 v[140:143], v[204:207], v[52:55], v[140:143]
    ds_read_b64_tr_b16 v[202:203], v17 offset:50912
    s_waitcnt lgkmcnt(10)
    v_mfma_f32_16x16x32_bf16 v[144:147], v[208:211], v[48:51], v[144:147]
    ds_read_b64_tr_b16 v[204:205], v17 offset:46336
    v_mfma_f32_16x16x32_bf16 v[148:151], v[208:211], v[52:55], v[148:151]
    ds_read_b64_tr_b16 v[206:207], v17 offset:50944
    v_mfma_f32_16x16x32_bf16 v[152:155], v[212:215], v[48:51], v[152:155]
    ds_read_b64_tr_b16 v[208:209], v17 offset:55296
    v_mfma_f32_16x16x32_bf16 v[156:159], v[212:215], v[52:55], v[156:159]
    ds_read_b64_tr_b16 v[210:211], v17 offset:59904
    s_waitcnt lgkmcnt(10)
    v_mfma_f32_16x16x32_bf16 v[160:163], v[216:219], v[48:51], v[160:163]
    ds_read_b64_tr_b16 v[212:213], v17 offset:55328
    v_mfma_f32_16x16x32_bf16 v[164:167], v[216:219], v[52:55], v[164:167]
    ds_read_b64_tr_b16 v[214:215], v17 offset:59936
    v_mfma_f32_16x16x32_bf16 v[168:171], v[220:223], v[48:51], v[168:171]
    ds_read_b64_tr_b16 v[216:217], v17 offset:55360
    v_mfma_f32_16x16x32_bf16 v[172:175], v[220:223], v[52:55], v[172:175]
    ds_read_b64_tr_b16 v[218:219], v17 offset:59968
    s_waitcnt lgkmcnt(10)
    v_mfma_f32_16x16x32_bf16 v[176:179], v[224:227], v[48:51], v[176:179]
    ds_read_b64_tr_b16 v[220:221], v17 offset:55392
    v_mfma_f32_16x16x32_bf16 v[180:183], v[224:227], v[52:55], v[180:183]
    ds_read_b64_tr_b16 v[222:223], v17 offset:60000
    v_mfma_f32_16x16x32_bf16 v[184:187], v[228:231], v[48:51], v[184:187]
    ds_read_b64_tr_b16 v[224:225], v17 offset:55424
    v_mfma_f32_16x16x32_bf16 v[188:191], v[228:231], v[52:55], v[188:191]
    ds_read_b64_tr_b16 v[226:227], v17 offset:60032
    s_waitcnt lgkmcnt(10)
    v_mfma_f32_16x16x32_bf16 v[192:195], v[200:203], v[48:51], v[192:195]
    ds_read_b64_tr_b16 v[228:229], v17 offset:55456
    v_mfma_f32_16x16x32_bf16 v[196:199], v[200:203], v[52:55], v[196:199]
    ds_read_b64_tr_b16 v[230:231], v17 offset:60064
    v_mfma_f32_16x16x32_bf16 v[232:235], v[204:207], v[48:51], v[232:235]
    ds_read_b64_tr_b16 v[200:201], v17 offset:55488
    v_mfma_f32_16x16x32_bf16 v[236:239], v[204:207], v[52:55], v[236:239]
    ds_read_b64_tr_b16 v[202:203], v17 offset:60096
    s_waitcnt lgkmcnt(10)
    v_mfma_f32_16x16x32_bf16 v[136:139], v[208:211], v[56:59], v[136:139]
    ds_read_b64_tr_b16 v[204:205], v17 offset:55520
    v_mfma_f32_16x16x32_bf16 v[140:143], v[208:211], v[60:63], v[140:143]
    ds_read_b64_tr_b16 v[206:207], v17 offset:60128
    v_mfma_f32_16x16x32_bf16 v[144:147], v[212:215], v[56:59], v[144:147]
    ds_read_b64_tr_b16 v[208:209], v17 offset:55552
    v_mfma_f32_16x16x32_bf16 v[148:151], v[212:215], v[60:63], v[148:151]
    ds_read_b64_tr_b16 v[210:211], v17 offset:60160
    s_setprio 3
    s_lshl_b32 s11, s6, 2
    s_add_u32 s11, s11, s4
    s_add_u32 s11, s11, 3
    s_and_b32 s12, s11, 12
    s_and_b32 s11, s11, 15
    s_add_u32 s11, s11, s12
    s_mul_i32 s11, s11, 36864
    s_add_u32 s11, s11, s100
    s_mov_b32 s12, 1024
    s_cmp_eq_u32 s4, 1
    s_cselect_b32 s12, 10240, s12
    s_cmp_eq_u32 s4, 2
    s_cselect_b32 s12, 19456, s12
    s_cmp_eq_u32 s4, 3
    s_cselect_b32 s12, 28672, s12
    s_add_u32 m0, s12, 0
    s_nop 0
    buffer_load_dwordx4 v8, s[60:63], s11 offen offset:0 nt lds
    buffer_load_dwordx4 v9, s[60:63], s11 offen offset:1024 nt lds
    buffer_load_dwordx4 v10, s[60:63], s11 offen offset:2048 nt lds
    buffer_load_dwordx4 v11, s[60:63], s11 offen offset:3072 nt lds
    s_add_u32 s11, s11, 4096
    s_add_u32 m0, s12, 4096
    s_nop 0
    buffer_load_dwordx4 v12, s[60:63], s11 offen offset:0 nt lds
    buffer_load_dwordx4 v13, s[60:63], s11 offen offset:1024 nt lds
    buffer_load_dwordx4 v14, s[60:63], s11 offen offset:2048 nt lds
    buffer_load_dwordx4 v15, s[60:63], s11 offen offset:3072 nt lds
    s_add_u32 s11, s11, 4096
    s_add_u32 m0, s12, 8192
    s_nop 0
    buffer_load_dwordx4 v16, s[60:63], s11 offen offset:0 nt lds
L_wo_4:
    v_lshrrev_b32 v3, 1, v2
    v_and_b32 v3, 24, v3
    buffer_load_dwordx2 v[18:19], v3, s[68:71], s99 offen offset:0 sc1
    s_add_u32 s13, s33, 131072
    s_add_u32 m0, s76, 98304
    s_nop 0
    buffer_load_dwordx4 v4, s[48:51], s13 offen offset:0 nt lds
    v_xor_b32 v4, 64, v4
    buffer_load_dwordx4 v4, s[48:51], s13 offen offset:1024 nt lds
    v_xor_b32 v4, 128, v4
    buffer_load_dwordx4 v4, s[48:51], s13 offen offset:3072 nt lds
    v_xor_b32 v4, 64, v4
    buffer_load_dwordx4 v4, s[48:51], s13 offen offset:2048 nt lds
    s_add_u32 s13, s33, 135168
    s_add_u32 m0, s76, 102400
    s_nop 0
    buffer_load_dwordx4 v4, s[48:51], s13 offen offset:2048 nt lds
    v_xor_b32 v4, 64, v4
    buffer_load_dwordx4 v4, s[48:51], s13 offen offset:3072 nt lds
    v_xor_b32 v4, 128, v4
    buffer_load_dwordx4 v4, s[48:51], s13 offen offset:1024 nt lds
    v_xor_b32 v4, 64, v4
    buffer_load_dwordx4 v4, s[48:51], s13 offen offset:0 nt lds
    s_waitcnt vmcnt(20)
    s_waitcnt lgkmcnt(0)
    s_barrier
    s_waitcnt vmcnt(8)
    s_mov_b32 s96, 200000
    s_branch L_pcC0
L_plC0:
    v_lshrrev_b32 v3, 1, v2
    v_and_b32 v3, 24, v3
    buffer_load_dwordx2 v[18:19], v3, s[68:71], s99 offen offset:0 sc1
    s_sub_u32 s96, s96, 1
    s_cbranch_scc1 L_pxC0
    s_waitcnt vmcnt(0)
L_pcC0:
    v_cmp_ne_u64 s[28:29], s[92:93], v[18:19]
    s_nop 1
    s_cmp_lg_u64 s[28:29], 0
    s_cbranch_scc1 L_plC0
L_pxC0:
    s_add_u32 s11, s6, 1
    s_and_b32 s11, s11, 3
    s_lshl_b32 s11, s11, 15
    s_add_u32 s11, s11, s98
    s_add_u32 s12, s11, 4096
    buffer_load_dwordx4 v[72:75], v2, s[68:71], s11 offen offset:0 sc1
    buffer_load_dwordx4 v[76:79], v2, s[68:71], s11 offen offset:1024 sc1
    buffer_load_dwordx4 v[80:83], v2, s[68:71], s11 offen offset:2048 sc1
    buffer_load_dwordx4 v[84:87], v2, s[68:71], s11 offen offset:3072 sc1
    buffer_load_dwordx4 v[88:91], v2, s[68:71], s12 offen offset:0 sc1
    buffer_load_dwordx4 v[92:95], v2, s[68:71], s12 offen offset:1024 sc1
    buffer_load_dwordx4 v[96:99], v2, s[68:71], s12 offen offset:2048 sc1
    buffer_load_dwordx4 v[100:103], v2, s[68:71], s12 offen offset:3072 sc1
    s_cmp_ge_u32 s4, 3
    s_cbranch_scc1 L_wo_5
    s_lshl_b32 s11, s6, 2
    s_add_u32 s11, s11, s4
    s_add_u32 s11, s11, 7
    s_and_b32 s12, s11, 12
    s_and_b32 s11, s11, 15
    s_add_u32 s11, s11, s12
    s_mul_i32 s11, s11, 36864
    s_add_u32 s11, s11, s100
    s_mov_b32 s12, 37888
    s_cmp_eq_u32 s4, 1
    s_cselect_b32 s12, 47104, s12
    s_cmp_eq_u32 s4, 2
    s_cselect_b32 s12, 56320, s12
    s_add_u32 m0, s12, 0
    s_nop 0
    buffer_load_dwordx4 v8, s[60:63], s11 offen offset:0 nt lds
    buffer_load_dwordx4 v9, s[60:63], s11 offen offset:1024 nt lds
    buffer_load_dwordx4 v10, s[60:63], s11 offen offset:2048 nt lds
    buffer_load_dwordx4 v11, s[60:63], s11 offen offset:3072 nt lds
    s_add_u32 s11, s11, 4096
    s_add_u32 m0, s12, 4096
    s_nop 0
    buffer_load_dwordx4 v12, s[60:63], s11 offen offset:0 nt lds
    buffer_load_dwordx4 v13, s[60:63], s11 offen offset:1024 nt lds
    buffer_load_dwordx4 v14, s[60:63], s11 offen offset:2048 nt lds
    buffer_load_dwordx4 v15, s[60:63], s11 offen offset:3072 nt lds
    s_add_u32 s11, s11, 4096
    s_add_u32 m0, s12, 8192
    s_nop 0
    buffer_load_dwordx4 v16, s[60:63], s11 offen offset:0 nt lds
L_wo_5:
    s_add_u32 s11, s6, 2
    s_and_b32 s11, s11, 3
    s_lshl_b32 s11, s11, 15
    s_add_u32 s11, s11, s98
    s_add_u32 s12, s11, 4096
    buffer_load_dwordx4 v[104:107], v2, s[68:71], s11 offen offset:0 sc1
    buffer_load_dwordx4 v[108:111], v2, s[68:71], s11 offen offset:1024 sc1
    buffer_load_dwordx4 v[112:115], v2, s[68:71], s11 offen offset:2048 sc1
    buffer_load_dwordx4 v[116:119], v2, s[68:71], s11 offen offset:3072 sc1
    buffer_load_dwordx4 v[120:123], v2, s[68:71], s12 offen offset:0 sc1
    buffer_load_dwordx4 v[124:127], v2, s[68:71], s12 offen offset:1024 sc1
    buffer_load_dwordx4 v[128:131], v2, s[68:71], s12 offen offset:2048 sc1
    buffer_load_dwordx4 v[132:135], v2, s[68:71], s12 offen offset:3072 sc1
    s_andn2_b32 s13, s30, 0x8000
    s_add_u32 s13, s13, 131072
    s_add_u32 m0, s76, 131072
    s_nop 0
    buffer_load_dwordx4 v5, s[52:55], s13 offen offset:0 nt lds
    buffer_load_dwordx4 v5, s[52:55], s13 offen offset:2048 nt lds
    v_xor_b32 v5, 32768, v5
    buffer_load_dwordx4 v5, s[52:55], s13 offen offset:1024 nt lds
    buffer_load_dwordx4 v5, s[52:55], s13 offen offset:3072 nt lds
    s_andn2_b32 s13, s30, 0x8000
    s_add_u32 s13, s13, 135168
    s_add_u32 m0, s76, 135168
    s_nop 0
    buffer_load_dwordx4 v5, s[52:55], s13 offen offset:1024 nt lds
    buffer_load_dwordx4 v5, s[52:55], s13 offen offset:3072 nt lds
    v_xor_b32 v5, 32768, v5
    buffer_load_dwordx4 v5, s[52:55], s13 offen offset:0 nt lds
    buffer_load_dwordx4 v5, s[52:55], s13 offen offset:2048 nt lds
    s_cmp_ge_u32 s4, 3
    s_cbranch_scc0 L_ws_6
    s_waitcnt vmcnt(24)
L_ws_6:
    s_waitcnt vmcnt(33)
    s_waitcnt lgkmcnt(0)
    s_barrier
    s_cmp_ge_u32 s4, 3
    s_cbranch_scc0 L_ws_7
    s_waitcnt vmcnt(16)
L_ws_7:
    s_waitcnt vmcnt(25)
    s_setprio 3
    v_mfma_f32_16x16x32_bf16 v[152:155], v[216:219], v[56:59], v[152:155]
    ds_read_b64_tr_b16 v[212:213], v17 offset:0
    v_mfma_f32_16x16x32_bf16 v[156:159], v[216:219], v[60:63], v[156:159]
    ds_read_b64_tr_b16 v[214:215], v17 offset:4608
    v_mfma_f32_16x16x32_bf16 v[160:163], v[220:223], v[56:59], v[160:163]
    ds_read_b64_tr_b16 v[216:217], v17 offset:32
    v_mfma_f32_16x16x32_bf16 v[164:167], v[220:223], v[60:63], v[164:167]
    ds_read_b64_tr_b16 v[218:219], v17 offset:4640
    v_mfma_f32_16x16x32_bf16 v[168:171], v[224:227], v[56:59], v[168:171]
    ds_read_b64_tr_b16 v[220:221], v17 offset:64
    v_mfma_f32_16x16x32_bf16 v[172:175], v[224:227], v[60:63], v[172:175]
    ds_read_b64_tr_b16 v[222:223], v17 offset:4672
    v_mfma_f32_16x16x32_bf16 v[176:179], v[228:231], v[56:59], v[176:179]
    ds_read_b64_tr_b16 v[224:225], v17 offset:96
    v_mfma_f32_16x16x32_bf16 v[180:183], v[228:231], v[60:63], v[180:183]
    ds_read_b64_tr_b16 v[226:227], v17 offset:4704
    v_mfma_f32_16x16x32_bf16 v[184:187], v[200:203], v[56:59], v[184:187]
    ds_read_b64_tr_b16 v[228:229], v17 offset:128
    v_mfma_f32_16x16x32_bf16 v[188:191], v[200:203], v[60:63], v[188:191]
    ds_read_b64_tr_b16 v[230:231], v17 offset:4736
    v_mfma_f32_16x16x32_bf16 v[192:195], v[204:207], v[56:59], v[192:195]
    ds_read_b64_tr_b16 v[200:201], v17 offset:160
    v_mfma_f32_16x16x32_bf16 v[196:199], v[204:207], v[60:63], v[196:199]
    ds_read_b64_tr_b16 v[202:203], v17 offset:4768
    s_waitcnt lgkmcnt(10)
    v_mfma_f32_16x16x32_bf16 v[232:235], v[208:211], v[56:59], v[232:235]
    ds_read_b64_tr_b16 v[204:205], v17 offset:192
    v_mfma_f32_16x16x32_bf16 v[236:239], v[208:211], v[60:63], v[236:239]
    ds_read_b64_tr_b16 v[206:207], v17 offset:4800
    v_mfma_f32_16x16x32_bf16 v[136:139], v[212:215], v[64:67], v[136:139]
    ds_read_b64_tr_b16 v[208:209], v17 offset:224
    v_mfma_f32_16x16x32_bf16 v[140:143], v[212:215], v[68:71], v[140:143]
    ds_read_b64_tr_b16 v[210:211], v17 offset:4832
    s_waitcnt lgkmcnt(10)
    v_mfma_f32_16x16x32_bf16 v[144:147], v[216:219], v[64:67], v[144:147]
    ds_read_b64_tr_b16 v[212:213], v17 offset:256
    v_mfma_f32_16x16x32_bf16 v[148:151], v[216:219], v[68:71], v[148:151]
    ds_read_b64_tr_b16 v[214:215], v17 offset:4864
    v_mfma_f32_16x16x32_bf16 v[152:155], v[220:223], v[64:67], v[152:155]
    ds_read_b64_tr_b16 v[216:217], v17 offset:9216
    v_mfma_f32_16x16x32_bf16 v[156:159], v[220:223], v[68:71], v[156:159]
    ds_read_b64_tr_b16 v[218:219], v17 offset:13824
    s_waitcnt lgkmcnt(10)
    v_mfma_f32_16x16x32_bf16 v[160:163], v[224:227], v[64:67], v[160:163]
    ds_read_b64_tr_b16 v[220:221], v17 offset:9248
    v_mfma_f32_16x16x32_bf16 v[164:167], v[224:227], v[68:71], v[164:167]
    ds_read_b64_tr_b16 v[222:223], v17 offset:13856
    v_mfma_f32_16x16x32_bf16 v[168:171], v[228:231], v[64:67], v[168:171]
    ds_read_b64_tr_b16 v[224:225], v17 offset:9280
    v_mfma_f32_16x16x32_bf16 v[172:175], v[228:231], v[68:71], v[172:175]
    ds_read_b64_tr_b16 v[226:227], v17 offset:13888
    s_waitcnt lgkmcnt(10)
    v_mfma_f32_16x16x32_bf16 v[176:179], v[200:203], v[64:67], v[176:179]
    ds_read_b64_tr_b16 v[228:229], v17 offset:9312
    v_mfma_f32_16x16x32_bf16 v[180:183], v[200:203], v[68:71], v[180:183]
    ds_read_b64_tr_b16 v[230:231], v17 offset:13920
    v_mfma_f32_16x16x32_bf16 v[184:187], v[204:207], v[64:67], v[184:187]
    ds_read_b64_tr_b16 v[200:201], v17 offset:9344
    v_mfma_f32_16x16x32_bf16 v[188:191], v[204:207], v[68:71], v[188:191]
    ds_read_b64_tr_b16 v[202:203], v17 offset:13952
    s_waitcnt lgkmcnt(10)
    v_mfma_f32_16x16x32_bf16 v[192:195], v[208:211], v[64:67], v[192:195]
    ds_read_b64_tr_b16 v[204:205], v17 offset:9376
    v_mfma_f32_16x16x32_bf16 v[196:199], v[208:211], v[68:71], v[196:199]
    ds_read_b64_tr_b16 v[206:207], v17 offset:13984
    v_mfma_f32_16x16x32_bf16 v[232:235], v[212:215], v[64:67], v[232:235]
    ds_read_b64_tr_b16 v[208:209], v17 offset:9408
    v_mfma_f32_16x16x32_bf16 v[236:239], v[212:215], v[68:71], v[236:239]
    ds_read_b64_tr_b16 v[210:211], v17 offset:14016
    s_waitcnt lgkmcnt(10)
    v_mfma_f32_16x16x32_bf16 v[136:139], v[216:219], v[72:75], v[136:139]
    ds_read_b64_tr_b16 v[212:213], v17 offset:9440
    v_mfma_f32_16x16x32_bf16 v[140:143], v[216:219], v[76:79], v[140:143]
    ds_read_b64_tr_b16 v[214:215], v17 offset:14048
    v_mfma_f32_16x16x32_bf16 v[144:147], v[220:223], v[72:75], v[144:147]
    ds_read_b64_tr_b16 v[216:217], v17 offset:9472
    v_mfma_f32_16x16x32_bf16 v[148:151], v[220:223], v[76:79], v[148:151]
    ds_read_b64_tr_b16 v[218:219], v17 offset:14080
    s_waitcnt lgkmcnt(10)
    v_mfma_f32_16x16x32_bf16 v[152:155], v[224:227], v[72:75], v[152:155]
    ds_read_b64_tr_b16 v[220:221], v17 offset:18432
    v_mfma_f32_16x16x32_bf16 v[156:159], v[224:227], v[76:79], v[156:159]
    ds_read_b64_tr_b16 v[222:223], v17 offset:23040
    v_mfma_f32_16x16x32_bf16 v[160:163], v[228:231], v[72:75], v[160:163]
    ds_read_b64_tr_b16 v[224:225], v17 offset:18464
    v_mfma_f32_16x16x32_bf16 v[164:167], v[228:231], v[76:79], v[164:167]
    ds_read_b64_tr_b16 v[226:227], v17 offset:23072
    s_waitcnt lgkmcnt(10)
    v_mfma_f32_16x16x32_bf16 v[168:171], v[200:203], v[72:75], v[168:171]
    ds_read_b64_tr_b16 v[228:229], v17 offset:18496
    v_mfma_f32_16x16x32_bf16 v[172:175], v[200:203], v[76:79], v[172:175]
    ds_read_b64_tr_b16 v[230:231], v17 offset:23104
    v_mfma_f32_16x16x32_bf16 v[176:179], v[204:207], v[72:75], v[176:179]
    ds_read_b64_tr_b16 v[200:201], v17 offset:18528
    v_mfma_f32_16x16x32_bf16 v[180:183], v[204:207], v[76:79], v[180:183]
    ds_read_b64_tr_b16 v[202:203], v17 offset:23136
    s_waitcnt lgkmcnt(10)
    v_mfma_f32_16x16x32_bf16 v[184:187], v[208:211], v[72:75], v[184:187]
    ds_read_b64_tr_b16 v[204:205], v17 offset:18560
    v_mfma_f32_16x16x32_bf16 v[188:191], v[208:211], v[76:79], v[188:191]
    ds_read_b64_tr_b16 v[206:207], v17 offset:23168
    v_mfma_f32_16x16x32_bf16 v[192:195], v[212:215], v[72:75], v[192:195]
    ds_read_b64_tr_b16 v[208:209], v17 offset:18592
    v_mfma_f32_16x16x32_bf16 v[196:199], v[212:215], v[76:79], v[196:199]
    ds_read_b64_tr_b16 v[210:211], v17 offset:23200
    s_waitcnt lgkmcnt(10)
    v_mfma_f32_16x16x32_bf16 v[232:235], v[216:219], v[72:75], v[232:235]
    ds_read_b64_tr_b16 v[212:213], v17 offset:18624
    v_mfma_f32_16x16x32_bf16 v[236:239], v[216:219], v[76:79], v[236:239]
    ds_read_b64_tr_b16 v[214:215], v17 offset:23232
    v_mfma_f32_16x16x32_bf16 v[136:139], v[220:223], v[80:83], v[136:139]
    ds_read_b64_tr_b16 v[216:217], v17 offset:18656
    v_mfma_f32_16x16x32_bf16 v[140:143], v[220:223], v[84:87], v[140:143]
    ds_read_b64_tr_b16 v[218:219], v17 offset:23264
    s_waitcnt lgkmcnt(10)
    v_mfma_f32_16x16x32_bf16 v[144:147], v[224:227], v[80:83], v[144:147]
    ds_read_b64_tr_b16 v[220:221], v17 offset:18688
    v_mfma_f32_16x16x32_bf16 v[148:151], v[224:227], v[84:87], v[148:151]
    ds_read_b64_tr_b16 v[222:223], v17 offset:23296
    v_mfma_f32_16x16x32_bf16 v[152:155], v[228:231], v[80:83], v[152:155]
    ds_read_b64_tr_b16 v[224:225], v17 offset:27648
    v_mfma_f32_16x16x32_bf16 v[156:159], v[228:231], v[84:87], v[156:159]
    ds_read_b64_tr_b16 v[226:227], v17 offset:32256
    s_waitcnt lgkmcnt(10)
    v_mfma_f32_16x16x32_bf16 v[160:163], v[200:203], v[80:83], v[160:163]
    ds_read_b64_tr_b16 v[228:229], v17 offset:27680
    v_mfma_f32_16x16x32_bf16 v[164:167], v[200:203], v[84:87], v[164:167]
    ds_read_b64_tr_b16 v[230:231], v17 offset:32288
    v_mfma_f32_16x16x32_bf16 v[168:171], v[204:207], v[80:83], v[168:171]
    ds_read_b64_tr_b16 v[200:201], v17 offset:27712
    v_mfma_f32_16x16x32_bf16 v[172:175], v[204:207], v[84:87], v[172:175]
    ds_read_b64_tr_b16 v[202:203], v17 offset:32320
    s_waitcnt lgkmcnt(10)
    v_mfma_f32_16x16x32_bf16 v[176:179], v[208:211], v[80:83], v[176:179]
    ds_read_b64_tr_b16 v[204:205], v17 offset:27744
    v_mfma_f32_16x16x32_bf16 v[180:183], v[208:211], v[84:87], v[180:183]
    ds_read_b64_tr_b16 v[206:207], v17 offset:32352
    v_mfma_f32_16x16x32_bf16 v[184:187], v[212:215], v[80:83], v[184:187]
    ds_read_b64_tr_b16 v[208:209], v17 offset:27776
    v_mfma_f32_16x16x32_bf16 v[188:191], v[212:215], v[84:87], v[188:191]
    ds_read_b64_tr_b16 v[210:211], v17 offset:32384
    s_waitcnt lgkmcnt(10)
    v_mfma_f32_16x16x32_bf16 v[192:195], v[216:219], v[80:83], v[192:195]
    ds_read_b64_tr_b16 v[212:213], v17 offset:27808
    v_mfma_f32_16x16x32_bf16 v[196:199], v[216:219], v[84:87], v[196:199]
    ds_read_b64_tr_b16 v[214:215], v17 offset:32416
    v_mfma_f32_16x16x32_bf16 v[232:235], v[220:223], v[80:83], v[232:235]
    ds_read_b64_tr_b16 v[216:217], v17 offset:27840
    v_mfma_f32_16x16x32_bf16 v[236:239], v[220:223], v[84:87], v[236:239]
    ds_read_b64_tr_b16 v[218:219], v17 offset:32448
    s_waitcnt lgkmcnt(10)
    v_mfma_f32_16x16x32_bf16 v[136:139], v[224:227], v[88:91], v[136:139]
    ds_read_b64_tr_b16 v[220:221], v17 offset:27872
    v_mfma_f32_16x16x32_bf16 v[140:143], v[224:227], v[92:95], v[140:143]
    ds_read_b64_tr_b16 v[222:223], v17 offset:32480
    v_mfma_f32_16x16x32_bf16 v[144:147], v[228:231], v[88:91], v[144:147]
    ds_read_b64_tr_b16 v[224:225], v17 offset:27904
    v_mfma_f32_16x16x32_bf16 v[148:151], v[228:231], v[92:95], v[148:151]
    ds_read_b64_tr_b16 v[226:227], v17 offset:32512
    s_setprio 3
    s_add_u32 s11, s6, 3
    s_and_b32 s11, s11, 3
    s_lshl_b32 s11, s11, 15
    s_add_u32 s11, s11, s98
    s_add_u32 s12, s11, 4096
    buffer_load_dwordx4 v[20:23], v2, s[68:71], s11 offen offset:0 sc1
    buffer_load_dwordx4 v[24:27], v2, s[68:71], s11 offen offset:1024 sc1
    buffer_load_dwordx4 v[28:31], v2, s[68:71], s11 offen offset:2048 sc1
    buffer_load_dwordx4 v[32:35], v2, s[68:71], s11 offen offset:3072 sc1
    buffer_load_dwordx4 v[36:39], v2, s[68:71], s12 offen offset:0 sc1
    buffer_load_dwordx4 v[240:243], v2, s[68:71], s12 offen offset:1024 sc1
    buffer_load_dwordx4 v[244:247], v2, s[68:71], s12 offen offset:2048 sc1
    buffer_load_dwordx4 v[248:251], v2, s[68:71], s12 offen offset:3072 sc1
    s_andn2_b32 s13, s32, 0x8000
    s_add_u32 s13, s13, 131072
    s_add_u32 m0, s76, 65536
    s_nop 0
    buffer_load_dwordx4 v5, s[52:55], s13 offen offset:0 nt lds
    buffer_load_dwordx4 v5, s[52:55], s13 offen offset:2048 nt lds
    v_xor_b32 v5, 32768, v5
    buffer_load_dwordx4 v5, s[52:55], s13 offen offset:1024 nt lds
    buffer_load_dwordx4 v5, s[52:55], s13 offen offset:3072 nt lds
    s_andn2_b32 s13, s32, 0x8000
    s_add_u32 s13, s13, 135168
    s_add_u32 m0, s76, 69632
    s_nop 0
    buffer_load_dwordx4 v5, s[52:55], s13 offen offset:1024 nt lds
    buffer_load_dwordx4 v5, s[52:55], s13 offen offset:3072 nt lds
    v_xor_b32 v5, 32768, v5
    buffer_load_dwordx4 v5, s[52:55], s13 offen offset:0 nt lds
    buffer_load_dwordx4 v5, s[52:55], s13 offen offset:2048 nt lds
    s_waitcnt vmcnt(16)
    s_waitcnt lgkmcnt(0)
    s_barrier
    s_waitcnt vmcnt(8)
    s_lshl_b32 s11, s6, 3
    s_add_u32 s11, s11, s99
    v_mov_b32 v18, s92
    v_mov_b32 v19, s93
    s_mov_b64 exec, 1
    s_cmp_eq_u32 s34, 0
    s_cbranch_scc0 L_fs_8
    buffer_store_dwordx2 v[18:19], off, s[68:71], s11 offset:64
    s_branch L_fs_9
L_fs_8:
    buffer_store_dwordx2 v[18:19], off, s[68:71], s11 offset:64 sc1
L_fs_9:
    s_mov_b64 exec, -1
    s_setprio 3
    v_mfma_f32_16x16x32_bf16 v[152:155], v[200:203], v[88:91], v[152:155]
    ds_read_b64_tr_b16 v[228:229], v17 offset:36864
    v_mfma_f32_16x16x32_bf16 v[156:159], v[200:203], v[92:95], v[156:159]
    ds_read_b64_tr_b16 v[230:231], v17 offset:41472
    v_mfma_f32_16x16x32_bf16 v[160:163], v[204:207], v[88:91], v[160:163]
    ds_read_b64_tr_b16 v[200:201], v17 offset:36896
    v_mfma_f32_16x16x32_bf16 v[164:167], v[204:207], v[92:95], v[164:167]
    ds_read_b64_tr_b16 v[202:203], v17 offset:41504
    v_mfma_f32_16x16x32_bf16 v[168:171], v[208:211], v[88:91], v[168:171]
    ds_read_b64_tr_b16 v[204:205], v17 offset:36928
    v_mfma_f32_16x16x32_bf16 v[172:175], v[208:211], v[92:95], v[172:175]
    ds_read_b64_tr_b16 v[206:207], v17 offset:41536
    v_mfma_f32_16x16x32_bf16 v[176:179], v[212:215], v[88:91], v[176:179]
    ds_read_b64_tr_b16 v[208:209], v17 offset:36960
    v_mfma_f32_16x16x32_bf16 v[180:183], v[212:215], v[92:95], v[180:183]
    ds_read_b64_tr_b16 v[210:211], v17 offset:41568
    v_mfma_f32_16x16x32_bf16 v[184:187], v[216:219], v[88:91], v[184:187]
    ds_read_b64_tr_b16 v[212:213], v17 offset:36992
    v_mfma_f32_16x16x32_bf16 v[188:191], v[216:219], v[92:95], v[188:191]
    ds_read_b64_tr_b16 v[214:215], v17 offset:41600
    v_mfma_f32_16x16x32_bf16 v[192:195], v[220:223], v[88:91], v[192:195]
    ds_read_b64_tr_b16 v[216:217], v17 offset:37024
    v_mfma_f32_16x16x32_bf16 v[196:199], v[220:223], v[92:95], v[196:199]
    ds_read_b64_tr_b16 v[218:219], v17 offset:41632
    s_waitcnt lgkmcnt(10)
    v_mfma_f32_16x16x32_bf16 v[232:235], v[224:227], v[88:91], v[232:235]
    ds_read_b64_tr_b16 v[220:221], v17 offset:37056
    v_mfma_f32_16x16x32_bf16 v[236:239], v[224:227], v[92:95], v[236:239]
    ds_read_b64_tr_b16 v[222:223], v17 offset:41664
    v_mfma_f32_16x16x32_bf16 v[136:139], v[228:231], v[96:99], v[136:139]
    ds_read_b64_tr_b16 v[224:225], v17 offset:37088
    v_mfma_f32_16x16x32_bf16 v[140:143], v[228:231], v[100:103], v[140:143]
    ds_read_b64_tr_b16 v[226:227], v17 offset:41696
    s_waitcnt lgkmcnt(10)
    v_mfma_f32_16x16x32_bf16 v[144:147], v[200:203], v[96:99], v[144:147]
    ds_read_b64_tr_b16 v[228:229], v17 offset:37120
    v_mfma_f32_16x16x32_bf16 v[148:151], v[200:203], v[100:103], v[148:151]
    ds_read_b64_tr_b16 v[230:231], v17 offset:41728
    v_mfma_f32_16x16x32_bf16 v[152:155], v[204:207], v[96:99], v[152:155]
    ds_read_b64_tr_b16 v[200:201], v17 offset:46080
    v_mfma_f32_16x16x32_bf16 v[156:159], v[204:207], v[100:103], v[156:159]
    ds_read_b64_tr_b16 v[202:203], v17 offset:50688
    s_waitcnt lgkmcnt(10)
    v_mfma_f32_16x16x32_bf16 v[160:163], v[208:211], v[96:99], v[160:163]
    ds_read_b64_tr_b16 v[204:205], v17 offset:46112
    v_mfma_f32_16x16x32_bf16 v[164:167], v[208:211], v[100:103], v[164:167]
    ds_read_b64_tr_b16 v[206:207], v17 offset:50720
    v_mfma_f32_16x16x32_bf16 v[168:171], v[212:215], v[96:99], v[168:171]
    ds_read_b64_tr_b16 v[208:209], v17 offset:46144
    v_mfma_f32_16x16x32_bf16 v[172:175], v[212:215], v[100:103], v[172:175]
    ds_read_b64_tr_b16 v[210:211], v17 offset:50752
    s_waitcnt lgkmcnt(10)
    v_mfma_f32_16x16x32_bf16 v[176:179], v[216:219], v[96:99], v[176:179]
    ds_read_b64_tr_b16 v[212:213], v17 offset:46176
    v_mfma_f32_16x16x32_bf16 v[180:183], v[216:219], v[100:103], v[180:183]
    ds_read_b64_tr_b16 v[214:215], v17 offset:50784
    v_mfma_f32_16x16x32_bf16 v[184:187], v[220:223], v[96:99], v[184:187]
    ds_read_b64_tr_b16 v[216:217], v17 offset:46208
    v_mfma_f32_16x16x32_bf16 v[188:191], v[220:223], v[100:103], v[188:191]
    ds_read_b64_tr_b16 v[218:219], v17 offset:50816
    s_waitcnt lgkmcnt(10)
    v_mfma_f32_16x16x32_bf16 v[192:195], v[224:227], v[96:99], v[192:195]
    ds_read_b64_tr_b16 v[220:221], v17 offset:46240
    v_mfma_f32_16x16x32_bf16 v[196:199], v[224:227], v[100:103], v[196:199]
    ds_read_b64_tr_b16 v[222:223], v17 offset:50848
    v_mfma_f32_16x16x32_bf16 v[232:235], v[228:231], v[96:99], v[232:235]
    ds_read_b64_tr_b16 v[224:225], v17 offset:46272
    v_mfma_f32_16x16x32_bf16 v[236:239], v[228:231], v[100:103], v[236:239]
    ds_read_b64_tr_b16 v[226:227], v17 offset:50880
    s_waitcnt lgkmcnt(10)
    v_mfma_f32_16x16x32_bf16 v[136:139], v[200:203], v[104:107], v[136:139]
    ds_read_b64_tr_b16 v[228:229], v17 offset:46304
    v_mfma_f32_16x16x32_bf16 v[140:143], v[200:203], v[108:111], v[140:143]
    ds_read_b64_tr_b16 v[230:231], v17 offset:50912
    v_mfma_f32_16x16x32_bf16 v[144:147], v[204:207], v[104:107], v[144:147]
    ds_read_b64_tr_b16 v[200:201], v17 offset:46336
    v_mfma_f32_16x16x32_bf16 v[148:151], v[204:207], v[108:111], v[148:151]
    ds_read_b64_tr_b16 v[202:203], v17 offset:50944
    s_waitcnt lgkmcnt(10)
    v_mfma_f32_16x16x32_bf16 v[152:155], v[208:211], v[104:107], v[152:155]
    ds_read_b64_tr_b16 v[204:205], v17 offset:55296
    v_mfma_f32_16x16x32_bf16 v[156:159], v[208:211], v[108:111], v[156:159]
    ds_read_b64_tr_b16 v[206:207], v17 offset:59904
    v_mfma_f32_16x16x32_bf16 v[160:163], v[212:215], v[104:107], v[160:163]
    ds_read_b64_tr_b16 v[208:209], v17 offset:55328
    v_mfma_f32_16x16x32_bf16 v[164:167], v[212:215], v[108:111], v[164:167]
    ds_read_b64_tr_b16 v[210:211], v17 offset:59936
    s_waitcnt lgkmcnt(10)
    v_mfma_f32_16x16x32_bf16 v[168:171], v[216:219], v[104:107], v[168:171]
    ds_read_b64_tr_b16 v[212:213], v17 offset:55360
    v_mfma_f32_16x16x32_bf16 v[172:175], v[216:219], v[108:111], v[172:175]
    ds_read_b64_tr_b16 v[214:215], v17 offset:59968
    v_mfma_f32_16x16x32_bf16 v[176:179], v[220:223], v[104:107], v[176:179]
    ds_read_b64_tr_b16 v[216:217], v17 offset:55392
    v_mfma_f32_16x16x32_bf16 v[180:183], v[220:223], v[108:111], v[180:183]
    ds_read_b64_tr_b16 v[218:219], v17 offset:60000
    s_waitcnt lgkmcnt(10)
    v_mfma_f32_16x16x32_bf16 v[184:187], v[224:227], v[104:107], v[184:187]
    ds_read_b64_tr_b16 v[220:221], v17 offset:55424
    v_mfma_f32_16x16x32_bf16 v[188:191], v[224:227], v[108:111], v[188:191]
    ds_read_b64_tr_b16 v[222:223], v17 offset:60032
    v_mfma_f32_16x16x32_bf16 v[192:195], v[228:231], v[104:107], v[192:195]
    ds_read_b64_tr_b16 v[224:225], v17 offset:55456
    v_mfma_f32_16x16x32_bf16 v[196:199], v[228:231], v[108:111], v[196:199]
    ds_read_b64_tr_b16 v[226:227], v17 offset:60064
    s_waitcnt lgkmcnt(10)
    v_mfma_f32_16x16x32_bf16 v[232:235], v[200:203], v[104:107], v[232:235]
    ds_read_b64_tr_b16 v[228:229], v17 offset:55488
    v_mfma_f32_16x16x32_bf16 v[236:239], v[200:203], v[108:111], v[236:239]
    ds_read_b64_tr_b16 v[230:231], v17 offset:60096
    v_mfma_f32_16x16x32_bf16 v[136:139], v[204:207], v[112:115], v[136:139]
    ds_read_b64_tr_b16 v[200:201], v17 offset:55520
    v_mfma_f32_16x16x32_bf16 v[140:143], v[204:207], v[116:119], v[140:143]
    ds_read_b64_tr_b16 v[202:203], v17 offset:60128
    s_waitcnt lgkmcnt(10)
    v_mfma_f32_16x16x32_bf16 v[144:147], v[208:211], v[112:115], v[144:147]
    ds_read_b64_tr_b16 v[204:205], v17 offset:55552
    v_mfma_f32_16x16x32_bf16 v[148:151], v[208:211], v[116:119], v[148:151]
    ds_read_b64_tr_b16 v[206:207], v17 offset:60160
    s_setprio 3
    s_lshl_b32 s11, s6, 2
    s_add_u32 s11, s11, s4
    s_add_u32 s11, s11, 10
    s_and_b32 s12, s11, 12
    s_and_b32 s11, s11, 15
    s_add_u32 s11, s11, s12
    s_mul_i32 s11, s11, 36864
    s_add_u32 s11, s11, s100
    s_mov_b32 s12, 1024
    s_cmp_eq_u32 s4, 1
    s_cselect_b32 s12, 10240, s12
    s_cmp_eq_u32 s4, 2
    s_cselect_b32 s12, 19456, s12
    s_cmp_eq_u32 s4, 3
    s_cselect_b32 s12, 28672, s12
    s_add_u32 m0, s12, 0
    s_nop 0
    buffer_load_dwordx4 v8, s[60:63], s11 offen offset:0 nt lds
    buffer_load_dwordx4 v9, s[60:63], s11 offen offset:1024 nt lds
    buffer_load_dwordx4 v10, s[60:63], s11 offen offset:2048 nt lds
    buffer_load_dwordx4 v11, s[60:63], s11 offen offset:3072 nt lds
    s_add_u32 s11, s11, 4096
    s_add_u32 m0, s12, 4096
    s_nop 0
    buffer_load_dwordx4 v12, s[60:63], s11 offen offset:0 nt lds
    buffer_load_dwordx4 v13, s[60:63], s11 offen offset:1024 nt lds
    buffer_load_dwordx4 v14, s[60:63], s11 offen offset:2048 nt lds
    buffer_load_dwordx4 v15, s[60:63], s11 offen offset:3072 nt lds
    s_add_u32 s11, s11, 4096
    s_add_u32 m0, s12, 8192
    s_nop 0
    buffer_load_dwordx4 v16, s[60:63], s11 offen offset:0 nt lds
L_wo_10:
    s_andn2_b32 s13, s30, 0x8000
    s_add_u32 s13, s13, 131072
    v_xor_b32 v5, 128, v5
    s_add_u32 m0, s76, 98304
    s_nop 0
    buffer_load_dwordx4 v5, s[52:55], s13 offen offset:0 nt lds
    buffer_load_dwordx4 v5, s[52:55], s13 offen offset:2048 nt lds
    v_xor_b32 v5, 32768, v5
    buffer_load_dwordx4 v5, s[52:55], s13 offen offset:1024 nt lds
    buffer_load_dwordx4 v5, s[52:55], s13 offen offset:3072 nt lds
    s_andn2_b32 s13, s30, 0x8000
    s_add_u32 s13, s13, 135168
    s_add_u32 m0, s76, 102400
    s_nop 0
    buffer_load_dwordx4 v5, s[52:55], s13 offen offset:1024 nt lds
    buffer_load_dwordx4 v5, s[52:55], s13 offen offset:3072 nt lds
    v_xor_b32 v5, 32768, v5
    buffer_load_dwordx4 v5, s[52:55], s13 offen offset:0 nt lds
    buffer_load_dwordx4 v5, s[52:55], s13 offen offset:2048 nt lds
    s_waitcnt vmcnt(8)
    s_waitcnt lgkmcnt(0)
    s_barrier
    s_cmp_ge_u32 s4, 2
    s_cbranch_scc1 L_wo_11
    s_lshl_b32 s11, s6, 2
    s_add_u32 s11, s11, s4
    s_add_u32 s11, s11, 14
    s_and_b32 s12, s11, 12
    s_and_b32 s11, s11, 15
    s_add_u32 s11, s11, s12
    s_mul_i32 s11, s11, 36864
    s_add_u32 s11, s11, s100
    s_mov_b32 s12, 37888
    s_cmp_eq_u32 s4, 1
    s_cselect_b32 s12, 47104, s12
    s_add_u32 m0, s12, 0
    s_nop 0
    buffer_load_dwordx4 v8, s[60:63], s11 offen offset:0 nt lds
    buffer_load_dwordx4 v9, s[60:63], s11 offen offset:1024 nt lds
    buffer_load_dwordx4 v10, s[60:63], s11 offen offset:2048 nt lds
    buffer_load_dwordx4 v11, s[60:63], s11 offen offset:3072 nt lds
    s_add_u32 s11, s11, 4096
    s_add_u32 m0, s12, 4096
    s_nop 0
    buffer_load_dwordx4 v12, s[60:63], s11 offen offset:0 nt lds
    buffer_load_dwordx4 v13, s[60:63], s11 offen offset:1024 nt lds
    buffer_load_dwordx4 v14, s[60:63], s11 offen offset:2048 nt lds
    buffer_load_dwordx4 v15, s[60:63], s11 offen offset:3072 nt lds
    s_add_u32 s11, s11, 4096
    s_add_u32 m0, s12, 8192
    s_nop 0
    buffer_load_dwordx4 v16, s[60:63], s11 offen offset:0 nt lds
L_wo_11:
    s_setprio 1
    v_mfma_f32_16x16x32_bf16 v[152:155], v[212:215], v[112:115], v[152:155]
    ds_read_b64_tr_b16 v[208:209], v17 offset:0
    v_mfma_f32_16x16x32_bf16 v[156:159], v[212:215], v[116:119], v[156:159]
    ds_read_b64_tr_b16 v[210:211], v17 offset:4608
    v_mfma_f32_16x16x32_bf16 v[160:163], v[216:219], v[112:115], v[160:163]
    ds_read_b64_tr_b16 v[212:213], v17 offset:32
    v_mfma_f32_16x16x32_bf16 v[164:167], v[216:219], v[116:119], v[164:167]
    ds_read_b64_tr_b16 v[214:215], v17 offset:4640
    v_mfma_f32_16x16x32_bf16 v[168:171], v[220:223], v[112:115], v[168:171]
    ds_read_b64_tr_b16 v[216:217], v17 offset:64
    v_mfma_f32_16x16x32_bf16 v[172:175], v[220:223], v[116:119], v[172:175]
    ds_read_b64_tr_b16 v[218:219], v17 offset:4672
    v_mfma_f32_16x16x32_bf16 v[176:179], v[224:227], v[112:115], v[176:179]
    ds_read_b64_tr_b16 v[220:221], v17 offset:96
    v_mfma_f32_16x16x32_bf16 v[180:183], v[224:227], v[116:119], v[180:183]
    ds_read_b64_tr_b16 v[222:223], v17 offset:4704
    v_mfma_f32_16x16x32_bf16 v[184:187], v[228:231], v[112:115], v[184:187]
    ds_read_b64_tr_b16 v[224:225], v17 offset:128
    v_mfma_f32_16x16x32_bf16 v[188:191], v[228:231], v[116:119], v[188:191]
    ds_read_b64_tr_b16 v[226:227], v17 offset:4736
    v_mfma_f32_16x16x32_bf16 v[192:195], v[200:203], v[112:115], v[192:195]
    ds_read_b64_tr_b16 v[228:229], v17 offset:160
    v_mfma_f32_16x16x32_bf16 v[196:199], v[200:203], v[116:119], v[196:199]
    ds_read_b64_tr_b16 v[230:231], v17 offset:4768
    v_mfma_f32_16x16x32_bf16 v[232:235], v[204:207], v[112:115], v[232:235]
    ds_read_b64_tr_b16 v[200:201], v17 offset:192
    v_mfma_f32_16x16x32_bf16 v[236:239], v[204:207], v[116:119], v[236:239]
    ds_read_b64_tr_b16 v[202:203], v17 offset:4800
    s_waitcnt lgkmcnt(10)
    v_mfma_f32_16x16x32_bf16 v[136:139], v[208:211], v[120:123], v[136:139]
    ds_read_b64_tr_b16 v[204:205], v17 offset:224
    v_mfma_f32_16x16x32_bf16 v[140:143], v[208:211], v[124:127], v[140:143]
    ds_read_b64_tr_b16 v[206:207], v17 offset:4832
    v_mfma_f32_16x16x32_bf16 v[144:147], v[212:215], v[120:123], v[144:147]
    ds_read_b64_tr_b16 v[208:209], v17 offset:256
    v_mfma_f32_16x16x32_bf16 v[148:151], v[212:215], v[124:127], v[148:151]
    ds_read_b64_tr_b16 v[210:211], v17 offset:4864
    s_waitcnt lgkmcnt(10)
    v_mfma_f32_16x16x32_bf16 v[152:155], v[216:219], v[120:123], v[152:155]
    ds_read_b64_tr_b16 v[212:213], v17 offset:9216
    v_mfma_f32_16x16x32_bf16 v[156:159], v[216:219], v[124:127], v[156:159]
    ds_read_b64_tr_b16 v[214:215], v17 offset:13824
    v_mfma_f32_16x16x32_bf16 v[160:163], v[220:223], v[120:123], v[160:163]
    ds_read_b64_tr_b16 v[216:217], v17 offset:9248
    v_mfma_f32_16x16x32_bf16 v[164:167], v[220:223], v[124:127], v[164:167]
    ds_read_b64_tr_b16 v[218:219], v17 offset:13856
    s_waitcnt lgkmcnt(10)
    v_mfma_f32_16x16x32_bf16 v[168:171], v[224:227], v[120:123], v[168:171]
    ds_read_b64_tr_b16 v[220:221], v17 offset:9280
    v_mfma_f32_16x16x32_bf16 v[172:175], v[224:227], v[124:127], v[172:175]
    ds_read_b64_tr_b16 v[222:223], v17 offset:13888
    v_mfma_f32_16x16x32_bf16 v[176:179], v[228:231], v[120:123], v[176:179]
    ds_read_b64_tr_b16 v[224:225], v17 offset:9312
    v_mfma_f32_16x16x32_bf16 v[180:183], v[228:231], v[124:127], v[180:183]
    ds_read_b64_tr_b16 v[226:227], v17 offset:13920
    s_waitcnt lgkmcnt(10)
    v_mfma_f32_16x16x32_bf16 v[184:187], v[200:203], v[120:123], v[184:187]
    ds_read_b64_tr_b16 v[228:229], v17 offset:9344
    v_mfma_f32_16x16x32_bf16 v[188:191], v[200:203], v[124:127], v[188:191]
    ds_read_b64_tr_b16 v[230:231], v17 offset:13952
    v_mfma_f32_16x16x32_bf16 v[192:195], v[204:207], v[120:123], v[192:195]
    ds_read_b64_tr_b16 v[200:201], v17 offset:9376
    v_mfma_f32_16x16x32_bf16 v[196:199], v[204:207], v[124:127], v[196:199]
    ds_read_b64_tr_b16 v[202:203], v17 offset:13984
    s_waitcnt lgkmcnt(10)
    v_mfma_f32_16x16x32_bf16 v[232:235], v[208:211], v[120:123], v[232:235]
    ds_read_b64_tr_b16 v[204:205], v17 offset:9408
    v_mfma_f32_16x16x32_bf16 v[236:239], v[208:211], v[124:127], v[236:239]
    ds_read_b64_tr_b16 v[206:207], v17 offset:14016
    v_mfma_f32_16x16x32_bf16 v[136:139], v[212:215], v[128:131], v[136:139]
    ds_read_b64_tr_b16 v[208:209], v17 offset:9440
    v_mfma_f32_16x16x32_bf16 v[140:143], v[212:215], v[132:135], v[140:143]
    ds_read_b64_tr_b16 v[210:211], v17 offset:14048
    s_waitcnt lgkmcnt(10)
    v_mfma_f32_16x16x32_bf16 v[144:147], v[216:219], v[128:131], v[144:147]
    ds_read_b64_tr_b16 v[212:213], v17 offset:9472
    v_mfma_f32_16x16x32_bf16 v[148:151], v[216:219], v[132:135], v[148:151]
    ds_read_b64_tr_b16 v[214:215], v17 offset:14080
    v_mfma_f32_16x16x32_bf16 v[152:155], v[220:223], v[128:131], v[152:155]
    ds_read_b64_tr_b16 v[216:217], v17 offset:18432
    v_mfma_f32_16x16x32_bf16 v[156:159], v[220:223], v[132:135], v[156:159]
    ds_read_b64_tr_b16 v[218:219], v17 offset:23040
    s_waitcnt lgkmcnt(10)
    v_mfma_f32_16x16x32_bf16 v[160:163], v[224:227], v[128:131], v[160:163]
    ds_read_b64_tr_b16 v[220:221], v17 offset:18464
    v_mfma_f32_16x16x32_bf16 v[164:167], v[224:227], v[132:135], v[164:167]
    ds_read_b64_tr_b16 v[222:223], v17 offset:23072
    v_mfma_f32_16x16x32_bf16 v[168:171], v[228:231], v[128:131], v[168:171]
    ds_read_b64_tr_b16 v[224:225], v17 offset:18496
    v_mfma_f32_16x16x32_bf16 v[172:175], v[228:231], v[132:135], v[172:175]
    ds_read_b64_tr_b16 v[226:227], v17 offset:23104
    s_waitcnt lgkmcnt(10)
    v_mfma_f32_16x16x32_bf16 v[176:179], v[200:203], v[128:131], v[176:179]
    ds_read_b64_tr_b16 v[228:229], v17 offset:18528
    v_mfma_f32_16x16x32_bf16 v[180:183], v[200:203], v[132:135], v[180:183]
    ds_read_b64_tr_b16 v[230:231], v17 offset:23136
    v_mfma_f32_16x16x32_bf16 v[184:187], v[204:207], v[128:131], v[184:187]
    ds_read_b64_tr_b16 v[200:201], v17 offset:18560
    v_mfma_f32_16x16x32_bf16 v[188:191], v[204:207], v[132:135], v[188:191]
    ds_read_b64_tr_b16 v[202:203], v17 offset:23168
    s_waitcnt lgkmcnt(10)
    v_mfma_f32_16x16x32_bf16 v[192:195], v[208:211], v[128:131], v[192:195]
    ds_read_b64_tr_b16 v[204:205], v17 offset:18592
    v_mfma_f32_16x16x32_bf16 v[196:199], v[208:211], v[132:135], v[196:199]
    ds_read_b64_tr_b16 v[206:207], v17 offset:23200
    v_mfma_f32_16x16x32_bf16 v[232:235], v[212:215], v[128:131], v[232:235]
    ds_read_b64_tr_b16 v[208:209], v17 offset:18624
    v_mfma_f32_16x16x32_bf16 v[236:239], v[212:215], v[132:135], v[236:239]
    ds_read_b64_tr_b16 v[210:211], v17 offset:23232
    s_waitcnt lgkmcnt(10)
    v_mfma_f32_16x16x32_bf16 v[136:139], v[216:219], v[20:23], v[136:139]
    ds_read_b64_tr_b16 v[212:213], v17 offset:18656
    v_mfma_f32_16x16x32_bf16 v[140:143], v[216:219], v[24:27], v[140:143]
    ds_read_b64_tr_b16 v[214:215], v17 offset:23264
    v_mfma_f32_16x16x32_bf16 v[144:147], v[220:223], v[20:23], v[144:147]
    ds_read_b64_tr_b16 v[216:217], v17 offset:18688
    v_mfma_f32_16x16x32_bf16 v[148:151], v[220:223], v[24:27], v[148:151]
    ds_read_b64_tr_b16 v[218:219], v17 offset:23296
    s_waitcnt lgkmcnt(10)
    v_mfma_f32_16x16x32_bf16 v[152:155], v[224:227], v[20:23], v[152:155]
    ds_read_b64_tr_b16 v[220:221], v17 offset:27648
    v_mfma_f32_16x16x32_bf16 v[156:159], v[224:227], v[24:27], v[156:159]
    ds_read_b64_tr_b16 v[222:223], v17 offset:32256
    v_mfma_f32_16x16x32_bf16 v[160:163], v[228:231], v[20:23], v[160:163]
    ds_read_b64_tr_b16 v[224:225], v17 offset:27680
    v_mfma_f32_16x16x32_bf16 v[164:167], v[228:231], v[24:27], v[164:167]
    ds_read_b64_tr_b16 v[226:227], v17 offset:32288
    s_waitcnt lgkmcnt(10)
    v_mfma_f32_16x16x32_bf16 v[168:171], v[200:203], v[20:23], v[168:171]
    ds_read_b64_tr_b16 v[228:229], v17 offset:27712
    v_mfma_f32_16x16x32_bf16 v[172:175], v[200:203], v[24:27], v[172:175]
    ds_read_b64_tr_b16 v[230:231], v17 offset:32320
    v_mfma_f32_16x16x32_bf16 v[176:179], v[204:207], v[20:23], v[176:179]
    ds_read_b64_tr_b16 v[200:201], v17 offset:27744
    v_mfma_f32_16x16x32_bf16 v[180:183], v[204:207], v[24:27], v[180:183]
    ds_read_b64_tr_b16 v[202:203], v17 offset:32352
    s_waitcnt lgkmcnt(10)
    v_mfma_f32_16x16x32_bf16 v[184:187], v[208:211], v[20:23], v[184:187]
    ds_read_b64_tr_b16 v[204:205], v17 offset:27776
    v_mfma_f32_16x16x32_bf16 v[188:191], v[208:211], v[24:27], v[188:191]
    ds_read_b64_tr_b16 v[206:207], v17 offset:32384
    v_mfma_f32_16x16x32_bf16 v[192:195], v[212:215], v[20:23], v[192:195]
    ds_read_b64_tr_b16 v[208:209], v17 offset:27808
    v_mfma_f32_16x16x32_bf16 v[196:199], v[212:215], v[24:27], v[196:199]
    ds_read_b64_tr_b16 v[210:211], v17 offset:32416
    s_waitcnt lgkmcnt(10)
    v_mfma_f32_16x16x32_bf16 v[232:235], v[216:219], v[20:23], v[232:235]
    ds_read_b64_tr_b16 v[212:213], v17 offset:27840
    v_mfma_f32_16x16x32_bf16 v[236:239], v[216:219], v[24:27], v[236:239]
    ds_read_b64_tr_b16 v[214:215], v17 offset:32448
    v_mfma_f32_16x16x32_bf16 v[136:139], v[220:223], v[28:31], v[136:139]
    ds_read_b64_tr_b16 v[216:217], v17 offset:27872
    v_mfma_f32_16x16x32_bf16 v[140:143], v[220:223], v[32:35], v[140:143]
    ds_read_b64_tr_b16 v[218:219], v17 offset:32480
    s_waitcnt lgkmcnt(10)
    v_mfma_f32_16x16x32_bf16 v[144:147], v[224:227], v[28:31], v[144:147]
    ds_read_b64_tr_b16 v[220:221], v17 offset:27904
    v_mfma_f32_16x16x32_bf16 v[148:151], v[224:227], v[32:35], v[148:151]
    ds_read_b64_tr_b16 v[222:223], v17 offset:32512
    s_setprio 3
    s_andn2_b32 s13, s32, 0x8000
    s_add_u32 s13, s13, 131072
    s_add_u32 m0, s76, 131072
    s_nop 0
    buffer_load_dwordx4 v5, s[52:55], s13 offen offset:0 nt lds
    buffer_load_dwordx4 v5, s[52:55], s13 offen offset:2048 nt lds
    v_xor_b32 v5, 32768, v5
    buffer_load_dwordx4 v5, s[52:55], s13 offen offset:1024 nt lds
    buffer_load_dwordx4 v5, s[52:55], s13 offen offset:3072 nt lds
    s_andn2_b32 s13, s32, 0x8000
    s_add_u32 s13, s13, 135168
    s_add_u32 m0, s76, 135168
    s_nop 0
    buffer_load_dwordx4 v5, s[52:55], s13 offen offset:1024 nt lds
    buffer_load_dwordx4 v5, s[52:55], s13 offen offset:3072 nt lds
    v_xor_b32 v5, 32768, v5
    buffer_load_dwordx4 v5, s[52:55], s13 offen offset:0 nt lds
    buffer_load_dwordx4 v5, s[52:55], s13 offen offset:2048 nt lds
    s_waitcnt vmcnt(8)
    s_waitcnt lgkmcnt(0)
    s_barrier
    s_setprio 3
    v_mfma_f32_16x16x32_bf16 v[152:155], v[228:231], v[28:31], v[152:155]
    ds_read_b64_tr_b16 v[224:225], v17 offset:36864
    v_mfma_f32_16x16x32_bf16 v[156:159], v[228:231], v[32:35], v[156:159]
    ds_read_b64_tr_b16 v[226:227], v17 offset:41472
    v_mfma_f32_16x16x32_bf16 v[160:163], v[200:203], v[28:31], v[160:163]
    ds_read_b64_tr_b16 v[228:229], v17 offset:36896
    v_mfma_f32_16x16x32_bf16 v[164:167], v[200:203], v[32:35], v[164:167]
    ds_read_b64_tr_b16 v[230:231], v17 offset:41504
    v_mfma_f32_16x16x32_bf16 v[168:171], v[204:207], v[28:31], v[168:171]
    ds_read_b64_tr_b16 v[200:201], v17 offset:36928
    v_mfma_f32_16x16x32_bf16 v[172:175], v[204:207], v[32:35], v[172:175]
    ds_read_b64_tr_b16 v[202:203], v17 offset:41536
    v_mfma_f32_16x16x32_bf16 v[176:179], v[208:211], v[28:31], v[176:179]
    ds_read_b64_tr_b16 v[204:205], v17 offset:36960
    v_mfma_f32_16x16x32_bf16 v[180:183], v[208:211], v[32:35], v[180:183]
    ds_read_b64_tr_b16 v[206:207], v17 offset:41568
    v_mfma_f32_16x16x32_bf16 v[184:187], v[212:215], v[28:31], v[184:187]
    ds_read_b64_tr_b16 v[208:209], v17 offset:36992
    v_mfma_f32_16x16x32_bf16 v[188:191], v[212:215], v[32:35], v[188:191]
    ds_read_b64_tr_b16 v[210:211], v17 offset:41600
    v_mfma_f32_16x16x32_bf16 v[192:195], v[216:219], v[28:31], v[192:195]
    ds_read_b64_tr_b16 v[212:213], v17 offset:37024
    v_mfma_f32_16x16x32_bf16 v[196:199], v[216:219], v[32:35], v[196:199]
    ds_read_b64_tr_b16 v[214:215], v17 offset:41632
    v_mfma_f32_16x16x32_bf16 v[232:235], v[220:223], v[28:31], v[232:235]
    ds_read_b64_tr_b16 v[216:217], v17 offset:37056
    v_mfma_f32_16x16x32_bf16 v[236:239], v[220:223], v[32:35], v[236:239]
    ds_read_b64_tr_b16 v[218:219], v17 offset:41664
    s_waitcnt lgkmcnt(10)
    v_mfma_f32_16x16x32_bf16 v[136:139], v[224:227], v[36:39], v[136:139]
    ds_read_b64_tr_b16 v[220:221], v17 offset:37088
    v_mfma_f32_16x16x32_bf16 v[140:143], v[224:227], v[240:243], v[140:143]
    ds_read_b64_tr_b16 v[222:223], v17 offset:41696
    v_mfma_f32_16x16x32_bf16 v[144:147], v[228:231], v[36:39], v[144:147]
    ds_read_b64_tr_b16 v[224:225], v17 offset:37120
    v_mfma_f32_16x16x32_bf16 v[148:151], v[228:231], v[240:243], v[148:151]
    ds_read_b64_tr_b16 v[226:227], v17 offset:41728
    s_waitcnt lgkmcnt(10)
    v_mfma_f32_16x16x32_bf16 v[152:155], v[200:203], v[36:39], v[152:155]
    ds_read_b64_tr_b16 v[228:229], v17 offset:46080
    v_mfma_f32_16x16x32_bf16 v[156:159], v[200:203], v[240:243], v[156:159]
    ds_read_b64_tr_b16 v[230:231], v17 offset:50688
    v_mfma_f32_16x16x32_bf16 v[160:163], v[204:207], v[36:39], v[160:163]
    ds_read_b64_tr_b16 v[200:201], v17 offset:46112
    v_mfma_f32_16x16x32_bf16 v[164:167], v[204:207], v[240:243], v[164:167]
    ds_read_b64_tr_b16 v[202:203], v17 offset:50720
    s_waitcnt lgkmcnt(10)
    v_mfma_f32_16x16x32_bf16 v[168:171], v[208:211], v[36:39], v[168:171]
    ds_read_b64_tr_b16 v[204:205], v17 offset:46144
    v_mfma_f32_16x16x32_bf16 v[172:175], v[208:211], v[240:243], v[172:175]
    ds_read_b64_tr_b16 v[206:207], v17 offset:50752
    v_mfma_f32_16x16x32_bf16 v[176:179], v[212:215], v[36:39], v[176:179]
    ds_read_b64_tr_b16 v[208:209], v17 offset:46176
    v_mfma_f32_16x16x32_bf16 v[180:183], v[212:215], v[240:243], v[180:183]
    ds_read_b64_tr_b16 v[210:211], v17 offset:50784
    s_waitcnt lgkmcnt(10)
    v_mfma_f32_16x16x32_bf16 v[184:187], v[216:219], v[36:39], v[184:187]
    ds_read_b64_tr_b16 v[212:213], v17 offset:46208
    v_mfma_f32_16x16x32_bf16 v[188:191], v[216:219], v[240:243], v[188:191]
    ds_read_b64_tr_b16 v[214:215], v17 offset:50816
    v_mfma_f32_16x16x32_bf16 v[192:195], v[220:223], v[36:39], v[192:195]
    ds_read_b64_tr_b16 v[216:217], v17 offset:46240
    v_mfma_f32_16x16x32_bf16 v[196:199], v[220:223], v[240:243], v[196:199]
    ds_read_b64_tr_b16 v[218:219], v17 offset:50848
    s_waitcnt lgkmcnt(10)
    v_mfma_f32_16x16x32_bf16 v[232:235], v[224:227], v[36:39], v[232:235]
    ds_read_b64_tr_b16 v[220:221], v17 offset:46272
    v_mfma_f32_16x16x32_bf16 v[236:239], v[224:227], v[240:243], v[236:239]
    ds_read_b64_tr_b16 v[222:223], v17 offset:50880
    v_mfma_f32_16x16x32_bf16 v[136:139], v[228:231], v[244:247], v[136:139]
    ds_read_b64_tr_b16 v[224:225], v17 offset:46304
    v_mfma_f32_16x16x32_bf16 v[140:143], v[228:231], v[248:251], v[140:143]
    ds_read_b64_tr_b16 v[226:227], v17 offset:50912
    s_waitcnt lgkmcnt(10)
    v_mfma_f32_16x16x32_bf16 v[144:147], v[200:203], v[244:247], v[144:147]
    ds_read_b64_tr_b16 v[228:229], v17 offset:46336
    v_mfma_f32_16x16x32_bf16 v[148:151], v[200:203], v[248:251], v[148:151]
    ds_read_b64_tr_b16 v[230:231], v17 offset:50944
    v_mfma_f32_16x16x32_bf16 v[152:155], v[204:207], v[244:247], v[152:155]
    v_mfma_f32_16x16x32_bf16 v[156:159], v[204:207], v[248:251], v[156:159]
    s_waitcnt lgkmcnt(8)
    v_mfma_f32_16x16x32_bf16 v[160:163], v[208:211], v[244:247], v[160:163]
    v_mfma_f32_16x16x32_bf16 v[164:167], v[208:211], v[248:251], v[164:167]
    v_mfma_f32_16x16x32_bf16 v[168:171], v[212:215], v[244:247], v[168:171]
    v_mfma_f32_16x16x32_bf16 v[172:175], v[212:215], v[248:251], v[172:175]
    s_waitcnt lgkmcnt(4)
    v_mfma_f32_16x16x32_bf16 v[176:179], v[216:219], v[244:247], v[176:179]
    v_mfma_f32_16x16x32_bf16 v[180:183], v[216:219], v[248:251], v[180:183]
    v_mfma_f32_16x16x32_bf16 v[184:187], v[220:223], v[244:247], v[184:187]
    v_mfma_f32_16x16x32_bf16 v[188:191], v[220:223], v[248:251], v[188:191]
    s_waitcnt lgkmcnt(0)
    v_mfma_f32_16x16x32_bf16 v[192:195], v[224:227], v[244:247], v[192:195]
    v_mfma_f32_16x16x32_bf16 v[196:199], v[224:227], v[248:251], v[196:199]
    v_mfma_f32_16x16x32_bf16 v[232:235], v[228:231], v[244:247], v[232:235]
    v_mfma_f32_16x16x32_bf16 v[236:239], v[228:231], v[248:251], v[236:239]
    s_setprio 3
    s_lshl_b32 s11, s6, 1
    s_add_u32 s11, s11, s4
    s_add_u32 s11, s11, 0
    s_and_b32 s12, s11, 6
    s_lshl_b32 s12, s12, 1
    s_add_u32 s12, s12, s40
    s_lshl_b32 s12, s12, 1
    s_and_b32 s11, s11, 1
    s_add_u32 s11, s11, 4
    s_add_u32 s11, s11, s12
    s_mul_i32 s11, s11, 36864
    s_add_u32 s11, s11, s100
    s_mov_b32 s12, 1024
    s_cmp_eq_u32 s4, 1
    s_cselect_b32 s12, 10240, s12
    s_cmp_eq_u32 s4, 2
    s_cselect_b32 s12, 19456, s12
    s_cmp_eq_u32 s4, 3
    s_cselect_b32 s12, 28672, s12
    s_add_u32 m0, s12, 0
    s_nop 0
    buffer_load_dwordx4 v8, s[60:63], s11 offen offset:0 nt lds
    buffer_load_dwordx4 v9, s[60:63], s11 offen offset:1024 nt lds
    buffer_load_dwordx4 v10, s[60:63], s11 offen offset:2048 nt lds
    buffer_load_dwordx4 v11, s[60:63], s11 offen offset:3072 nt lds
    s_add_u32 s11, s11, 4096
    s_add_u32 m0, s12, 4096
    s_nop 0
    buffer_load_dwordx4 v12, s[60:63], s11 offen offset:0 nt lds
    buffer_load_dwordx4 v13, s[60:63], s11 offen offset:1024 nt lds
    buffer_load_dwordx4 v14, s[60:63], s11 offen offset:2048 nt lds
    buffer_load_dwordx4 v15, s[60:63], s11 offen offset:3072 nt lds
    s_add_u32 s11, s11, 4096
    s_add_u32 m0, s12, 8192
    s_nop 0
    buffer_load_dwordx4 v16, s[60:63], s11 offen offset:0 nt lds
L_wo_12:
    s_mov_b32 s96, 200000
    v_add_u32 v255, 129024, v17
    s_add_u32 s11, s6, 0
    s_and_b32 s11, s11, 3
    s_lshl_b32 s11, s11, 15
    s_add_u32 s11, s11, s98
    s_add_u32 s36, s11, 4096
    s_add_u32 s11, s6, 1
    s_and_b32 s11, s11, 3
    s_lshl_b32 s11, s11, 15
    s_add_u32 s11, s11, s98
    s_add_u32 s37, s11, 4096
    s_add_u32 s11, s6, 2
    s_and_b32 s11, s11, 3
    s_lshl_b32 s11, s11, 15
    s_add_u32 s11, s11, s98
    s_add_u32 s38, s11, 4096
    s_add_u32 s11, s6, 3
    s_and_b32 s11, s11, 3
    s_lshl_b32 s11, s11, 15
    s_add_u32 s11, s11, s98
    s_add_u32 s39, s11, 4096
    s_sub_u32 s14, s36, 4096
    buffer_load_dwordx4 v[40:43], v2, s[68:71], s14 offen offset:0 sc1
    buffer_load_dwordx4 v[44:47], v2, s[68:71], s14 offen offset:1024 sc1
    buffer_load_dwordx4 v[48:51], v2, s[68:71], s14 offen offset:2048 sc1
    buffer_load_dwordx4 v[52:55], v2, s[68:71], s14 offen offset:3072 sc1
    s_sub_u32 s14, s37, 4096
    buffer_load_dwordx4 v[56:59], v2, s[68:71], s14 offen offset:0 sc1
    buffer_load_dwordx4 v[60:63], v2, s[68:71], s14 offen offset:1024 sc1
    buffer_load_dwordx4 v[64:67], v2, s[68:71], s14 offen offset:2048 sc1
    buffer_load_dwordx4 v[68:71], v2, s[68:71], s14 offen offset:3072 sc1
    s_waitcnt vmcnt(8)
    s_waitcnt lgkmcnt(0)
    s_barrier
    s_lshl_b32 s11, s6, 1
    s_add_u32 s11, s11, s4
    s_add_u32 s11, s11, 4
    s_and_b32 s12, s11, 6
    s_lshl_b32 s12, s12, 1
    s_add_u32 s12, s12, s40
    s_lshl_b32 s12, s12, 1
    s_and_b32 s11, s11, 1
    s_add_u32 s11, s11, 4
    s_add_u32 s11, s11, s12
    s_mul_i32 s11, s11, 36864
    s_add_u32 s11, s11, s100
    s_mov_b32 s12, 56320
    s_cmp_eq_u32 s4, 1
    s_cselect_b32 s12, 65536, s12
    s_cmp_eq_u32 s4, 2
    s_cselect_b32 s12, 74752, s12
    s_cmp_eq_u32 s4, 3
    s_cselect_b32 s12, 83968, s12
    s_add_u32 m0, s12, 0
    s_nop 0
    buffer_load_dwordx4 v8, s[60:63], s11 offen offset:0 nt lds
    buffer_load_dwordx4 v9, s[60:63], s11 offen offset:1024 nt lds
    buffer_load_dwordx4 v10, s[60:63], s11 offen offset:2048 nt lds
    buffer_load_dwordx4 v11, s[60:63], s11 offen offset:3072 nt lds
    s_add_u32 s11, s11, 4096
    s_add_u32 m0, s12, 4096
    s_nop 0
    buffer_load_dwordx4 v12, s[60:63], s11 offen offset:0 nt lds
    buffer_load_dwordx4 v13, s[60:63], s11 offen offset:1024 nt lds
    buffer_load_dwordx4 v14, s[60:63], s11 offen offset:2048 nt lds
    buffer_load_dwordx4 v15, s[60:63], s11 offen offset:3072 nt lds
    s_add_u32 s11, s11, 4096
    s_add_u32 m0, s12, 8192
    s_nop 0
    buffer_load_dwordx4 v16, s[60:63], s11 offen offset:0 nt lds
L_wo_13:
    s_sub_u32 s14, s38, 4096
    buffer_load_dwordx4 v[72:75], v2, s[68:71], s14 offen offset:0 sc1
    buffer_load_dwordx4 v[76:79], v2, s[68:71], s14 offen offset:1024 sc1
    buffer_load_dwordx4 v[80:83], v2, s[68:71], s14 offen offset:2048 sc1
    buffer_load_dwordx4 v[84:87], v2, s[68:71], s14 offen offset:3072 sc1
    s_sub_u32 s14, s39, 4096
    buffer_load_dwordx4 v[88:91], v2, s[68:71], s14 offen offset:0 sc1
    buffer_load_dwordx4 v[92:95], v2, s[68:71], s14 offen offset:1024 sc1
    buffer_load_dwordx4 v[96:99], v2, s[68:71], s14 offen offset:2048 sc1
    buffer_load_dwordx4 v[100:103], v2, s[68:71], s14 offen offset:3072 sc1
    s_setprio 1
    ds_read_b64_tr_b16 v[200:201], v17 offset:0
    ds_read_b64_tr_b16 v[202:203], v17 offset:4608
    ds_read_b64_tr_b16 v[204:205], v17 offset:32
    ds_read_b64_tr_b16 v[206:207], v17 offset:4640
    ds_read_b64_tr_b16 v[208:209], v17 offset:64
    ds_read_b64_tr_b16 v[210:211], v17 offset:4672
    ds_read_b64_tr_b16 v[212:213], v17 offset:96
    ds_read_b64_tr_b16 v[214:215], v17 offset:4704
    ds_read_b64_tr_b16 v[216:217], v17 offset:128
    ds_read_b64_tr_b16 v[218:219], v17 offset:4736
    ds_read_b64_tr_b16 v[220:221], v17 offset:160
    ds_read_b64_tr_b16 v[222:223], v17 offset:4768
    ds_read_b64_tr_b16 v[224:225], v17 offset:192
    ds_read_b64_tr_b16 v[226:227], v17 offset:4800
    s_waitcnt vmcnt(21)
L_rva0:
    v_and_b32 v3, v40, v44
    v_and_b32 v3, v3, v48
    v_and_b32 v3, v3, v52
    v_and_b32 v3, 1, v3
    v_cmp_ne_u32 vcc, 1, v3
    s_cbranch_vccnz L_rta0
L_rxa0:
    s_waitcnt lgkmcnt(10)
    v_mfma_f32_16x16x32_bf16 v[136:139], v[200:203], v[40:43], v[136:139]
    ds_read_b64_tr_b16 v[228:229], v17 offset:224
    v_mfma_f32_16x16x32_bf16 v[140:143], v[200:203], v[44:47], v[140:143]
    ds_read_b64_tr_b16 v[230:231], v17 offset:4832
    v_mfma_f32_16x16x32_bf16 v[144:147], v[204:207], v[40:43], v[144:147]
    ds_read_b64_tr_b16 v[200:201], v17 offset:256
    v_mfma_f32_16x16x32_bf16 v[148:151], v[204:207], v[44:47], v[148:151]
    ds_read_b64_tr_b16 v[202:203], v17 offset:4864
    s_waitcnt lgkmcnt(10)
    v_mfma_f32_16x16x32_bf16 v[152:155], v[208:211], v[40:43], v[152:155]
    ds_read_b64_tr_b16 v[204:205], v17 offset:9216
    v_mfma_f32_16x16x32_bf16 v[156:159], v[208:211], v[44:47], v[156:159]
    ds_read_b64_tr_b16 v[206:207], v17 offset:13824
    v_mfma_f32_16x16x32_bf16 v[160:163], v[212:215], v[40:43], v[160:163]
    ds_read_b64_tr_b16 v[208:209], v17 offset:9248
    v_mfma_f32_16x16x32_bf16 v[164:167], v[212:215], v[44:47], v[164:167]
    ds_read_b64_tr_b16 v[210:211], v17 offset:13856
    s_waitcnt lgkmcnt(10)
    v_mfma_f32_16x16x32_bf16 v[168:171], v[216:219], v[40:43], v[168:171]
    ds_read_b64_tr_b16 v[212:213], v17 offset:9280
    v_mfma_f32_16x16x32_bf16 v[172:175], v[216:219], v[44:47], v[172:175]
    ds_read_b64_tr_b16 v[214:215], v17 offset:13888
    v_mfma_f32_16x16x32_bf16 v[176:179], v[220:223], v[40:43], v[176:179]
    ds_read_b64_tr_b16 v[216:217], v17 offset:9312
    v_mfma_f32_16x16x32_bf16 v[180:183], v[220:223], v[44:47], v[180:183]
    ds_read_b64_tr_b16 v[218:219], v17 offset:13920
    s_waitcnt lgkmcnt(10)
    v_mfma_f32_16x16x32_bf16 v[184:187], v[224:227], v[40:43], v[184:187]
    ds_read_b64_tr_b16 v[220:221], v17 offset:9344
    v_mfma_f32_16x16x32_bf16 v[188:191], v[224:227], v[44:47], v[188:191]
    ds_read_b64_tr_b16 v[222:223], v17 offset:13952
    v_mfma_f32_16x16x32_bf16 v[192:195], v[228:231], v[40:43], v[192:195]
    ds_read_b64_tr_b16 v[224:225], v17 offset:9376
    v_mfma_f32_16x16x32_bf16 v[196:199], v[228:231], v[44:47], v[196:199]
    ds_read_b64_tr_b16 v[226:227], v17 offset:13984
    s_waitcnt lgkmcnt(10)
    v_mfma_f32_16x16x32_bf16 v[232:235], v[200:203], v[40:43], v[232:235]
    ds_read_b64_tr_b16 v[228:229], v17 offset:9408
    v_mfma_f32_16x16x32_bf16 v[236:239], v[200:203], v[44:47], v[236:239]
    ds_read_b64_tr_b16 v[230:231], v17 offset:14016
    v_mfma_f32_16x16x32_bf16 v[136:139], v[204:207], v[48:51], v[136:139]
    ds_read_b64_tr_b16 v[200:201], v17 offset:9440
    v_mfma_f32_16x16x32_bf16 v[140:143], v[204:207], v[52:55], v[140:143]
    ds_read_b64_tr_b16 v[202:203], v17 offset:14048
    s_waitcnt lgkmcnt(10)
    v_mfma_f32_16x16x32_bf16 v[144:147], v[208:211], v[48:51], v[144:147]
    ds_read_b64_tr_b16 v[204:205], v17 offset:9472
    v_mfma_f32_16x16x32_bf16 v[148:151], v[208:211], v[52:55], v[148:151]
    ds_read_b64_tr_b16 v[206:207], v17 offset:14080
    v_mfma_f32_16x16x32_bf16 v[152:155], v[212:215], v[48:51], v[152:155]
    ds_read_b64_tr_b16 v[208:209], v17 offset:18432
    v_mfma_f32_16x16x32_bf16 v[156:159], v[212:215], v[52:55], v[156:159]
    ds_read_b64_tr_b16 v[210:211], v17 offset:23040
    s_waitcnt lgkmcnt(10)
    v_mfma_f32_16x16x32_bf16 v[160:163], v[216:219], v[48:51], v[160:163]
    ds_read_b64_tr_b16 v[212:213], v17 offset:18464
    v_mfma_f32_16x16x32_bf16 v[164:167], v[216:219], v[52:55], v[164:167]
    ds_read_b64_tr_b16 v[214:215], v17 offset:23072
    v_mfma_f32_16x16x32_bf16 v[168:171], v[220:223], v[48:51], v[168:171]
    ds_read_b64_tr_b16 v[216:217], v17 offset:18496
    v_mfma_f32_16x16x32_bf16 v[172:175], v[220:223], v[52:55], v[172:175]
    ds_read_b64_tr_b16 v[218:219], v17 offset:23104
    s_waitcnt lgkmcnt(10)
    v_mfma_f32_16x16x32_bf16 v[176:179], v[224:227], v[48:51], v[176:179]
    ds_read_b64_tr_b16 v[220:221], v17 offset:18528
    v_mfma_f32_16x16x32_bf16 v[180:183], v[224:227], v[52:55], v[180:183]
    ds_read_b64_tr_b16 v[222:223], v17 offset:23136
    v_mfma_f32_16x16x32_bf16 v[184:187], v[228:231], v[48:51], v[184:187]
    ds_read_b64_tr_b16 v[224:225], v17 offset:18560
    v_mfma_f32_16x16x32_bf16 v[188:191], v[228:231], v[52:55], v[188:191]
    ds_read_b64_tr_b16 v[226:227], v17 offset:23168
    s_waitcnt lgkmcnt(10)
    v_mfma_f32_16x16x32_bf16 v[192:195], v[200:203], v[48:51], v[192:195]
    ds_read_b64_tr_b16 v[228:229], v17 offset:18592
    v_mfma_f32_16x16x32_bf16 v[196:199], v[200:203], v[52:55], v[196:199]
    ds_read_b64_tr_b16 v[230:231], v17 offset:23200
    v_mfma_f32_16x16x32_bf16 v[232:235], v[204:207], v[48:51], v[232:235]
    ds_read_b64_tr_b16 v[200:201], v17 offset:18624
    v_mfma_f32_16x16x32_bf16 v[236:239], v[204:207], v[52:55], v[236:239]
    ds_read_b64_tr_b16 v[202:203], v17 offset:23232
    s_waitcnt vmcnt(17)
L_rva1:
    v_and_b32 v3, v56, v60
    v_and_b32 v3, v3, v64
    v_and_b32 v3, v3, v68
    v_and_b32 v3, 1, v3
    v_cmp_ne_u32 vcc, 1, v3
    s_cbranch_vccnz L_rta1
L_rxa1:
    s_waitcnt lgkmcnt(10)
    v_mfma_f32_16x16x32_bf16 v[136:139], v[208:211], v[56:59], v[136:139]
    ds_read_b64_tr_b16 v[204:205], v17 offset:18656
    v_mfma_f32_16x16x32_bf16 v[140:143], v[208:211], v[60:63], v[140:143]
    ds_read_b64_tr_b16 v[206:207], v17 offset:23264
    v_mfma_f32_16x16x32_bf16 v[144:147], v[212:215], v[56:59], v[144:147]
    ds_read_b64_tr_b16 v[208:209], v17 offset:18688
    v_mfma_f32_16x16x32_bf16 v[148:151], v[212:215], v[60:63], v[148:151]
    ds_read_b64_tr_b16 v[210:211], v17 offset:23296
    s_waitcnt lgkmcnt(10)
    v_mfma_f32_16x16x32_bf16 v[152:155], v[216:219], v[56:59], v[152:155]
    ds_read_b64_tr_b16 v[212:213], v17 offset:27648
    v_mfma_f32_16x16x32_bf16 v[156:159], v[216:219], v[60:63], v[156:159]
    ds_read_b64_tr_b16 v[214:215], v17 offset:32256
    v_mfma_f32_16x16x32_bf16 v[160:163], v[220:223], v[56:59], v[160:163]
    ds_read_b64_tr_b16 v[216:217], v17 offset:27680
    v_mfma_f32_16x16x32_bf16 v[164:167], v[220:223], v[60:63], v[164:167]
    ds_read_b64_tr_b16 v[218:219], v17 offset:32288
    s_waitcnt lgkmcnt(10)
    v_mfma_f32_16x16x32_bf16 v[168:171], v[224:227], v[56:59], v[168:171]
    ds_read_b64_tr_b16 v[220:221], v17 offset:27712
    v_mfma_f32_16x16x32_bf16 v[172:175], v[224:227], v[60:63], v[172:175]
    ds_read_b64_tr_b16 v[222:223], v17 offset:32320
    v_mfma_f32_16x16x32_bf16 v[176:179], v[228:231], v[56:59], v[176:179]
    ds_read_b64_tr_b16 v[224:225], v17 offset:27744
    v_mfma_f32_16x16x32_bf16 v[180:183], v[228:231], v[60:63], v[180:183]
    ds_read_b64_tr_b16 v[226:227], v17 offset:32352
    s_waitcnt lgkmcnt(10)
    v_mfma_f32_16x16x32_bf16 v[184:187], v[200:203], v[56:59], v[184:187]
    ds_read_b64_tr_b16 v[228:229], v17 offset:27776
    v_mfma_f32_16x16x32_bf16 v[188:191], v[200:203], v[60:63], v[188:191]
    ds_read_b64_tr_b16 v[230:231], v17 offset:32384
    v_mfma_f32_16x16x32_bf16 v[192:195], v[204:207], v[56:59], v[192:195]
    ds_read_b64_tr_b16 v[200:201], v17 offset:27808
    v_mfma_f32_16x16x32_bf16 v[196:199], v[204:207], v[60:63], v[196:199]
    ds_read_b64_tr_b16 v[202:203], v17 offset:32416
    s_waitcnt lgkmcnt(10)
    v_mfma_f32_16x16x32_bf16 v[232:235], v[208:211], v[56:59], v[232:235]
    ds_read_b64_tr_b16 v[204:205], v17 offset:27840
    v_mfma_f32_16x16x32_bf16 v[236:239], v[208:211], v[60:63], v[236:239]
    ds_read_b64_tr_b16 v[206:207], v17 offset:32448
    v_mfma_f32_16x16x32_bf16 v[136:139], v[212:215], v[64:67], v[136:139]
    ds_read_b64_tr_b16 v[208:209], v17 offset:27872
    v_mfma_f32_16x16x32_bf16 v[140:143], v[212:215], v[68:71], v[140:143]
    ds_read_b64_tr_b16 v[210:211], v17 offset:32480
    s_waitcnt lgkmcnt(10)
    v_mfma_f32_16x16x32_bf16 v[144:147], v[216:219], v[64:67], v[144:147]
    ds_read_b64_tr_b16 v[212:213], v17 offset:27904
    v_mfma_f32_16x16x32_bf16 v[148:151], v[216:219], v[68:71], v[148:151]
    ds_read_b64_tr_b16 v[214:215], v17 offset:32512
    s_setprio 3
    s_waitcnt vmcnt(8)
    s_barrier
    s_setprio 1
    v_mfma_f32_16x16x32_bf16 v[152:155], v[220:223], v[64:67], v[152:155]
    ds_read_b64_tr_b16 v[216:217], v17 offset:55296
    v_mfma_f32_16x16x32_bf16 v[156:159], v[220:223], v[68:71], v[156:159]
    ds_read_b64_tr_b16 v[218:219], v17 offset:59904
    s_waitcnt lgkmcnt(10)
    v_mfma_f32_16x16x32_bf16 v[160:163], v[224:227], v[64:67], v[160:163]
    ds_read_b64_tr_b16 v[220:221], v17 offset:55328
    v_mfma_f32_16x16x32_bf16 v[164:167], v[224:227], v[68:71], v[164:167]
    ds_read_b64_tr_b16 v[222:223], v17 offset:59936
    v_mfma_f32_16x16x32_bf16 v[168:171], v[228:231], v[64:67], v[168:171]
    ds_read_b64_tr_b16 v[224:225], v17 offset:55360
    v_mfma_f32_16x16x32_bf16 v[172:175], v[228:231], v[68:71], v[172:175]
    ds_read_b64_tr_b16 v[226:227], v17 offset:59968
    s_waitcnt lgkmcnt(10)
    v_mfma_f32_16x16x32_bf16 v[176:179], v[200:203], v[64:67], v[176:179]
    ds_read_b64_tr_b16 v[228:229], v17 offset:55392
    v_mfma_f32_16x16x32_bf16 v[180:183], v[200:203], v[68:71], v[180:183]
    ds_read_b64_tr_b16 v[230:231], v17 offset:60000
    v_mfma_f32_16x16x32_bf16 v[184:187], v[204:207], v[64:67], v[184:187]
    ds_read_b64_tr_b16 v[200:201], v17 offset:55424
    v_mfma_f32_16x16x32_bf16 v[188:191], v[204:207], v[68:71], v[188:191]
    ds_read_b64_tr_b16 v[202:203], v17 offset:60032
    s_waitcnt lgkmcnt(10)
    v_mfma_f32_16x16x32_bf16 v[192:195], v[208:211], v[64:67], v[192:195]
    ds_read_b64_tr_b16 v[204:205], v17 offset:55456
    v_mfma_f32_16x16x32_bf16 v[196:199], v[208:211], v[68:71], v[196:199]
    ds_read_b64_tr_b16 v[206:207], v17 offset:60064
    v_mfma_f32_16x16x32_bf16 v[232:235], v[212:215], v[64:67], v[232:235]
    ds_read_b64_tr_b16 v[208:209], v17 offset:55488
    v_mfma_f32_16x16x32_bf16 v[236:239], v[212:215], v[68:71], v[236:239]
    ds_read_b64_tr_b16 v[210:211], v17 offset:60096
    s_waitcnt vmcnt(4)
L_rva2:
    v_and_b32 v3, v72, v76
    v_and_b32 v3, v3, v80
    v_and_b32 v3, v3, v84
    v_and_b32 v3, 1, v3
    v_cmp_ne_u32 vcc, 1, v3
    s_cbranch_vccnz L_rta2
L_rxa2:
    s_waitcnt lgkmcnt(10)
    v_mfma_f32_16x16x32_bf16 v[136:139], v[216:219], v[72:75], v[136:139]
    ds_read_b64_tr_b16 v[212:213], v17 offset:55520
    v_mfma_f32_16x16x32_bf16 v[140:143], v[216:219], v[76:79], v[140:143]
    ds_read_b64_tr_b16 v[214:215], v17 offset:60128
    v_mfma_f32_16x16x32_bf16 v[144:147], v[220:223], v[72:75], v[144:147]
    ds_read_b64_tr_b16 v[216:217], v17 offset:55552
    v_mfma_f32_16x16x32_bf16 v[148:151], v[220:223], v[76:79], v[148:151]
    ds_read_b64_tr_b16 v[218:219], v17 offset:60160
    s_waitcnt lgkmcnt(10)
    v_mfma_f32_16x16x32_bf16 v[152:155], v[224:227], v[72:75], v[152:155]
    ds_read_b64_tr_b16 v[220:221], v6 offset:0
    v_mfma_f32_16x16x32_bf16 v[156:159], v[224:227], v[76:79], v[156:159]
    ds_read_b64_tr_b16 v[222:223], v6 offset:4608
    v_mfma_f32_16x16x32_bf16 v[160:163], v[228:231], v[72:75], v[160:163]
    ds_read_b64_tr_b16 v[224:225], v6 offset:32
    v_mfma_f32_16x16x32_bf16 v[164:167], v[228:231], v[76:79], v[164:167]
    ds_read_b64_tr_b16 v[226:227], v6 offset:4640
    s_waitcnt lgkmcnt(10)
    v_mfma_f32_16x16x32_bf16 v[168:171], v[200:203], v[72:75], v[168:171]
    ds_read_b64_tr_b16 v[228:229], v6 offset:64
    v_mfma_f32_16x16x32_bf16 v[172:175], v[200:203], v[76:79], v[172:175]
    ds_read_b64_tr_b16 v[230:231], v6 offset:4672
    buffer_load_dwordx4 v[36:39], v2, s[68:71], s36 offen offset:0 sc1
    v_mfma_f32_16x16x32_bf16 v[176:179], v[204:207], v[72:75], v[176:179]
    ds_read_b64_tr_b16 v[200:201], v6 offset:96
    v_mfma_f32_16x16x32_bf16 v[180:183], v[204:207], v[76:79], v[180:183]
    ds_read_b64_tr_b16 v[202:203], v6 offset:4704
    buffer_load_dwordx4 v[240:243], v2, s[68:71], s36 offen offset:1024 sc1
    s_waitcnt lgkmcnt(10)
    v_mfma_f32_16x16x32_bf16 v[184:187], v[208:211], v[72:75], v[184:187]
    ds_read_b64_tr_b16 v[204:205], v6 offset:128
    v_mfma_f32_16x16x32_bf16 v[188:191], v[208:211], v[76:79], v[188:191]
    ds_read_b64_tr_b16 v[206:207], v6 offset:4736
    buffer_load_dwordx4 v[244:247], v2, s[68:71], s36 offen offset:2048 sc1
    v_mfma_f32_16x16x32_bf16 v[192:195], v[212:215], v[72:75], v[192:195]
    ds_read_b64_tr_b16 v[208:209], v6 offset:160
    v_mfma_f32_16x16x32_bf16 v[196:199], v[212:215], v[76:79], v[196:199]
    ds_read_b64_tr_b16 v[210:211], v6 offset:4768
    buffer_load_dwordx4 v[248:251], v2, s[68:71], s36 offen offset:3072 sc1
    s_waitcnt lgkmcnt(10)
    v_mfma_f32_16x16x32_bf16 v[232:235], v[216:219], v[72:75], v[232:235]
    ds_read_b64_tr_b16 v[212:213], v6 offset:192
    v_mfma_f32_16x16x32_bf16 v[236:239], v[216:219], v[76:79], v[236:239]
    ds_read_b64_tr_b16 v[214:215], v6 offset:4800
    buffer_load_dwordx4 v[104:107], v2, s[68:71], s37 offen offset:0 sc1
    v_mfma_f32_16x16x32_bf16 v[136:139], v[220:223], v[80:83], v[136:139]
    ds_read_b64_tr_b16 v[216:217], v6 offset:224
    v_mfma_f32_16x16x32_bf16 v[140:143], v[220:223], v[84:87], v[140:143]
    ds_read_b64_tr_b16 v[218:219], v6 offset:4832
    buffer_load_dwordx4 v[108:111], v2, s[68:71], s37 offen offset:1024 sc1
    s_waitcnt lgkmcnt(10)
    v_mfma_f32_16x16x32_bf16 v[144:147], v[224:227], v[80:83], v[144:147]
    ds_read_b64_tr_b16 v[220:221], v6 offset:256
    v_mfma_f32_16x16x32_bf16 v[148:151], v[224:227], v[84:87], v[148:151]
    ds_read_b64_tr_b16 v[222:223], v6 offset:4864
    buffer_load_dwordx4 v[112:115], v2, s[68:71], s37 offen offset:2048 sc1
    v_mfma_f32_16x16x32_bf16 v[152:155], v[228:231], v[80:83], v[152:155]
    ds_read_b64_tr_b16 v[224:225], v6 offset:9216
    v_mfma_f32_16x16x32_bf16 v[156:159], v[228:231], v[84:87], v[156:159]
    ds_read_b64_tr_b16 v[226:227], v6 offset:13824
    buffer_load_dwordx4 v[116:119], v2, s[68:71], s37 offen offset:3072 sc1
    s_waitcnt lgkmcnt(10)
    v_mfma_f32_16x16x32_bf16 v[160:163], v[200:203], v[80:83], v[160:163]
    ds_read_b64_tr_b16 v[228:229], v6 offset:9248
    v_mfma_f32_16x16x32_bf16 v[164:167], v[200:203], v[84:87], v[164:167]
    ds_read_b64_tr_b16 v[230:231], v6 offset:13856
    buffer_load_dwordx4 v[120:123], v2, s[68:71], s38 offen offset:0 sc1
    v_mfma_f32_16x16x32_bf16 v[168:171], v[204:207], v[80:83], v[168:171]
    ds_read_b64_tr_b16 v[200:201], v6 offset:9280
    v_mfma_f32_16x16x32_bf16 v[172:175], v[204:207], v[84:87], v[172:175]
    ds_read_b64_tr_b16 v[202:203], v6 offset:13888
    buffer_load_dwordx4 v[124:127], v2, s[68:71], s38 offen offset:1024 sc1
    s_waitcnt lgkmcnt(10)
    v_mfma_f32_16x16x32_bf16 v[176:179], v[208:211], v[80:83], v[176:179]
    ds_read_b64_tr_b16 v[204:205], v6 offset:9312
    v_mfma_f32_16x16x32_bf16 v[180:183], v[208:211], v[84:87], v[180:183]
    ds_read_b64_tr_b16 v[206:207], v6 offset:13920
    buffer_load_dwordx4 v[128:131], v2, s[68:71], s38 offen offset:2048 sc1
    v_mfma_f32_16x16x32_bf16 v[184:187], v[212:215], v[80:83], v[184:187]
    ds_read_b64_tr_b16 v[208:209], v6 offset:9344
    v_mfma_f32_16x16x32_bf16 v[188:191], v[212:215], v[84:87], v[188:191]
    ds_read_b64_tr_b16 v[210:211], v6 offset:13952
    buffer_load_dwordx4 v[132:135], v2, s[68:71], s38 offen offset:3072 sc1
    s_waitcnt lgkmcnt(10)
    v_mfma_f32_16x16x32_bf16 v[192:195], v[216:219], v[80:83], v[192:195]
    ds_read_b64_tr_b16 v[212:213], v6 offset:9376
    v_mfma_f32_16x16x32_bf16 v[196:199], v[216:219], v[84:87], v[196:199]
    ds_read_b64_tr_b16 v[214:215], v6 offset:13984
    buffer_load_dwordx4 v[20:23], v2, s[68:71], s39 offen offset:0 sc1
    v_mfma_f32_16x16x32_bf16 v[232:235], v[220:223], v[80:83], v[232:235]
    ds_read_b64_tr_b16 v[216:217], v6 offset:9408
    v_mfma_f32_16x16x32_bf16 v[236:239], v[220:223], v[84:87], v[236:239]
    ds_read_b64_tr_b16 v[218:219], v6 offset:14016
    s_waitcnt vmcnt(13)
L_rva3:
    v_and_b32 v3, v88, v92
    v_and_b32 v3, v3, v96
    v_and_b32 v3, v3, v100
    v_and_b32 v3, 1, v3
    v_cmp_ne_u32 vcc, 1, v3
    s_cbranch_vccnz L_rta3
L_rxa3:
    buffer_load_dwordx4 v[24:27], v2, s[68:71], s39 offen offset:1024 sc1
    s_waitcnt lgkmcnt(10)
    v_mfma_f32_16x16x32_bf16 v[136:139], v[224:227], v[88:91], v[136:139]
    ds_read_b64_tr_b16 v[220:221], v6 offset:9440
    v_mfma_f32_16x16x32_bf16 v[140:143], v[224:227], v[92:95], v[140:143]
    ds_read_b64_tr_b16 v[222:223], v6 offset:14048
    buffer_load_dwordx4 v[28:31], v2, s[68:71], s39 offen offset:2048 sc1
    v_mfma_f32_16x16x32_bf16 v[144:147], v[228:231], v[88:91], v[144:147]
    ds_read_b64_tr_b16 v[224:225], v6 offset:9472
    v_mfma_f32_16x16x32_bf16 v[148:151], v[228:231], v[92:95], v[148:151]
    ds_read_b64_tr_b16 v[226:227], v6 offset:14080
    buffer_load_dwordx4 v[32:35], v2, s[68:71], s39 offen offset:3072 sc1
    s_waitcnt lgkmcnt(10)
    v_mfma_f32_16x16x32_bf16 v[152:155], v[200:203], v[88:91], v[152:155]
    ds_read_b64_tr_b16 v[228:229], v6 offset:18432
    v_mfma_f32_16x16x32_bf16 v[156:159], v[200:203], v[92:95], v[156:159]
    ds_read_b64_tr_b16 v[230:231], v6 offset:23040
    v_mfma_f32_16x16x32_bf16 v[160:163], v[204:207], v[88:91], v[160:163]
    ds_read_b64_tr_b16 v[200:201], v6 offset:18464
    v_mfma_f32_16x16x32_bf16 v[164:167], v[204:207], v[92:95], v[164:167]
    ds_read_b64_tr_b16 v[202:203], v6 offset:23072
    s_waitcnt lgkmcnt(10)
    v_mfma_f32_16x16x32_bf16 v[168:171], v[208:211], v[88:91], v[168:171]
    ds_read_b64_tr_b16 v[204:205], v6 offset:18496
    v_mfma_f32_16x16x32_bf16 v[172:175], v[208:211], v[92:95], v[172:175]
    ds_read_b64_tr_b16 v[206:207], v6 offset:23104
    v_mfma_f32_16x16x32_bf16 v[176:179], v[212:215], v[88:91], v[176:179]
    ds_read_b64_tr_b16 v[208:209], v6 offset:18528
    v_mfma_f32_16x16x32_bf16 v[180:183], v[212:215], v[92:95], v[180:183]
    ds_read_b64_tr_b16 v[210:211], v6 offset:23136
    s_waitcnt lgkmcnt(10)
    v_mfma_f32_16x16x32_bf16 v[184:187], v[216:219], v[88:91], v[184:187]
    ds_read_b64_tr_b16 v[212:213], v6 offset:18560
    v_mfma_f32_16x16x32_bf16 v[188:191], v[216:219], v[92:95], v[188:191]
    ds_read_b64_tr_b16 v[214:215], v6 offset:23168
    v_mfma_f32_16x16x32_bf16 v[192:195], v[220:223], v[88:91], v[192:195]
    ds_read_b64_tr_b16 v[216:217], v6 offset:18592
    v_mfma_f32_16x16x32_bf16 v[196:199], v[220:223], v[92:95], v[196:199]
    ds_read_b64_tr_b16 v[218:219], v6 offset:23200
    s_waitcnt lgkmcnt(10)
    v_mfma_f32_16x16x32_bf16 v[232:235], v[224:227], v[88:91], v[232:235]
    ds_read_b64_tr_b16 v[220:221], v6 offset:18624
    v_mfma_f32_16x16x32_bf16 v[236:239], v[224:227], v[92:95], v[236:239]
    ds_read_b64_tr_b16 v[222:223], v6 offset:23232
    v_mfma_f32_16x16x32_bf16 v[136:139], v[228:231], v[96:99], v[136:139]
    ds_read_b64_tr_b16 v[224:225], v6 offset:18656
    v_mfma_f32_16x16x32_bf16 v[140:143], v[228:231], v[100:103], v[140:143]
    ds_read_b64_tr_b16 v[226:227], v6 offset:23264
    s_waitcnt lgkmcnt(10)
    v_mfma_f32_16x16x32_bf16 v[144:147], v[200:203], v[96:99], v[144:147]
    ds_read_b64_tr_b16 v[228:229], v6 offset:18688
    v_mfma_f32_16x16x32_bf16 v[148:151], v[200:203], v[100:103], v[148:151]
    ds_read_b64_tr_b16 v[230:231], v6 offset:23296
    s_setprio 3
    s_setprio 1
    s_barrier
    v_mfma_f32_16x16x32_bf16 v[152:155], v[204:207], v[96:99], v[152:155]
    ds_read_b64_tr_b16 v[200:201], v6 offset:27904
    v_mfma_f32_16x16x32_bf16 v[156:159], v[204:207], v[100:103], v[156:159]
    ds_read_b64_tr_b16 v[202:203], v6 offset:32512
    s_waitcnt lgkmcnt(10)
    v_mfma_f32_16x16x32_bf16 v[160:163], v[208:211], v[96:99], v[160:163]
    ds_read_b64_tr_b16 v[204:205], v6 offset:37120
    s_lshl_b32 s25, s94, 2
    s_add_u32 s25, s25, s6
    v_mfma_f32_16x16x32_bf16 v[164:167], v[208:211], v[100:103], v[164:167]
    ds_read_b64_tr_b16 v[206:207], v6 offset:41728
    v_mfma_f32_16x16x32_bf16 v[168:171], v[212:215], v[96:99], v[168:171]
    ds_read_b64_tr_b16 v[208:209], v6 offset:46336
    s_lshl_b32 s25, s25, 2
    s_add_u32 s25, s25, s4
    v_mfma_f32_16x16x32_bf16 v[172:175], v[212:215], v[100:103], v[172:175]
    ds_read_b64_tr_b16 v[210:211], v6 offset:50944
    s_waitcnt lgkmcnt(10)
    v_mfma_f32_16x16x32_bf16 v[176:179], v[216:219], v[96:99], v[176:179]
    ds_read_b64_tr_b16 v[212:213], v6 offset:55552
    s_lshl_b32 s25, s25, 2
    s_add_u32 s25, s25, s8
    v_mfma_f32_16x16x32_bf16 v[180:183], v[216:219], v[100:103], v[180:183]
    ds_read_b64_tr_b16 v[214:215], v6 offset:60160
    v_mfma_f32_16x16x32_bf16 v[184:187], v[220:223], v[96:99], v[184:187]
    ds_read_b64_tr_b16 v[216:217], v17 offset:37120
    s_mul_i32 s25, s25, 12288
    s_add_u32 s25, s25, 33554432
    v_mfma_f32_16x16x32_bf16 v[188:191], v[220:223], v[100:103], v[188:191]
    ds_read_b64_tr_b16 v[218:219], v17 offset:41728
    s_waitcnt lgkmcnt(10)
    v_mfma_f32_16x16x32_bf16 v[192:195], v[224:227], v[96:99], v[192:195]
    ds_read_b64_tr_b16 v[220:221], v17 offset:46336
    v_mfma_f32_16x16x32_bf16 v[196:199], v[224:227], v[100:103], v[196:199]
    ds_read_b64_tr_b16 v[222:223], v17 offset:50944
    v_mfma_f32_16x16x32_bf16 v[232:235], v[228:231], v[96:99], v[232:235]
    ds_read_b64_tr_b16 v[224:225], v255 offset:256
    v_mfma_f32_16x16x32_bf16 v[236:239], v[228:231], v[100:103], v[236:239]
    ds_read_b64_tr_b16 v[226:227], v255 offset:4864
    s_waitcnt vmcnt(0)
L_rvB:
    v_and_b32 v3, v104, v108
    v_and_b32 v3, v3, v112
    v_and_b32 v3, v3, v116
    v_and_b32 v3, v3, v120
    v_and_b32 v3, v3, v124
    v_and_b32 v3, v3, v128
    v_and_b32 v3, v3, v132
    v_and_b32 v3, v3, v20
    v_and_b32 v3, v3, v24
    v_and_b32 v3, v3, v28
    v_and_b32 v3, v3, v32
    v_and_b32 v3, v3, v36
    v_and_b32 v3, v3, v240
    v_and_b32 v3, v3, v244
    v_and_b32 v3, v3, v248
    v_and_b32 v3, 1, v3
    v_cmp_ne_u32 vcc, 1, v3
    s_cbranch_vccnz L_rtB
L_rxB:
    s_cmp_eq_u32 s4, s8
    s_cselect_b64 vcc, -1, 0
    s_waitcnt lgkmcnt(10)
    v_mfma_f32_16x16x32_bf16 v[232:235], v[200:203], v[104:107], v[232:235]
    ds_read_b64_tr_b16 v[228:229], v255 offset:9472
    v_mfma_f32_16x16x32_bf16 v[236:239], v[200:203], v[108:111], v[236:239]
    ds_read_b64_tr_b16 v[230:231], v255 offset:14080
    v_mfma_f32_16x16x32_bf16 v[232:235], v[204:207], v[112:115], v[232:235]
    ds_read_b64_tr_b16 v[200:201], v6 offset:27648
    v_mfma_f32_16x16x32_bf16 v[236:239], v[204:207], v[116:119], v[236:239]
    ds_read_b64_tr_b16 v[202:203], v6 offset:32256
    s_waitcnt lgkmcnt(10)
    v_mfma_f32_16x16x32_bf16 v[232:235], v[208:211], v[120:123], v[232:235]
    ds_read_b64_tr_b16 v[204:205], v6 offset:36864
    v_mov_b32 v43, s92
    v_mov_b32 v47, s92
    v_mfma_f32_16x16x32_bf16 v[236:239], v[208:211], v[124:127], v[236:239]
    ds_read_b64_tr_b16 v[206:207], v6 offset:41472
    v_mfma_f32_16x16x32_bf16 v[232:235], v[212:215], v[128:131], v[232:235]
    ds_read_b64_tr_b16 v[208:209], v6 offset:46080
    v_mov_b32 v51, s92
    v_mov_b32 v55, s92
    v_mfma_f32_16x16x32_bf16 v[236:239], v[212:215], v[132:135], v[236:239]
    ds_read_b64_tr_b16 v[210:211], v6 offset:50688
    s_waitcnt lgkmcnt(10)
    v_mfma_f32_16x16x32_bf16 v[232:235], v[216:219], v[20:23], v[232:235]
    ds_read_b64_tr_b16 v[212:213], v6 offset:55296
    v_mov_b32 v59, s92
    v_mov_b32 v63, s92
    v_mfma_f32_16x16x32_bf16 v[236:239], v[216:219], v[24:27], v[236:239]
    ds_read_b64_tr_b16 v[214:215], v6 offset:59904
    v_mfma_f32_16x16x32_bf16 v[232:235], v[220:223], v[28:31], v[232:235]
    ds_read_b64_tr_b16 v[216:217], v17 offset:36864
    v_mov_b32 v67, s92
    v_mov_b32 v71, s92
    v_mfma_f32_16x16x32_bf16 v[236:239], v[220:223], v[32:35], v[236:239]
    ds_read_b64_tr_b16 v[218:219], v17 offset:41472
    s_waitcnt lgkmcnt(10)
    v_mfma_f32_16x16x32_bf16 v[232:235], v[224:227], v[36:39], v[232:235]
    ds_read_b64_tr_b16 v[220:221], v17 offset:46080
    v_mov_b32 v75, s92
    v_mov_b32 v79, s92
    v_mfma_f32_16x16x32_bf16 v[236:239], v[224:227], v[240:243], v[236:239]
    ds_read_b64_tr_b16 v[222:223], v17 offset:50688
    v_mfma_f32_16x16x32_bf16 v[232:235], v[228:231], v[244:247], v[232:235]
    ds_read_b64_tr_b16 v[224:225], v255 offset:0
    v_mov_b32 v83, s92
    v_mov_b32 v87, s92
    v_mfma_f32_16x16x32_bf16 v[236:239], v[228:231], v[248:251], v[236:239]
    ds_read_b64_tr_b16 v[226:227], v255 offset:4608
    s_waitcnt lgkmcnt(10)
    v_mfma_f32_16x16x32_bf16 v[136:139], v[200:203], v[104:107], v[136:139]
    ds_read_b64_tr_b16 v[228:229], v255 offset:9216
    v_mfma_f32_16x16x32_bf16 v[140:143], v[200:203], v[108:111], v[140:143]
    ds_read_b64_tr_b16 v[230:231], v255 offset:13824
    v_mfma_f32_16x16x32_bf16 v[136:139], v[204:207], v[112:115], v[136:139]
    ds_read_b64_tr_b16 v[200:201], v6 offset:27680
    v_cvt_pk_bf16_f32 v40, v232, v233
    v_cvt_pk_bf16_f32 v52, v234, v235
    v_mfma_f32_16x16x32_bf16 v[140:143], v[204:207], v[116:119], v[140:143]
    ds_read_b64_tr_b16 v[202:203], v6 offset:32288
    s_waitcnt lgkmcnt(10)
    v_mfma_f32_16x16x32_bf16 v[136:139], v[208:211], v[120:123], v[136:139]
    ds_read_b64_tr_b16 v[204:205], v6 offset:36896
    v_cvt_pk_bf16_f32 v64, v236, v237
    v_cvt_pk_bf16_f32 v76, v238, v239
    v_mfma_f32_16x16x32_bf16 v[140:143], v[208:211], v[124:127], v[140:143]
    ds_read_b64_tr_b16 v[206:207], v6 offset:41504
    v_mfma_f32_16x16x32_bf16 v[136:139], v[212:215], v[128:131], v[136:139]
    ds_read_b64_tr_b16 v[208:209], v6 offset:46112
    v_mfma_f32_16x16x32_bf16 v[140:143], v[212:215], v[132:135], v[140:143]
    ds_read_b64_tr_b16 v[210:211], v6 offset:50720
    s_waitcnt lgkmcnt(10)
    v_mfma_f32_16x16x32_bf16 v[136:139], v[216:219], v[20:23], v[136:139]
    ds_read_b64_tr_b16 v[212:213], v6 offset:55328
    v_mfma_f32_16x16x32_bf16 v[140:143], v[216:219], v[24:27], v[140:143]
    ds_read_b64_tr_b16 v[214:215], v6 offset:59936
    v_mfma_f32_16x16x32_bf16 v[136:139], v[220:223], v[28:31], v[136:139]
    ds_read_b64_tr_b16 v[216:217], v17 offset:36896
    v_mfma_f32_16x16x32_bf16 v[140:143], v[220:223], v[32:35], v[140:143]
    ds_read_b64_tr_b16 v[218:219], v17 offset:41504
    s_waitcnt lgkmcnt(10)
    v_mfma_f32_16x16x32_bf16 v[136:139], v[224:227], v[36:39], v[136:139]
    ds_read_b64_tr_b16 v[220:221], v17 offset:46112
    v_mfma_f32_16x16x32_bf16 v[140:143], v[224:227], v[240:243], v[140:143]
    ds_read_b64_tr_b16 v[222:223], v17 offset:50720
    v_mfma_f32_16x16x32_bf16 v[136:139], v[228:231], v[244:247], v[136:139]
    ds_read_b64_tr_b16 v[224:225], v255 offset:32
    v_mfma_f32_16x16x32_bf16 v[140:143], v[228:231], v[248:251], v[140:143]
    ds_read_b64_tr_b16 v[226:227], v255 offset:4640
    s_waitcnt lgkmcnt(10)
    v_mfma_f32_16x16x32_bf16 v[144:147], v[200:203], v[104:107], v[144:147]
    ds_read_b64_tr_b16 v[228:229], v255 offset:9248
    v_mfma_f32_16x16x32_bf16 v[148:151], v[200:203], v[108:111], v[148:151]
    ds_read_b64_tr_b16 v[230:231], v255 offset:13856
    v_mfma_f32_16x16x32_bf16 v[144:147], v[204:207], v[112:115], v[144:147]
    ds_read_b64_tr_b16 v[200:201], v6 offset:27712
    v_cvt_pk_bf16_f32 v41, v136, v137
    v_cvt_pk_bf16_f32 v42, v138, v139
    v_mfma_f32_16x16x32_bf16 v[148:151], v[204:207], v[116:119], v[148:151]
    ds_read_b64_tr_b16 v[202:203], v6 offset:32320
    s_cbranch_vccnz L_st_14
    buffer_store_dwordx4 v[40:43], v2, s[68:71], s25 offen offset:0 sc1
L_st_14:
    s_waitcnt lgkmcnt(10)
    v_mfma_f32_16x16x32_bf16 v[144:147], v[208:211], v[120:123], v[144:147]
    ds_read_b64_tr_b16 v[204:205], v6 offset:36928
    v_cvt_pk_bf16_f32 v44, v140, v141
    v_cvt_pk_bf16_f32 v45, v142, v143
    v_mfma_f32_16x16x32_bf16 v[148:151], v[208:211], v[124:127], v[148:151]
    ds_read_b64_tr_b16 v[206:207], v6 offset:41536
    v_mfma_f32_16x16x32_bf16 v[144:147], v[212:215], v[128:131], v[144:147]
    ds_read_b64_tr_b16 v[208:209], v6 offset:46144
    v_mfma_f32_16x16x32_bf16 v[148:151], v[212:215], v[132:135], v[148:151]
    ds_read_b64_tr_b16 v[210:211], v6 offset:50752
    s_waitcnt lgkmcnt(10)
    v_mfma_f32_16x16x32_bf16 v[144:147], v[216:219], v[20:23], v[144:147]
    ds_read_b64_tr_b16 v[212:213], v6 offset:55360
    v_mfma_f32_16x16x32_bf16 v[148:151], v[216:219], v[24:27], v[148:151]
    ds_read_b64_tr_b16 v[214:215], v6 offset:59968
    v_mfma_f32_16x16x32_bf16 v[144:147], v[220:223], v[28:31], v[144:147]
    ds_read_b64_tr_b16 v[216:217], v17 offset:36928
    v_mfma_f32_16x16x32_bf16 v[148:151], v[220:223], v[32:35], v[148:151]
    ds_read_b64_tr_b16 v[218:219], v17 offset:41536
    s_waitcnt lgkmcnt(10)
    v_mfma_f32_16x16x32_bf16 v[144:147], v[224:227], v[36:39], v[144:147]
    ds_read_b64_tr_b16 v[220:221], v17 offset:46144
    v_mfma_f32_16x16x32_bf16 v[148:151], v[224:227], v[240:243], v[148:151]
    ds_read_b64_tr_b16 v[222:223], v17 offset:50752
    v_mfma_f32_16x16x32_bf16 v[144:147], v[228:231], v[244:247], v[144:147]
    ds_read_b64_tr_b16 v[224:225], v255 offset:64
    v_mfma_f32_16x16x32_bf16 v[148:151], v[228:231], v[248:251], v[148:151]
    ds_read_b64_tr_b16 v[226:227], v255 offset:4672
    s_waitcnt lgkmcnt(10)
    v_mfma_f32_16x16x32_bf16 v[152:155], v[200:203], v[104:107], v[152:155]
    ds_read_b64_tr_b16 v[228:229], v255 offset:9280
    v_mfma_f32_16x16x32_bf16 v[156:159], v[200:203], v[108:111], v[156:159]
    ds_read_b64_tr_b16 v[230:231], v255 offset:13888
    v_mfma_f32_16x16x32_bf16 v[152:155], v[204:207], v[112:115], v[152:155]
    ds_read_b64_tr_b16 v[200:201], v6 offset:27744
    v_cvt_pk_bf16_f32 v46, v144, v145
    v_cvt_pk_bf16_f32 v48, v146, v147
    v_mfma_f32_16x16x32_bf16 v[156:159], v[204:207], v[116:119], v[156:159]
    ds_read_b64_tr_b16 v[202:203], v6 offset:32352
    s_cbranch_vccnz L_st_15
    buffer_store_dwordx4 v[44:47], v2, s[68:71], s25 offen offset:1024 sc1
L_st_15:
    s_waitcnt lgkmcnt(10)
    v_mfma_f32_16x16x32_bf16 v[152:155], v[208:211], v[120:123], v[152:155]
    ds_read_b64_tr_b16 v[204:205], v6 offset:36960
    v_cvt_pk_bf16_f32 v49, v148, v149
    v_cvt_pk_bf16_f32 v50, v150, v151
    v_mfma_f32_16x16x32_bf16 v[156:159], v[208:211], v[124:127], v[156:159]
    ds_read_b64_tr_b16 v[206:207], v6 offset:41568
    s_cbranch_vccnz L_st_16
    buffer_store_dwordx4 v[48:51], v2, s[68:71], s25 offen offset:2048 sc1
    buffer_store_dword v87, off, s[68:71], s41 offset:0 sc1
L_st_16:
    v_mfma_f32_16x16x32_bf16 v[152:155], v[212:215], v[128:131], v[152:155]
    ds_read_b64_tr_b16 v[208:209], v6 offset:46176
    v_mfma_f32_16x16x32_bf16 v[156:159], v[212:215], v[132:135], v[156:159]
    ds_read_b64_tr_b16 v[210:211], v6 offset:50784
    s_waitcnt lgkmcnt(10)
    v_mfma_f32_16x16x32_bf16 v[152:155], v[216:219], v[20:23], v[152:155]
    ds_read_b64_tr_b16 v[212:213], v6 offset:55392
    v_mfma_f32_16x16x32_bf16 v[156:159], v[216:219], v[24:27], v[156:159]
    ds_read_b64_tr_b16 v[214:215], v6 offset:60000
    v_mfma_f32_16x16x32_bf16 v[152:155], v[220:223], v[28:31], v[152:155]
    ds_read_b64_tr_b16 v[216:217], v17 offset:36960
    v_mfma_f32_16x16x32_bf16 v[156:159], v[220:223], v[32:35], v[156:159]
    ds_read_b64_tr_b16 v[218:219], v17 offset:41568
    s_waitcnt lgkmcnt(10)
    v_mfma_f32_16x16x32_bf16 v[152:155], v[224:227], v[36:39], v[152:155]
    ds_read_b64_tr_b16 v[220:221], v17 offset:46176
    v_mfma_f32_16x16x32_bf16 v[156:159], v[224:227], v[240:243], v[156:159]
    ds_read_b64_tr_b16 v[222:223], v17 offset:50784
    v_mfma_f32_16x16x32_bf16 v[152:155], v[228:231], v[244:247], v[152:155]
    ds_read_b64_tr_b16 v[224:225], v255 offset:96
    v_mfma_f32_16x16x32_bf16 v[156:159], v[228:231], v[248:251], v[156:159]
    ds_read_b64_tr_b16 v[226:227], v255 offset:4704
    s_waitcnt lgkmcnt(10)
    v_mfma_f32_16x16x32_bf16 v[160:163], v[200:203], v[104:107], v[160:163]
    ds_read_b64_tr_b16 v[228:229], v255 offset:9312
    v_mfma_f32_16x16x32_bf16 v[164:167], v[200:203], v[108:111], v[164:167]
    ds_read_b64_tr_b16 v[230:231], v255 offset:13920
    v_mfma_f32_16x16x32_bf16 v[160:163], v[204:207], v[112:115], v[160:163]
    ds_read_b64_tr_b16 v[200:201], v6 offset:27776
    v_cvt_pk_bf16_f32 v53, v152, v153
    v_cvt_pk_bf16_f32 v54, v154, v155
    v_mfma_f32_16x16x32_bf16 v[164:167], v[204:207], v[116:119], v[164:167]
    ds_read_b64_tr_b16 v[202:203], v6 offset:32384
    s_cbranch_vccnz L_st_17
    buffer_store_dwordx4 v[52:55], v2, s[68:71], s25 offen offset:3072 sc1
L_st_17:
    s_waitcnt lgkmcnt(10)
    v_mfma_f32_16x16x32_bf16 v[160:163], v[208:211], v[120:123], v[160:163]
    ds_read_b64_tr_b16 v[204:205], v6 offset:36992
    v_cvt_pk_bf16_f32 v56, v156, v157
    v_cvt_pk_bf16_f32 v57, v158, v159
    v_mfma_f32_16x16x32_bf16 v[164:167], v[208:211], v[124:127], v[164:167]
    ds_read_b64_tr_b16 v[206:207], v6 offset:41600
    v_mfma_f32_16x16x32_bf16 v[160:163], v[212:215], v[128:131], v[160:163]
    ds_read_b64_tr_b16 v[208:209], v6 offset:46208
    v_mfma_f32_16x16x32_bf16 v[164:167], v[212:215], v[132:135], v[164:167]
    ds_read_b64_tr_b16 v[210:211], v6 offset:50816
    s_waitcnt lgkmcnt(10)
    v_mfma_f32_16x16x32_bf16 v[160:163], v[216:219], v[20:23], v[160:163]
    ds_read_b64_tr_b16 v[212:213], v6 offset:55424
    v_mfma_f32_16x16x32_bf16 v[164:167], v[216:219], v[24:27], v[164:167]
    ds_read_b64_tr_b16 v[214:215], v6 offset:60032
    v_mfma_f32_16x16x32_bf16 v[160:163], v[220:223], v[28:31], v[160:163]
    ds_read_b64_tr_b16 v[216:217], v17 offset:36992
    v_mfma_f32_16x16x32_bf16 v[164:167], v[220:223], v[32:35], v[164:167]
    ds_read_b64_tr_b16 v[218:219], v17 offset:41600
    s_waitcnt lgkmcnt(10)
    v_mfma_f32_16x16x32_bf16 v[160:163], v[224:227], v[36:39], v[160:163]
    ds_read_b64_tr_b16 v[220:221], v17 offset:46208
    v_mfma_f32_16x16x32_bf16 v[164:167], v[224:227], v[240:243], v[164:167]
    ds_read_b64_tr_b16 v[222:223], v17 offset:50816
    v_mfma_f32_16x16x32_bf16 v[160:163], v[228:231], v[244:247], v[160:163]
    ds_read_b64_tr_b16 v[224:225], v255 offset:128
    v_mfma_f32_16x16x32_bf16 v[164:167], v[228:231], v[248:251], v[164:167]
    ds_read_b64_tr_b16 v[226:227], v255 offset:4736
    s_waitcnt lgkmcnt(10)
    v_mfma_f32_16x16x32_bf16 v[168:171], v[200:203], v[104:107], v[168:171]
    ds_read_b64_tr_b16 v[228:229], v255 offset:9344
    v_mfma_f32_16x16x32_bf16 v[172:175], v[200:203], v[108:111], v[172:175]
    ds_read_b64_tr_b16 v[230:231], v255 offset:13952
    v_mfma_f32_16x16x32_bf16 v[168:171], v[204:207], v[112:115], v[168:171]
    ds_read_b64_tr_b16 v[200:201], v6 offset:27808
    v_cvt_pk_bf16_f32 v58, v160, v161
    v_cvt_pk_bf16_f32 v60, v162, v163
    v_mfma_f32_16x16x32_bf16 v[172:175], v[204:207], v[116:119], v[172:175]
    ds_read_b64_tr_b16 v[202:203], v6 offset:32416
    s_add_u32 s25, s25, 4096
    s_cbranch_vccnz L_st_18
    buffer_store_dwordx4 v[56:59], v2, s[68:71], s25 offen offset:0 sc1
L_st_18:
    s_waitcnt lgkmcnt(10)
    v_mfma_f32_16x16x32_bf16 v[168:171], v[208:211], v[120:123], v[168:171]
    ds_read_b64_tr_b16 v[204:205], v6 offset:37024
    v_cvt_pk_bf16_f32 v61, v164, v165
    v_cvt_pk_bf16_f32 v62, v166, v167
    v_mfma_f32_16x16x32_bf16 v[172:175], v[208:211], v[124:127], v[172:175]
    ds_read_b64_tr_b16 v[206:207], v6 offset:41632
    s_cbranch_vccnz L_st_19
    buffer_store_dwordx4 v[60:63], v2, s[68:71], s25 offen offset:1024 sc1
    buffer_store_dword v87, off, s[68:71], s41 offset:4 sc1
L_st_19:
    v_mfma_f32_16x16x32_bf16 v[168:171], v[212:215], v[128:131], v[168:171]
    ds_read_b64_tr_b16 v[208:209], v6 offset:46240
    v_mfma_f32_16x16x32_bf16 v[172:175], v[212:215], v[132:135], v[172:175]
    ds_read_b64_tr_b16 v[210:211], v6 offset:50848
    s_waitcnt lgkmcnt(10)
    v_mfma_f32_16x16x32_bf16 v[168:171], v[216:219], v[20:23], v[168:171]
    ds_read_b64_tr_b16 v[212:213], v6 offset:55456
    v_mfma_f32_16x16x32_bf16 v[172:175], v[216:219], v[24:27], v[172:175]
    ds_read_b64_tr_b16 v[214:215], v6 offset:60064
    v_mfma_f32_16x16x32_bf16 v[168:171], v[220:223], v[28:31], v[168:171]
    ds_read_b64_tr_b16 v[216:217], v17 offset:37024
    v_mfma_f32_16x16x32_bf16 v[172:175], v[220:223], v[32:35], v[172:175]
    ds_read_b64_tr_b16 v[218:219], v17 offset:41632
    s_waitcnt lgkmcnt(10)
    v_mfma_f32_16x16x32_bf16 v[168:171], v[224:227], v[36:39], v[168:171]
    ds_read_b64_tr_b16 v[220:221], v17 offset:46240
    v_mfma_f32_16x16x32_bf16 v[172:175], v[224:227], v[240:243], v[172:175]
    ds_read_b64_tr_b16 v[222:223], v17 offset:50848
    v_mfma_f32_16x16x32_bf16 v[168:171], v[228:231], v[244:247], v[168:171]
    ds_read_b64_tr_b16 v[224:225], v255 offset:160
    v_mfma_f32_16x16x32_bf16 v[172:175], v[228:231], v[248:251], v[172:175]
    ds_read_b64_tr_b16 v[226:227], v255 offset:4768
    s_waitcnt lgkmcnt(10)
    v_mfma_f32_16x16x32_bf16 v[176:179], v[200:203], v[104:107], v[176:179]
    ds_read_b64_tr_b16 v[228:229], v255 offset:9376
    v_mfma_f32_16x16x32_bf16 v[180:183], v[200:203], v[108:111], v[180:183]
    ds_read_b64_tr_b16 v[230:231], v255 offset:13984
    v_mfma_f32_16x16x32_bf16 v[176:179], v[204:207], v[112:115], v[176:179]
    ds_read_b64_tr_b16 v[200:201], v6 offset:27840
    v_cvt_pk_bf16_f32 v65, v168, v169
    v_cvt_pk_bf16_f32 v66, v170, v171
    v_mfma_f32_16x16x32_bf16 v[180:183], v[204:207], v[116:119], v[180:183]
    ds_read_b64_tr_b16 v[202:203], v6 offset:32448
    s_cbranch_vccnz L_st_20
    buffer_store_dwordx4 v[64:67], v2, s[68:71], s25 offen offset:2048 sc1
L_st_20:
    s_waitcnt lgkmcnt(10)
    v_mfma_f32_16x16x32_bf16 v[176:179], v[208:211], v[120:123], v[176:179]
    ds_read_b64_tr_b16 v[204:205], v6 offset:37056
    v_cvt_pk_bf16_f32 v68, v172, v173
    v_cvt_pk_bf16_f32 v69, v174, v175
    v_mfma_f32_16x16x32_bf16 v[180:183], v[208:211], v[124:127], v[180:183]
    ds_read_b64_tr_b16 v[206:207], v6 offset:41664
    v_mfma_f32_16x16x32_bf16 v[176:179], v[212:215], v[128:131], v[176:179]
    ds_read_b64_tr_b16 v[208:209], v6 offset:46272
    v_mfma_f32_16x16x32_bf16 v[180:183], v[212:215], v[132:135], v[180:183]
    ds_read_b64_tr_b16 v[210:211], v6 offset:50880
    s_waitcnt lgkmcnt(10)
    v_mfma_f32_16x16x32_bf16 v[176:179], v[216:219], v[20:23], v[176:179]
    ds_read_b64_tr_b16 v[212:213], v6 offset:55488
    v_mfma_f32_16x16x32_bf16 v[180:183], v[216:219], v[24:27], v[180:183]
    ds_read_b64_tr_b16 v[214:215], v6 offset:60096
    v_mfma_f32_16x16x32_bf16 v[176:179], v[220:223], v[28:31], v[176:179]
    ds_read_b64_tr_b16 v[216:217], v17 offset:37056
    v_mfma_f32_16x16x32_bf16 v[180:183], v[220:223], v[32:35], v[180:183]
    ds_read_b64_tr_b16 v[218:219], v17 offset:41664
    s_waitcnt lgkmcnt(10)
    v_mfma_f32_16x16x32_bf16 v[176:179], v[224:227], v[36:39], v[176:179]
    ds_read_b64_tr_b16 v[220:221], v17 offset:46272
    v_mfma_f32_16x16x32_bf16 v[180:183], v[224:227], v[240:243], v[180:183]
    ds_read_b64_tr_b16 v[222:223], v17 offset:50880
    v_mfma_f32_16x16x32_bf16 v[176:179], v[228:231], v[244:247], v[176:179]
    ds_read_b64_tr_b16 v[224:225], v255 offset:192
    v_mfma_f32_16x16x32_bf16 v[180:183], v[228:231], v[248:251], v[180:183]
    ds_read_b64_tr_b16 v[226:227], v255 offset:4800
    s_waitcnt lgkmcnt(10)
    v_mfma_f32_16x16x32_bf16 v[184:187], v[200:203], v[104:107], v[184:187]
    ds_read_b64_tr_b16 v[228:229], v255 offset:9408
    v_mfma_f32_16x16x32_bf16 v[188:191], v[200:203], v[108:111], v[188:191]
    ds_read_b64_tr_b16 v[230:231], v255 offset:14016
    v_mfma_f32_16x16x32_bf16 v[184:187], v[204:207], v[112:115], v[184:187]
    ds_read_b64_tr_b16 v[200:201], v6 offset:27872
    v_cvt_pk_bf16_f32 v70, v176, v177
    v_cvt_pk_bf16_f32 v72, v178, v179
    v_mfma_f32_16x16x32_bf16 v[188:191], v[204:207], v[116:119], v[188:191]
    ds_read_b64_tr_b16 v[202:203], v6 offset:32480
    s_cbranch_vccnz L_st_21
    buffer_store_dwordx4 v[68:71], v2, s[68:71], s25 offen offset:3072 sc1
L_st_21:
    s_waitcnt lgkmcnt(10)
    v_mfma_f32_16x16x32_bf16 v[184:187], v[208:211], v[120:123], v[184:187]
    ds_read_b64_tr_b16 v[204:205], v6 offset:37088
    v_cvt_pk_bf16_f32 v73, v180, v181
    v_cvt_pk_bf16_f32 v74, v182, v183
    v_mfma_f32_16x16x32_bf16 v[188:191], v[208:211], v[124:127], v[188:191]
    ds_read_b64_tr_b16 v[206:207], v6 offset:41696
    s_add_u32 s25, s25, 4096
    s_cbranch_vccnz L_st_22
    buffer_store_dwordx4 v[72:75], v2, s[68:71], s25 offen offset:0 sc1
    buffer_store_dword v87, off, s[68:71], s41 offset:8 sc1
L_st_22:
    v_mfma_f32_16x16x32_bf16 v[184:187], v[212:215], v[128:131], v[184:187]
    ds_read_b64_tr_b16 v[208:209], v6 offset:46304
    v_mfma_f32_16x16x32_bf16 v[188:191], v[212:215], v[132:135], v[188:191]
    ds_read_b64_tr_b16 v[210:211], v6 offset:50912
    s_waitcnt lgkmcnt(10)
    v_mfma_f32_16x16x32_bf16 v[184:187], v[216:219], v[20:23], v[184:187]
    ds_read_b64_tr_b16 v[212:213], v6 offset:55520
    v_mfma_f32_16x16x32_bf16 v[188:191], v[216:219], v[24:27], v[188:191]
    ds_read_b64_tr_b16 v[214:215], v6 offset:60128
    v_mfma_f32_16x16x32_bf16 v[184:187], v[220:223], v[28:31], v[184:187]
    ds_read_b64_tr_b16 v[216:217], v17 offset:37088
    v_mfma_f32_16x16x32_bf16 v[188:191], v[220:223], v[32:35], v[188:191]
    ds_read_b64_tr_b16 v[218:219], v17 offset:41696
    s_waitcnt lgkmcnt(10)
    v_mfma_f32_16x16x32_bf16 v[184:187], v[224:227], v[36:39], v[184:187]
    ds_read_b64_tr_b16 v[220:221], v17 offset:46304
    v_mfma_f32_16x16x32_bf16 v[188:191], v[224:227], v[240:243], v[188:191]
    ds_read_b64_tr_b16 v[222:223], v17 offset:50912
    v_mfma_f32_16x16x32_bf16 v[184:187], v[228:231], v[244:247], v[184:187]
    ds_read_b64_tr_b16 v[224:225], v255 offset:224
    v_mfma_f32_16x16x32_bf16 v[188:191], v[228:231], v[248:251], v[188:191]
    ds_read_b64_tr_b16 v[226:227], v255 offset:4832
    s_waitcnt lgkmcnt(10)
    v_mfma_f32_16x16x32_bf16 v[192:195], v[200:203], v[104:107], v[192:195]
    ds_read_b64_tr_b16 v[228:229], v255 offset:9440
    v_mfma_f32_16x16x32_bf16 v[196:199], v[200:203], v[108:111], v[196:199]
    ds_read_b64_tr_b16 v[230:231], v255 offset:14048
    v_mfma_f32_16x16x32_bf16 v[192:195], v[204:207], v[112:115], v[192:195]
    v_cvt_pk_bf16_f32 v77, v184, v185
    v_cvt_pk_bf16_f32 v78, v186, v187
    v_mfma_f32_16x16x32_bf16 v[196:199], v[204:207], v[116:119], v[196:199]
    s_cbranch_vccnz L_st_23
    buffer_store_dwordx4 v[76:79], v2, s[68:71], s25 offen offset:1024 sc1
L_st_23:
    s_waitcnt lgkmcnt(8)
    v_mfma_f32_16x16x32_bf16 v[192:195], v[208:211], v[120:123], v[192:195]
    v_cvt_pk_bf16_f32 v80, v188, v189
    v_cvt_pk_bf16_f32 v81, v190, v191
    v_mfma_f32_16x16x32_bf16 v[196:199], v[208:211], v[124:127], v[196:199]
    v_mfma_f32_16x16x32_bf16 v[192:195], v[212:215], v[128:131], v[192:195]
    v_mfma_f32_16x16x32_bf16 v[196:199], v[212:215], v[132:135], v[196:199]
    s_waitcnt lgkmcnt(4)
    v_mfma_f32_16x16x32_bf16 v[192:195], v[216:219], v[20:23], v[192:195]
    v_mfma_f32_16x16x32_bf16 v[196:199], v[216:219], v[24:27], v[196:199]
    v_mfma_f32_16x16x32_bf16 v[192:195], v[220:223], v[28:31], v[192:195]
    v_mfma_f32_16x16x32_bf16 v[196:199], v[220:223], v[32:35], v[196:199]
    s_waitcnt lgkmcnt(0)
    v_mfma_f32_16x16x32_bf16 v[192:195], v[224:227], v[36:39], v[192:195]
    v_mfma_f32_16x16x32_bf16 v[196:199], v[224:227], v[240:243], v[196:199]
    v_mfma_f32_16x16x32_bf16 v[192:195], v[228:231], v[244:247], v[192:195]
    v_mfma_f32_16x16x32_bf16 v[196:199], v[228:231], v[248:251], v[196:199]
    s_nop 6
    v_cvt_pk_bf16_f32 v82, v192, v193
    v_cvt_pk_bf16_f32 v84, v194, v195
    s_cbranch_vccnz L_st_24
    buffer_store_dwordx4 v[80:83], v2, s[68:71], s25 offen offset:2048 sc1
L_st_24:
    v_cvt_pk_bf16_f32 v85, v196, v197
    v_cvt_pk_bf16_f32 v86, v198, v199
    s_cbranch_vccnz L_st_25
    buffer_store_dwordx4 v[84:87], v2, s[68:71], s25 offen offset:3072 sc1
    buffer_store_dword v87, off, s[68:71], s41 offset:12 sc1
L_st_25:
    s_cbranch_vccz L_fin
    v_add_u32 v3, 148480, v2
    ds_write_b128 v3, v[40:43] offset:0
    ds_write_b128 v3, v[44:47] offset:1024
    ds_write_b128 v3, v[48:51] offset:2048
    ds_write_b128 v3, v[52:55] offset:3072
    ds_write_b128 v3, v[56:59] offset:4096
    ds_write_b128 v3, v[60:63] offset:5120
    ds_write_b128 v3, v[64:67] offset:6144
    ds_write_b128 v3, v[68:71] offset:7168
    ds_write_b128 v3, v[72:75] offset:8192
    ds_write_b128 v3, v[76:79] offset:9216
    ds_write_b128 v3, v[80:83] offset:10240
    ds_write_b128 v3, v[84:87] offset:11264
    s_waitcnt lgkmcnt(0)
L_fin:
L_end:
    s_endpgm
L_k2:
    s_nop 0
    s_waitcnt lgkmcnt(5)
    v_mfma_f32_16x16x32_bf16 v[72:75], v[200:203], v[40:43], v[16:19]
    v_mfma_f32_16x16x32_bf16 v[80:83], v[200:203], v[44:47], v[20:23]
    ds_read_b128 v[228:231], v7 offset:4096
    v_mfma_f32_16x16x32_bf16 v[72:75], v[204:207], v[48:51], v[72:75]
    v_mfma_f32_16x16x32_bf16 v[80:83], v[204:207], v[52:55], v[80:83]
    ds_read_b128 v[200:203], v4 offset:8192
    s_waitcnt lgkmcnt(5)
    v_mfma_f32_16x16x32_bf16 v[72:75], v[208:211], v[56:59], v[72:75]
    v_mfma_f32_16x16x32_bf16 v[80:83], v[208:211], v[60:63], v[80:83]
    ds_read_b128 v[204:207], v5 offset:8192
    v_mfma_f32_16x16x32_bf16 v[72:75], v[212:215], v[64:67], v[72:75]
    v_mfma_f32_16x16x32_bf16 v[80:83], v[212:215], v[68:71], v[80:83]
    ds_read_b128 v[208:211], v6 offset:8192
    s_waitcnt lgkmcnt(5)
    v_mfma_f32_16x16x32_bf16 v[76:79], v[216:219], v[40:43], v[16:19]
    v_mfma_f32_16x16x32_bf16 v[84:87], v[216:219], v[44:47], v[20:23]
    ds_read_b128 v[212:215], v7 offset:8192
    v_mfma_f32_16x16x32_bf16 v[76:79], v[220:223], v[48:51], v[76:79]
    v_mfma_f32_16x16x32_bf16 v[84:87], v[220:223], v[52:55], v[84:87]
    ds_read_b128 v[216:219], v4 offset:12288
    s_waitcnt lgkmcnt(5)
    v_mfma_f32_16x16x32_bf16 v[76:79], v[224:227], v[56:59], v[76:79]
    v_mfma_f32_16x16x32_bf16 v[84:87], v[224:227], v[60:63], v[84:87]
    ds_read_b128 v[220:223], v5 offset:12288
    v_mfma_f32_16x16x32_bf16 v[76:79], v[228:231], v[64:67], v[76:79]
    v_mfma_f32_16x16x32_bf16 v[84:87], v[228:231], v[68:71], v[84:87]
    ds_read_b128 v[224:227], v6 offset:12288
    s_waitcnt lgkmcnt(5)
    v_mfma_f32_16x16x32_bf16 v[88:91], v[200:203], v[40:43], v[16:19]
    v_mfma_f32_16x16x32_bf16 v[96:99], v[200:203], v[44:47], v[20:23]
    ds_read_b128 v[228:231], v7 offset:12288
    v_mfma_f32_16x16x32_bf16 v[88:91], v[204:207], v[48:51], v[88:91]
    v_mfma_f32_16x16x32_bf16 v[96:99], v[204:207], v[52:55], v[96:99]
    ds_read_b128 v[200:203], v4 offset:16384
    s_waitcnt lgkmcnt(5)
    v_mfma_f32_16x16x32_bf16 v[88:91], v[208:211], v[56:59], v[88:91]
    v_max_f32 v36, v72, v73
    v_max_f32 v37, v80, v81
    v_max3_f32 v36, v74, v75, v36
    v_mfma_f32_16x16x32_bf16 v[96:99], v[208:211], v[60:63], v[96:99]
    ds_read_b128 v[204:207], v5 offset:16384
    v_max3_f32 v37, v82, v83, v37
    v_max3_f32 v36, v76, v77, v36
    v_mfma_f32_16x16x32_bf16 v[88:91], v[212:215], v[64:67], v[88:91]
    v_max3_f32 v37, v84, v85, v37
    v_max3_f32 v36, v78, v79, v36
    v_max3_f32 v37, v86, v87, v37
    v_mfma_f32_16x16x32_bf16 v[96:99], v[212:215], v[68:71], v[96:99]
    ds_read_b128 v[208:211], v6 offset:16384
    s_waitcnt lgkmcnt(5)
    v_mfma_f32_16x16x32_bf16 v[92:95], v[216:219], v[40:43], v[16:19]
    v_exp_f32 v72, v72
    v_mfma_f32_16x16x32_bf16 v[100:103], v[216:219], v[44:47], v[20:23]
    ds_read_b128 v[212:215], v7 offset:16384
    v_exp_f32 v73, v73
    v_mfma_f32_16x16x32_bf16 v[92:95], v[220:223], v[48:51], v[92:95]
    v_exp_f32 v74, v74
    v_mfma_f32_16x16x32_bf16 v[100:103], v[220:223], v[52:55], v[100:103]
    ds_read_b128 v[216:219], v4 offset:20480
    s_waitcnt lgkmcnt(5)
    v_mfma_f32_16x16x32_bf16 v[92:95], v[224:227], v[56:59], v[92:95]
    v_exp_f32 v75, v75
    v_mfma_f32_16x16x32_bf16 v[100:103], v[224:227], v[60:63], v[100:103]
    ds_read_b128 v[220:223], v5 offset:20480
    v_exp_f32 v76, v76
    v_mfma_f32_16x16x32_bf16 v[92:95], v[228:231], v[64:67], v[92:95]
    v_exp_f32 v77, v77
    v_mfma_f32_16x16x32_bf16 v[100:103], v[228:231], v[68:71], v[100:103]
    ds_read_b128 v[224:227], v6 offset:20480
    s_waitcnt lgkmcnt(5)
    v_mfma_f32_16x16x32_bf16 v[104:107], v[200:203], v[40:43], v[16:19]
    v_exp_f32 v78, v78
    v_mfma_f32_16x16x32_bf16 v[112:115], v[200:203], v[44:47], v[20:23]
    ds_read_b128 v[228:231], v7 offset:20480
    v_exp_f32 v79, v79
    v_mfma_f32_16x16x32_bf16 v[104:107], v[204:207], v[48:51], v[104:107]
    v_exp_f32 v80, v80
    v_mfma_f32_16x16x32_bf16 v[112:115], v[204:207], v[52:55], v[112:115]
    ds_read_b128 v[200:203], v4 offset:24576
    s_waitcnt lgkmcnt(5)
    v_mfma_f32_16x16x32_bf16 v[104:107], v[208:211], v[56:59], v[104:107]
    v_exp_f32 v81, v81
    v_cvt_pk_bf16_f32 v136, v72, v73
    v_mfma_f32_16x16x32_bf16 v[112:115], v[208:211], v[60:63], v[112:115]
    ds_read_b128 v[204:207], v5 offset:24576
    v_cvt_pk_bf16_f32 v137, v74, v75
    v_cvt_pk_bf16_f32 v138, v76, v77
    v_mfma_f32_16x16x32_bf16 v[104:107], v[212:215], v[64:67], v[104:107]
    v_cvt_pk_bf16_f32 v139, v78, v79
    v_exp_f32 v82, v82
    v_mfma_f32_16x16x32_bf16 v[112:115], v[212:215], v[68:71], v[112:115]
    ds_read_b128 v[208:211], v6 offset:24576
    s_waitcnt lgkmcnt(5)
    v_mfma_f32_16x16x32_bf16 v[108:111], v[216:219], v[40:43], v[16:19]
    v_exp_f32 v83, v83
    v_mfma_f32_16x16x32_bf16 v[116:119], v[216:219], v[44:47], v[20:23]
    ds_read_b128 v[212:215], v7 offset:24576
    v_exp_f32 v84, v84
    v_mfma_f32_16x16x32_bf16 v[108:111], v[220:223], v[48:51], v[108:111]
    v_exp_f32 v85, v85
    v_mfma_f32_16x16x32_bf16 v[116:119], v[220:223], v[52:55], v[116:119]
    ds_read_b128 v[216:219], v4 offset:28672
    s_waitcnt lgkmcnt(5)
    v_mfma_f32_16x16x32_bf16 v[108:111], v[224:227], v[56:59], v[108:111]
    v_exp_f32 v86, v86
    v_mfma_f32_16x16x32_bf16 v[116:119], v[224:227], v[60:63], v[116:119]
    ds_read_b128 v[220:223], v5 offset:28672
    v_exp_f32 v87, v87
    v_mfma_f32_16x16x32_bf16 v[108:111], v[228:231], v[64:67], v[108:111]
    v_cvt_pk_bf16_f32 v140, v80, v81
    v_cvt_pk_bf16_f32 v141, v82, v83
    v_cvt_pk_bf16_f32 v142, v84, v85
    v_mfma_f32_16x16x32_bf16 v[116:119], v[228:231], v[68:71], v[116:119]
    ds_read_b128 v[224:227], v6 offset:28672
    v_cvt_pk_bf16_f32 v143, v86, v87
    s_waitcnt lgkmcnt(5)
    v_mfma_f32_16x16x32_bf16 v[120:123], v[200:203], v[40:43], v[16:19]
    v_max3_f32 v36, v88, v89, v36
    v_max3_f32 v37, v96, v97, v37
    v_max3_f32 v36, v90, v91, v36
    v_mfma_f32_16x16x32_bf16 v[128:131], v[200:203], v[44:47], v[20:23]
    ds_read_b128 v[228:231], v7 offset:28672
    v_max3_f32 v37, v98, v99, v37
    v_max3_f32 v36, v92, v93, v36
    v_mfma_f32_16x16x32_bf16 v[120:123], v[204:207], v[48:51], v[120:123]
    v_max3_f32 v37, v100, v101, v37
    v_max3_f32 v36, v94, v95, v36
    v_max3_f32 v37, v102, v103, v37
    v_mfma_f32_16x16x32_bf16 v[128:131], v[204:207], v[52:55], v[128:131]
    v_exp_f32 v88, v88
    s_waitcnt lgkmcnt(4)
    v_mfma_f32_16x16x32_bf16 v[120:123], v[208:211], v[56:59], v[120:123]
    v_exp_f32 v89, v89
    v_mfma_f32_16x16x32_bf16 v[128:131], v[208:211], v[60:63], v[128:131]
    v_exp_f32 v90, v90
    v_mfma_f32_16x16x32_bf16 v[120:123], v[212:215], v[64:67], v[120:123]
    v_exp_f32 v91, v91
    v_max3_f32 v36, v104, v105, v36
    v_mfma_f32_16x16x32_bf16 v[128:131], v[212:215], v[68:71], v[128:131]
    v_max3_f32 v37, v112, v113, v37
    v_max3_f32 v36, v106, v107, v36
    s_waitcnt lgkmcnt(2)
    v_mfma_f32_16x16x32_bf16 v[124:127], v[216:219], v[40:43], v[16:19]
    v_max3_f32 v37, v114, v115, v37
    v_max3_f32 v36, v108, v109, v36
    v_max3_f32 v37, v116, v117, v37
    v_mfma_f32_16x16x32_bf16 v[132:135], v[216:219], v[44:47], v[20:23]
    v_max3_f32 v36, v110, v111, v36
    v_max3_f32 v37, v118, v119, v37
    v_mfma_f32_16x16x32_bf16 v[124:127], v[220:223], v[48:51], v[124:127]
    v_exp_f32 v92, v92
    v_mfma_f32_16x16x32_bf16 v[132:135], v[220:223], v[52:55], v[132:135]
    v_exp_f32 v93, v93
    s_waitcnt lgkmcnt(0)
    v_mfma_f32_16x16x32_bf16 v[124:127], v[224:227], v[56:59], v[124:127]
    v_exp_f32 v94, v94
    v_mfma_f32_16x16x32_bf16 v[132:135], v[224:227], v[60:63], v[132:135]
    v_exp_f32 v95, v95
    v_mfma_f32_16x16x32_bf16 v[124:127], v[228:231], v[64:67], v[124:127]
    v_exp_f32 v96, v96
    v_mfma_f32_16x16x32_bf16 v[132:135], v[228:231], v[68:71], v[132:135]
    v_exp_f32 v97, v97
    v_cvt_pk_bf16_f32 v144, v88, v89
    v_cvt_pk_bf16_f32 v145, v90, v91
    v_cvt_pk_bf16_f32 v146, v92, v93
    v_cvt_pk_bf16_f32 v147, v94, v95
    v_max3_f32 v36, v120, v121, v36
    v_max3_f32 v37, v128, v129, v37
    v_max3_f32 v36, v122, v123, v36
    v_max3_f32 v37, v130, v131, v37
    v_max3_f32 v36, v124, v125, v36
    v_max3_f32 v37, v132, v133, v37
    v_max3_f32 v36, v126, v127, v36
    v_max3_f32 v37, v134, v135, v37
    v_max_f32 v38, v36, v37
    v_cmp_lt_f32 vcc, 0, v38
    v_exp_f32 v98, v98
    v_exp_f32 v99, v99
    s_nop 1
    s_cbranch_vccnz L_rd0
L_nr0:
    s_waitcnt vmcnt(0) lgkmcnt(0)
    s_barrier
    ds_read_b128 v[200:203], v4 offset:32768
    ds_read_b128 v[204:207], v5 offset:32768
    ds_read_b128 v[208:211], v6 offset:32768
    ds_read_b128 v[212:215], v7 offset:32768
    ds_read_b128 v[216:219], v4 offset:36864
    ds_read_b128 v[220:223], v5 offset:36864
    ds_read_b128 v[224:227], v6 offset:36864
    v_exp_f32 v100, v100
    v_exp_f32 v101, v101
    v_exp_f32 v102, v102
    v_exp_f32 v103, v103
    v_cvt_pk_bf16_f32 v148, v96, v97
    v_cvt_pk_bf16_f32 v149, v98, v99
    v_cvt_pk_bf16_f32 v150, v100, v101
    v_cvt_pk_bf16_f32 v151, v102, v103
    v_exp_f32 v104, v104
    v_exp_f32 v105, v105
    v_exp_f32 v106, v106
    v_exp_f32 v107, v107
    v_exp_f32 v108, v108
    v_exp_f32 v109, v109
    v_exp_f32 v110, v110
    v_exp_f32 v111, v111
    v_exp_f32 v112, v112
    v_exp_f32 v113, v113
    v_cvt_pk_bf16_f32 v152, v104, v105
    v_cvt_pk_bf16_f32 v153, v106, v107
    s_waitcnt lgkmcnt(5)
    v_mfma_f32_16x16x32_bf16 v[72:75], v[200:203], v[40:43], v[16:19]
    v_cvt_pk_bf16_f32 v154, v108, v109
    v_cvt_pk_bf16_f32 v155, v110, v111
    v_mfma_f32_16x16x32_bf16 v[80:83], v[200:203], v[44:47], v[20:23]
    ds_read_b128 v[228:231], v7 offset:36864
    v_exp_f32 v114, v114
    v_mfma_f32_16x16x32_bf16 v[72:75], v[204:207], v[48:51], v[72:75]
    v_exp_f32 v115, v115
    v_mfma_f32_16x16x32_bf16 v[80:83], v[204:207], v[52:55], v[80:83]
    ds_read_b128 v[200:203], v4 offset:40960
    s_waitcnt lgkmcnt(5)
    v_mfma_f32_16x16x32_bf16 v[72:75], v[208:211], v[56:59], v[72:75]
    v_exp_f32 v116, v116
    v_mfma_f32_16x16x32_bf16 v[80:83], v[208:211], v[60:63], v[80:83]
    ds_read_b128 v[204:207], v5 offset:40960
    v_exp_f32 v117, v117
    v_mfma_f32_16x16x32_bf16 v[72:75], v[212:215], v[64:67], v[72:75]
    v_exp_f32 v118, v118
    v_mfma_f32_16x16x32_bf16 v[80:83], v[212:215], v[68:71], v[80:83]
    ds_read_b128 v[208:211], v6 offset:40960
    v_mfma_f32_16x16x32_bf16 v[24:27], v[32:35], v[136:139], v[24:27]
    v_exp_f32 v119, v119
    v_cvt_pk_bf16_f32 v156, v112, v113
    v_mfma_f32_16x16x32_bf16 v[28:31], v[32:35], v[140:143], v[28:31]
    v_cvt_pk_bf16_f32 v157, v114, v115
    v_cvt_pk_bf16_f32 v158, v116, v117
    v_cvt_pk_bf16_f32 v159, v118, v119
    s_waitcnt lgkmcnt(5)
    v_mfma_f32_16x16x32_bf16 v[76:79], v[216:219], v[40:43], v[16:19]
    v_exp_f32 v120, v120
    v_mfma_f32_16x16x32_bf16 v[84:87], v[216:219], v[44:47], v[20:23]
    ds_read_b128 v[212:215], v7 offset:40960
    v_exp_f32 v121, v121
    v_mfma_f32_16x16x32_bf16 v[76:79], v[220:223], v[48:51], v[76:79]
    v_exp_f32 v122, v122
    v_mfma_f32_16x16x32_bf16 v[84:87], v[220:223], v[52:55], v[84:87]
    ds_read_b128 v[216:219], v4 offset:45056
    s_waitcnt lgkmcnt(5)
    v_mfma_f32_16x16x32_bf16 v[76:79], v[224:227], v[56:59], v[76:79]
    v_exp_f32 v123, v123
    v_mfma_f32_16x16x32_bf16 v[84:87], v[224:227], v[60:63], v[84:87]
    ds_read_b128 v[220:223], v5 offset:45056
    v_exp_f32 v124, v124
    v_mfma_f32_16x16x32_bf16 v[76:79], v[228:231], v[64:67], v[76:79]
    v_exp_f32 v125, v125
    v_mfma_f32_16x16x32_bf16 v[84:87], v[228:231], v[68:71], v[84:87]
    ds_read_b128 v[224:227], v6 offset:45056
    s_waitcnt lgkmcnt(5)
    v_mfma_f32_16x16x32_bf16 v[88:91], v[200:203], v[40:43], v[16:19]
    v_exp_f32 v126, v126
    v_mfma_f32_16x16x32_bf16 v[96:99], v[200:203], v[44:47], v[20:23]
    ds_read_b128 v[228:231], v7 offset:45056
    v_exp_f32 v127, v127
    v_mfma_f32_16x16x32_bf16 v[88:91], v[204:207], v[48:51], v[88:91]
    v_exp_f32 v128, v128
    v_mfma_f32_16x16x32_bf16 v[96:99], v[204:207], v[52:55], v[96:99]
    ds_read_b128 v[200:203], v4 offset:49152
    s_waitcnt lgkmcnt(5)
    v_mfma_f32_16x16x32_bf16 v[88:91], v[208:211], v[56:59], v[88:91]
    v_exp_f32 v129, v129
    v_cvt_pk_bf16_f32 v160, v120, v121
    v_mfma_f32_16x16x32_bf16 v[96:99], v[208:211], v[60:63], v[96:99]
    ds_read_b128 v[204:207], v5 offset:49152
    v_cvt_pk_bf16_f32 v161, v122, v123
    v_cvt_pk_bf16_f32 v162, v124, v125
    v_mfma_f32_16x16x32_bf16 v[88:91], v[212:215], v[64:67], v[88:91]
    v_cvt_pk_bf16_f32 v163, v126, v127
    v_exp_f32 v130, v130
    v_mfma_f32_16x16x32_bf16 v[96:99], v[212:215], v[68:71], v[96:99]
    ds_read_b128 v[208:211], v6 offset:49152
    v_mfma_f32_16x16x32_bf16 v[24:27], v[32:35], v[144:147], v[24:27]
    v_exp_f32 v131, v131
    v_mfma_f32_16x16x32_bf16 v[28:31], v[32:35], v[148:151], v[28:31]
    v_exp_f32 v132, v132
    s_waitcnt lgkmcnt(5)
    v_mfma_f32_16x16x32_bf16 v[92:95], v[216:219], v[40:43], v[16:19]
    v_exp_f32 v133, v133
    v_mfma_f32_16x16x32_bf16 v[100:103], v[216:219], v[44:47], v[20:23]
    ds_read_b128 v[212:215], v7 offset:49152
    v_exp_f32 v134, v134
    v_mfma_f32_16x16x32_bf16 v[92:95], v[220:223], v[48:51], v[92:95]
    v_exp_f32 v135, v135
    v_cvt_pk_bf16_f32 v164, v128, v129
    v_mfma_f32_16x16x32_bf16 v[100:103], v[220:223], v[52:55], v[100:103]
    ds_read_b128 v[216:219], v4 offset:53248
    v_cvt_pk_bf16_f32 v165, v130, v131
    s_waitcnt lgkmcnt(5)
    v_mfma_f32_16x16x32_bf16 v[92:95], v[224:227], v[56:59], v[92:95]
    v_cvt_pk_bf16_f32 v166, v132, v133
    v_cvt_pk_bf16_f32 v167, v134, v135
    v_max_f32 v36, v72, v73
    v_mfma_f32_16x16x32_bf16 v[100:103], v[224:227], v[60:63], v[100:103]
    ds_read_b128 v[220:223], v5 offset:53248
    v_max_f32 v37, v80, v81
    v_max3_f32 v36, v74, v75, v36
    v_mfma_f32_16x16x32_bf16 v[92:95], v[228:231], v[64:67], v[92:95]
    v_max3_f32 v37, v82, v83, v37
    v_max3_f32 v36, v76, v77, v36
    v_max3_f32 v37, v84, v85, v37
    v_mfma_f32_16x16x32_bf16 v[100:103], v[228:231], v[68:71], v[100:103]
    ds_read_b128 v[224:227], v6 offset:53248
    v_max3_f32 v36, v78, v79, v36
    s_waitcnt lgkmcnt(5)
    v_mfma_f32_16x16x32_bf16 v[104:107], v[200:203], v[40:43], v[16:19]
    v_max3_f32 v37, v86, v87, v37
    v_exp_f32 v72, v72
    v_mfma_f32_16x16x32_bf16 v[112:115], v[200:203], v[44:47], v[20:23]
    ds_read_b128 v[228:231], v7 offset:53248
    v_exp_f32 v73, v73
    v_mfma_f32_16x16x32_bf16 v[104:107], v[204:207], v[48:51], v[104:107]
    v_exp_f32 v74, v74
    v_mfma_f32_16x16x32_bf16 v[112:115], v[204:207], v[52:55], v[112:115]
    ds_read_b128 v[200:203], v4 offset:57344
    s_waitcnt lgkmcnt(5)
    v_mfma_f32_16x16x32_bf16 v[104:107], v[208:211], v[56:59], v[104:107]
    v_exp_f32 v75, v75
    v_mfma_f32_16x16x32_bf16 v[112:115], v[208:211], v[60:63], v[112:115]
    ds_read_b128 v[204:207], v5 offset:57344
    v_exp_f32 v76, v76
    v_mfma_f32_16x16x32_bf16 v[104:107], v[212:215], v[64:67], v[104:107]
    v_exp_f32 v77, v77
    v_mfma_f32_16x16x32_bf16 v[112:115], v[212:215], v[68:71], v[112:115]
    ds_read_b128 v[208:211], v6 offset:57344
    v_mfma_f32_16x16x32_bf16 v[24:27], v[32:35], v[152:155], v[24:27]
    v_exp_f32 v78, v78
    v_mfma_f32_16x16x32_bf16 v[28:31], v[32:35], v[156:159], v[28:31]
    v_exp_f32 v79, v79
    s_waitcnt lgkmcnt(5)
    v_mfma_f32_16x16x32_bf16 v[108:111], v[216:219], v[40:43], v[16:19]
    v_exp_f32 v80, v80
    v_mfma_f32_16x16x32_bf16 v[116:119], v[216:219], v[44:47], v[20:23]
    ds_read_b128 v[212:215], v7 offset:57344
    v_exp_f32 v81, v81
    v_mfma_f32_16x16x32_bf16 v[108:111], v[220:223], v[48:51], v[108:111]
    v_cvt_pk_bf16_f32 v168, v72, v73
    v_cvt_pk_bf16_f32 v169, v74, v75
    v_cvt_pk_bf16_f32 v170, v76, v77
    v_mfma_f32_16x16x32_bf16 v[116:119], v[220:223], v[52:55], v[116:119]
    ds_read_b128 v[216:219], v4 offset:61440
    v_cvt_pk_bf16_f32 v171, v78, v79
    s_waitcnt lgkmcnt(5)
    v_mfma_f32_16x16x32_bf16 v[108:111], v[224:227], v[56:59], v[108:111]
    v_exp_f32 v82, v82
    v_mfma_f32_16x16x32_bf16 v[116:119], v[224:227], v[60:63], v[116:119]
    ds_read_b128 v[220:223], v5 offset:61440
    v_exp_f32 v83, v83
    v_mfma_f32_16x16x32_bf16 v[108:111], v[228:231], v[64:67], v[108:111]
    v_exp_f32 v84, v84
    v_mfma_f32_16x16x32_bf16 v[116:119], v[228:231], v[68:71], v[116:119]
    ds_read_b128 v[224:227], v6 offset:61440
    s_waitcnt lgkmcnt(5)
    v_mfma_f32_16x16x32_bf16 v[120:123], v[200:203], v[40:43], v[16:19]
    v_exp_f32 v85, v85
    v_mfma_f32_16x16x32_bf16 v[128:131], v[200:203], v[44:47], v[20:23]
    ds_read_b128 v[228:231], v7 offset:61440
    v_exp_f32 v86, v86
    v_mfma_f32_16x16x32_bf16 v[120:123], v[204:207], v[48:51], v[120:123]
    v_exp_f32 v87, v87
    v_cvt_pk_bf16_f32 v172, v80, v81
    v_mfma_f32_16x16x32_bf16 v[128:131], v[204:207], v[52:55], v[128:131]
    v_cvt_pk_bf16_f32 v173, v82, v83
    v_cvt_pk_bf16_f32 v174, v84, v85
    s_waitcnt lgkmcnt(4)
    v_mfma_f32_16x16x32_bf16 v[120:123], v[208:211], v[56:59], v[120:123]
    v_cvt_pk_bf16_f32 v175, v86, v87
    v_max3_f32 v36, v88, v89, v36
    v_max3_f32 v37, v96, v97, v37
    v_mfma_f32_16x16x32_bf16 v[128:131], v[208:211], v[60:63], v[128:131]
    v_max3_f32 v36, v90, v91, v36
    v_max3_f32 v37, v98, v99, v37
    v_max3_f32 v36, v92, v93, v36
    v_mfma_f32_16x16x32_bf16 v[120:123], v[212:215], v[64:67], v[120:123]
    v_max3_f32 v37, v100, v101, v37
    v_max3_f32 v36, v94, v95, v36
    v_max3_f32 v37, v102, v103, v37
    v_mfma_f32_16x16x32_bf16 v[128:131], v[212:215], v[68:71], v[128:131]
    v_max3_f32 v36, v104, v105, v36
    v_max3_f32 v37, v112, v113, v37
    v_mfma_f32_16x16x32_bf16 v[24:27], v[32:35], v[160:163], v[24:27]
    v_max3_f32 v36, v106, v107, v36
    v_max3_f32 v37, v114, v115, v37
    v_max3_f32 v36, v108, v109, v36
    v_mfma_f32_16x16x32_bf16 v[28:31], v[32:35], v[164:167], v[28:31]
    v_max3_f32 v37, v116, v117, v37
    v_max3_f32 v36, v110, v111, v36
    v_max3_f32 v37, v118, v119, v37
    s_waitcnt lgkmcnt(2)
    v_mfma_f32_16x16x32_bf16 v[124:127], v[216:219], v[40:43], v[16:19]
    v_exp_f32 v88, v88
    v_mfma_f32_16x16x32_bf16 v[132:135], v[216:219], v[44:47], v[20:23]
    v_exp_f32 v89, v89
    v_mfma_f32_16x16x32_bf16 v[124:127], v[220:223], v[48:51], v[124:127]
    v_exp_f32 v90, v90
    v_mfma_f32_16x16x32_bf16 v[132:135], v[220:223], v[52:55], v[132:135]
    v_exp_f32 v91, v91
    s_waitcnt lgkmcnt(0)
    v_mfma_f32_16x16x32_bf16 v[124:127], v[224:227], v[56:59], v[124:127]
    v_exp_f32 v92, v92
    v_mfma_f32_16x16x32_bf16 v[132:135], v[224:227], v[60:63], v[132:135]
    v_exp_f32 v93, v93
    v_mfma_f32_16x16x32_bf16 v[124:127], v[228:231], v[64:67], v[124:127]
    v_exp_f32 v94, v94
    v_mfma_f32_16x16x32_bf16 v[132:135], v[228:231], v[68:71], v[132:135]
    v_exp_f32 v95, v95
    v_exp_f32 v96, v96
    v_exp_f32 v97, v97
    v_cvt_pk_bf16_f32 v176, v88, v89
    v_cvt_pk_bf16_f32 v177, v90, v91
    v_max3_f32 v36, v120, v121, v36
    v_max3_f32 v37, v128, v129, v37
    v_max3_f32 v36, v122, v123, v36
    v_max3_f32 v37, v130, v131, v37
    v_max3_f32 v36, v124, v125, v36
    v_max3_f32 v37, v132, v133, v37
    v_max3_f32 v36, v126, v127, v36
    v_max3_f32 v37, v134, v135, v37
    v_max_f32 v38, v36, v37
    v_cmp_lt_f32 vcc, 0, v38
    v_cvt_pk_bf16_f32 v178, v92, v93
    v_cvt_pk_bf16_f32 v179, v94, v95
    s_nop 1
    s_cbranch_vccnz L_rd1
L_nr1:
    v_subrev_u32 v4, 32768, v4
    v_subrev_u32 v5, 32768, v5
    v_subrev_u32 v6, 32768, v6
    v_subrev_u32 v7, 32768, v7
    s_waitcnt lgkmcnt(0)
    s_barrier
    ds_read_b128 v[200:203], v4 offset:0
    ds_read_b128 v[204:207], v5 offset:0
    ds_read_b128 v[208:211], v6 offset:0
    ds_read_b128 v[212:215], v7 offset:0
    ds_read_b128 v[216:219], v4 offset:4096
    ds_read_b128 v[220:223], v5 offset:4096
    ds_read_b128 v[224:227], v6 offset:4096
    v_exp_f32 v98, v98
    v_exp_f32 v99, v99
    v_exp_f32 v100, v100
    v_exp_f32 v101, v101
    v_exp_f32 v102, v102
    v_exp_f32 v103, v103
    v_cvt_pk_bf16_f32 v180, v96, v97
    v_cvt_pk_bf16_f32 v181, v98, v99
    v_cvt_pk_bf16_f32 v182, v100, v101
    v_cvt_pk_bf16_f32 v183, v102, v103
    v_exp_f32 v104, v104
    v_exp_f32 v105, v105
    v_exp_f32 v106, v106
    v_exp_f32 v107, v107
    v_exp_f32 v108, v108
    v_exp_f32 v109, v109
    v_exp_f32 v110, v110
    v_exp_f32 v111, v111
    v_exp_f32 v112, v112
    v_exp_f32 v113, v113
    s_waitcnt lgkmcnt(5)
    v_mfma_f32_16x16x32_bf16 v[72:75], v[200:203], v[40:43], v[16:19]
    v_cvt_pk_bf16_f32 v184, v104, v105
    v_cvt_pk_bf16_f32 v185, v106, v107
    v_cvt_pk_bf16_f32 v186, v108, v109
    v_mfma_f32_16x16x32_bf16 v[80:83], v[200:203], v[44:47], v[20:23]
    ds_read_b128 v[228:231], v7 offset:4096
    v_cvt_pk_bf16_f32 v187, v110, v111
    v_mfma_f32_16x16x32_bf16 v[72:75], v[204:207], v[48:51], v[72:75]
    v_exp_f32 v114, v114
    v_mfma_f32_16x16x32_bf16 v[80:83], v[204:207], v[52:55], v[80:83]
    ds_read_b128 v[200:203], v4 offset:8192
    s_waitcnt lgkmcnt(5)
    v_mfma_f32_16x16x32_bf16 v[72:75], v[208:211], v[56:59], v[72:75]
    v_exp_f32 v115, v115
    v_mfma_f32_16x16x32_bf16 v[80:83], v[208:211], v[60:63], v[80:83]
    ds_read_b128 v[204:207], v5 offset:8192
    v_exp_f32 v116, v116
    v_mfma_f32_16x16x32_bf16 v[72:75], v[212:215], v[64:67], v[72:75]
    v_exp_f32 v117, v117
    v_mfma_f32_16x16x32_bf16 v[80:83], v[212:215], v[68:71], v[80:83]
    ds_read_b128 v[208:211], v6 offset:8192
    v_mfma_f32_16x16x32_bf16 v[24:27], v[32:35], v[168:171], v[24:27]
    v_exp_f32 v118, v118
    v_mfma_f32_16x16x32_bf16 v[28:31], v[32:35], v[172:175], v[28:31]
    v_exp_f32 v119, v119
    v_cvt_pk_bf16_f32 v188, v112, v113
    s_waitcnt lgkmcnt(5)
    v_mfma_f32_16x16x32_bf16 v[76:79], v[216:219], v[40:43], v[16:19]
    v_cvt_pk_bf16_f32 v189, v114, v115
    v_cvt_pk_bf16_f32 v190, v116, v117
    v_cvt_pk_bf16_f32 v191, v118, v119
    v_mfma_f32_16x16x32_bf16 v[84:87], v[216:219], v[44:47], v[20:23]
    ds_read_b128 v[212:215], v7 offset:8192
    v_exp_f32 v120, v120
    v_mfma_f32_16x16x32_bf16 v[76:79], v[220:223], v[48:51], v[76:79]
    v_exp_f32 v121, v121
    v_mfma_f32_16x16x32_bf16 v[84:87], v[220:223], v[52:55], v[84:87]
    ds_read_b128 v[216:219], v4 offset:12288
    s_waitcnt lgkmcnt(5)
    v_mfma_f32_16x16x32_bf16 v[76:79], v[224:227], v[56:59], v[76:79]
    v_exp_f32 v122, v122
    v_mfma_f32_16x16x32_bf16 v[84:87], v[224:227], v[60:63], v[84:87]
    ds_read_b128 v[220:223], v5 offset:12288
    v_exp_f32 v123, v123
    v_mfma_f32_16x16x32_bf16 v[76:79], v[228:231], v[64:67], v[76:79]
    v_exp_f32 v124, v124
    v_mfma_f32_16x16x32_bf16 v[84:87], v[228:231], v[68:71], v[84:87]
    ds_read_b128 v[224:227], v6 offset:12288
    s_waitcnt lgkmcnt(5)
    v_mfma_f32_16x16x32_bf16 v[88:91], v[200:203], v[40:43], v[16:19]
    v_exp_f32 v125, v125
    v_mfma_f32_16x16x32_bf16 v[96:99], v[200:203], v[44:47], v[20:23]
    ds_read_b128 v[228:231], v7 offset:12288
    v_exp_f32 v126, v126
    v_mfma_f32_16x16x32_bf16 v[88:91], v[204:207], v[48:51], v[88:91]
    v_exp_f32 v127, v127
    v_mfma_f32_16x16x32_bf16 v[96:99], v[204:207], v[52:55], v[96:99]
    ds_read_b128 v[200:203], v4 offset:16384
    s_waitcnt lgkmcnt(5)
    v_mfma_f32_16x16x32_bf16 v[88:91], v[208:211], v[56:59], v[88:91]
    v_exp_f32 v128, v128
    v_mfma_f32_16x16x32_bf16 v[96:99], v[208:211], v[60:63], v[96:99]
    ds_read_b128 v[204:207], v5 offset:16384
    v_exp_f32 v129, v129
    v_mfma_f32_16x16x32_bf16 v[88:91], v[212:215], v[64:67], v[88:91]
    v_cvt_pk_bf16_f32 v192, v120, v121
    v_cvt_pk_bf16_f32 v193, v122, v123
    v_cvt_pk_bf16_f32 v194, v124, v125
    v_mfma_f32_16x16x32_bf16 v[96:99], v[212:215], v[68:71], v[96:99]
    ds_read_b128 v[208:211], v6 offset:16384
    v_cvt_pk_bf16_f32 v195, v126, v127
    v_mfma_f32_16x16x32_bf16 v[24:27], v[32:35], v[176:179], v[24:27]
    v_exp_f32 v130, v130
    v_mfma_f32_16x16x32_bf16 v[28:31], v[32:35], v[180:183], v[28:31]
    v_exp_f32 v131, v131
    s_waitcnt lgkmcnt(5)
    v_mfma_f32_16x16x32_bf16 v[92:95], v[216:219], v[40:43], v[16:19]
    v_exp_f32 v132, v132
    v_mfma_f32_16x16x32_bf16 v[100:103], v[216:219], v[44:47], v[20:23]
    ds_read_b128 v[212:215], v7 offset:16384
    v_exp_f32 v133, v133
    v_mfma_f32_16x16x32_bf16 v[92:95], v[220:223], v[48:51], v[92:95]
    v_exp_f32 v134, v134
    v_mfma_f32_16x16x32_bf16 v[100:103], v[220:223], v[52:55], v[100:103]
    ds_read_b128 v[216:219], v4 offset:20480
    s_waitcnt lgkmcnt(5)
    v_mfma_f32_16x16x32_bf16 v[92:95], v[224:227], v[56:59], v[92:95]
    v_exp_f32 v135, v135
    v_cvt_pk_bf16_f32 v196, v128, v129
    v_mfma_f32_16x16x32_bf16 v[100:103], v[224:227], v[60:63], v[100:103]
    ds_read_b128 v[220:223], v5 offset:20480
    v_cvt_pk_bf16_f32 v197, v130, v131
    v_cvt_pk_bf16_f32 v198, v132, v133
    v_mfma_f32_16x16x32_bf16 v[92:95], v[228:231], v[64:67], v[92:95]
    v_cvt_pk_bf16_f32 v199, v134, v135
    v_max_f32 v36, v72, v73
    v_max_f32 v37, v80, v81
    v_mfma_f32_16x16x32_bf16 v[100:103], v[228:231], v[68:71], v[100:103]
    ds_read_b128 v[224:227], v6 offset:20480
    v_max3_f32 v36, v74, v75, v36
    s_waitcnt lgkmcnt(5)
    v_mfma_f32_16x16x32_bf16 v[104:107], v[200:203], v[40:43], v[16:19]
    v_max3_f32 v37, v82, v83, v37
    v_max3_f32 v36, v76, v77, v36
    v_max3_f32 v37, v84, v85, v37
    v_mfma_f32_16x16x32_bf16 v[112:115], v[200:203], v[44:47], v[20:23]
    ds_read_b128 v[228:231], v7 offset:20480
    v_max3_f32 v36, v78, v79, v36
    v_max3_f32 v37, v86, v87, v37
    v_mfma_f32_16x16x32_bf16 v[104:107], v[204:207], v[48:51], v[104:107]
    v_exp_f32 v72, v72
    v_mfma_f32_16x16x32_bf16 v[112:115], v[204:207], v[52:55], v[112:115]
    ds_read_b128 v[200:203], v4 offset:24576
    s_waitcnt lgkmcnt(5)
    v_mfma_f32_16x16x32_bf16 v[104:107], v[208:211], v[56:59], v[104:107]
    v_exp_f32 v73, v73
    v_mfma_f32_16x16x32_bf16 v[112:115], v[208:211], v[60:63], v[112:115]
    ds_read_b128 v[204:207], v5 offset:24576
    v_exp_f32 v74, v74
    v_mfma_f32_16x16x32_bf16 v[104:107], v[212:215], v[64:67], v[104:107]
    v_exp_f32 v75, v75
    v_mfma_f32_16x16x32_bf16 v[112:115], v[212:215], v[68:71], v[112:115]
    ds_read_b128 v[208:211], v6 offset:24576
    v_mfma_f32_16x16x32_bf16 v[24:27], v[32:35], v[184:187], v[24:27]
    v_exp_f32 v76, v76
    v_mfma_f32_16x16x32_bf16 v[28:31], v[32:35], v[188:191], v[28:31]
    v_exp_f32 v77, v77
    s_waitcnt lgkmcnt(5)
    v_mfma_f32_16x16x32_bf16 v[108:111], v[216:219], v[40:43], v[16:19]
    v_exp_f32 v78, v78
    v_mfma_f32_16x16x32_bf16 v[116:119], v[216:219], v[44:47], v[20:23]
    ds_read_b128 v[212:215], v7 offset:24576
    v_exp_f32 v79, v79
    v_mfma_f32_16x16x32_bf16 v[108:111], v[220:223], v[48:51], v[108:111]
    v_exp_f32 v80, v80
    v_mfma_f32_16x16x32_bf16 v[116:119], v[220:223], v[52:55], v[116:119]
    ds_read_b128 v[216:219], v4 offset:28672
    s_waitcnt lgkmcnt(5)
    v_mfma_f32_16x16x32_bf16 v[108:111], v[224:227], v[56:59], v[108:111]
    v_exp_f32 v81, v81
    v_cvt_pk_bf16_f32 v232, v72, v73
    v_mfma_f32_16x16x32_bf16 v[116:119], v[224:227], v[60:63], v[116:119]
    ds_read_b128 v[220:223], v5 offset:28672
    v_cvt_pk_bf16_f32 v233, v74, v75
    v_cvt_pk_bf16_f32 v234, v76, v77
    v_mfma_f32_16x16x32_bf16 v[108:111], v[228:231], v[64:67], v[108:111]
    v_cvt_pk_bf16_f32 v235, v78, v79
    v_exp_f32 v82, v82
    v_mfma_f32_16x16x32_bf16 v[116:119], v[228:231], v[68:71], v[116:119]
    ds_read_b128 v[224:227], v6 offset:28672
    s_waitcnt lgkmcnt(5)
    v_mfma_f32_16x16x32_bf16 v[120:123], v[200:203], v[40:43], v[16:19]
    v_exp_f32 v83, v83
    v_mfma_f32_16x16x32_bf16 v[128:131], v[200:203], v[44:47], v[20:23]
    ds_read_b128 v[228:231], v7 offset:28672
    v_exp_f32 v84, v84
    v_mfma_f32_16x16x32_bf16 v[120:123], v[204:207], v[48:51], v[120:123]
    v_exp_f32 v85, v85
    v_mfma_f32_16x16x32_bf16 v[128:131], v[204:207], v[52:55], v[128:131]
    v_exp_f32 v86, v86
    s_waitcnt lgkmcnt(4)
    v_mfma_f32_16x16x32_bf16 v[120:123], v[208:211], v[56:59], v[120:123]
    v_exp_f32 v87, v87
    v_cvt_pk_bf16_f32 v236, v80, v81
    v_mfma_f32_16x16x32_bf16 v[128:131], v[208:211], v[60:63], v[128:131]
    v_cvt_pk_bf16_f32 v237, v82, v83
    v_cvt_pk_bf16_f32 v238, v84, v85
    v_cvt_pk_bf16_f32 v239, v86, v87
    v_mfma_f32_16x16x32_bf16 v[120:123], v[212:215], v[64:67], v[120:123]
    v_max3_f32 v36, v88, v89, v36
    v_max3_f32 v37, v96, v97, v37
    v_max3_f32 v36, v90, v91, v36
    v_mfma_f32_16x16x32_bf16 v[128:131], v[212:215], v[68:71], v[128:131]
    v_max3_f32 v37, v98, v99, v37
    v_max3_f32 v36, v92, v93, v36
    v_mfma_f32_16x16x32_bf16 v[24:27], v[32:35], v[192:195], v[24:27]
    v_max3_f32 v37, v100, v101, v37
    v_max3_f32 v36, v94, v95, v36
    v_max3_f32 v37, v102, v103, v37
    v_mfma_f32_16x16x32_bf16 v[28:31], v[32:35], v[196:199], v[28:31]
    v_max3_f32 v36, v104, v105, v36
    v_max3_f32 v37, v112, v113, v37
    v_max3_f32 v36, v106, v107, v36
    s_waitcnt lgkmcnt(2)
    v_mfma_f32_16x16x32_bf16 v[124:127], v[216:219], v[40:43], v[16:19]
    v_max3_f32 v37, v114, v115, v37
    v_max3_f32 v36, v108, v109, v36
    v_max3_f32 v37, v116, v117, v37
    v_mfma_f32_16x16x32_bf16 v[132:135], v[216:219], v[44:47], v[20:23]
    v_max3_f32 v36, v110, v111, v36
    v_max3_f32 v37, v118, v119, v37
    v_mfma_f32_16x16x32_bf16 v[124:127], v[220:223], v[48:51], v[124:127]
    v_exp_f32 v88, v88
    v_mfma_f32_16x16x32_bf16 v[132:135], v[220:223], v[52:55], v[132:135]
    v_exp_f32 v89, v89
    s_waitcnt lgkmcnt(0)
    v_mfma_f32_16x16x32_bf16 v[124:127], v[224:227], v[56:59], v[124:127]
    v_exp_f32 v90, v90
    v_mfma_f32_16x16x32_bf16 v[132:135], v[224:227], v[60:63], v[132:135]
    v_exp_f32 v91, v91
    v_mfma_f32_16x16x32_bf16 v[124:127], v[228:231], v[64:67], v[124:127]
    v_exp_f32 v92, v92
    v_mfma_f32_16x16x32_bf16 v[132:135], v[228:231], v[68:71], v[132:135]
    v_exp_f32 v93, v93
    v_exp_f32 v94, v94
    v_exp_f32 v95, v95
    v_exp_f32 v96, v96
    v_exp_f32 v97, v97
    v_max3_f32 v36, v120, v121, v36
    v_max3_f32 v37, v128, v129, v37
    v_max3_f32 v36, v122, v123, v36
    v_max3_f32 v37, v130, v131, v37
    v_max3_f32 v36, v124, v125, v36
    v_max3_f32 v37, v132, v133, v37
    v_max3_f32 v36, v126, v127, v36
    v_max3_f32 v37, v134, v135, v37
    v_max_f32 v38, v36, v37
    v_cmp_lt_f32 vcc, 0, v38
    v_cvt_pk_bf16_f32 v240, v88, v89
    v_cvt_pk_bf16_f32 v241, v90, v91
    s_nop 1
    s_cbranch_vccnz L_rd2
L_nr2:
    s_waitcnt lgkmcnt(0)
    s_barrier
    ds_read_b128 v[200:203], v4 offset:32768
    ds_read_b128 v[204:207], v5 offset:32768
    ds_read_b128 v[208:211], v6 offset:32768
    ds_read_b128 v[212:215], v7 offset:32768
    ds_read_b128 v[216:219], v4 offset:36864
    ds_read_b128 v[220:223], v5 offset:36864
    ds_read_b128 v[224:227], v6 offset:36864
    v_cvt_pk_bf16_f32 v242, v92, v93
    v_cvt_pk_bf16_f32 v243, v94, v95
    v_exp_f32 v98, v98
    v_exp_f32 v99, v99
    v_exp_f32 v100, v100
    v_exp_f32 v101, v101
    v_exp_f32 v102, v102
    v_exp_f32 v103, v103
    v_cvt_pk_bf16_f32 v244, v96, v97
    v_cvt_pk_bf16_f32 v245, v98, v99
    v_cvt_pk_bf16_f32 v246, v100, v101
    v_cvt_pk_bf16_f32 v247, v102, v103
    v_exp_f32 v104, v104
    v_exp_f32 v105, v105
    v_exp_f32 v106, v106
    v_exp_f32 v107, v107
    v_exp_f32 v108, v108
    v_exp_f32 v109, v109
    v_exp_f32 v110, v110
    v_exp_f32 v111, v111
    s_waitcnt lgkmcnt(5)
    v_mfma_f32_16x16x32_bf16 v[72:75], v[200:203], v[40:43], v[16:19]
    v_exp_f32 v112, v112
    v_mfma_f32_16x16x32_bf16 v[80:83], v[200:203], v[44:47], v[20:23]
    ds_read_b128 v[228:231], v7 offset:36864
    v_exp_f32 v113, v113
    v_mfma_f32_16x16x32_bf16 v[72:75], v[204:207], v[48:51], v[72:75]
    v_cvt_pk_bf16_f32 v248, v104, v105
    v_cvt_pk_bf16_f32 v249, v106, v107
    v_cvt_pk_bf16_f32 v250, v108, v109
    v_mfma_f32_16x16x32_bf16 v[80:83], v[204:207], v[52:55], v[80:83]
    ds_read_b128 v[200:203], v4 offset:40960
    v_cvt_pk_bf16_f32 v251, v110, v111
    s_waitcnt lgkmcnt(5)
    v_mfma_f32_16x16x32_bf16 v[72:75], v[208:211], v[56:59], v[72:75]
    v_exp_f32 v114, v114
    v_mfma_f32_16x16x32_bf16 v[80:83], v[208:211], v[60:63], v[80:83]
    ds_read_b128 v[204:207], v5 offset:40960
    v_exp_f32 v115, v115
    v_mfma_f32_16x16x32_bf16 v[72:75], v[212:215], v[64:67], v[72:75]
    v_exp_f32 v116, v116
    v_mfma_f32_16x16x32_bf16 v[80:83], v[212:215], v[68:71], v[80:83]
    ds_read_b128 v[208:211], v6 offset:40960
    v_mfma_f32_16x16x32_bf16 v[24:27], v[32:35], v[232:235], v[24:27]
    v_exp_f32 v117, v117
    v_mfma_f32_16x16x32_bf16 v[28:31], v[32:35], v[236:239], v[28:31]
    v_exp_f32 v118, v118
    s_waitcnt lgkmcnt(5)
    v_mfma_f32_16x16x32_bf16 v[76:79], v[216:219], v[40:43], v[16:19]
    v_exp_f32 v119, v119
    v_cvt_pk_bf16_f32 v252, v112, v113
    v_mfma_f32_16x16x32_bf16 v[84:87], v[216:219], v[44:47], v[20:23]
    ds_read_b128 v[212:215], v7 offset:40960
    v_cvt_pk_bf16_f32 v253, v114, v115
    v_cvt_pk_bf16_f32 v254, v116, v117
    v_mfma_f32_16x16x32_bf16 v[76:79], v[220:223], v[48:51], v[76:79]
    v_cvt_pk_bf16_f32 v255, v118, v119
    v_exp_f32 v120, v120
    v_mfma_f32_16x16x32_bf16 v[84:87], v[220:223], v[52:55], v[84:87]
    ds_read_b128 v[216:219], v4 offset:45056
    s_waitcnt lgkmcnt(5)
    v_mfma_f32_16x16x32_bf16 v[76:79], v[224:227], v[56:59], v[76:79]
    v_exp_f32 v121, v121
    v_mfma_f32_16x16x32_bf16 v[84:87], v[224:227], v[60:63], v[84:87]
    ds_read_b128 v[220:223], v5 offset:45056
    v_exp_f32 v122, v122
    v_mfma_f32_16x16x32_bf16 v[76:79], v[228:231], v[64:67], v[76:79]
    v_exp_f32 v123, v123
    v_mfma_f32_16x16x32_bf16 v[84:87], v[228:231], v[68:71], v[84:87]
    ds_read_b128 v[224:227], v6 offset:45056
    s_waitcnt lgkmcnt(5)
    v_mfma_f32_16x16x32_bf16 v[88:91], v[200:203], v[40:43], v[16:19]
    v_exp_f32 v124, v124
    v_mfma_f32_16x16x32_bf16 v[96:99], v[200:203], v[44:47], v[20:23]
    ds_read_b128 v[228:231], v7 offset:45056
    v_exp_f32 v125, v125
    v_mfma_f32_16x16x32_bf16 v[88:91], v[204:207], v[48:51], v[88:91]
    v_exp_f32 v126, v126
    v_mfma_f32_16x16x32_bf16 v[96:99], v[204:207], v[52:55], v[96:99]
    ds_read_b128 v[200:203], v4 offset:49152
    s_waitcnt lgkmcnt(5)
    v_mfma_f32_16x16x32_bf16 v[88:91], v[208:211], v[56:59], v[88:91]
    v_exp_f32 v127, v127
    v_mfma_f32_16x16x32_bf16 v[96:99], v[208:211], v[60:63], v[96:99]
    ds_read_b128 v[204:207], v5 offset:49152
    v_exp_f32 v128, v128
    v_mfma_f32_16x16x32_bf16 v[88:91], v[212:215], v[64:67], v[88:91]
    v_exp_f32 v129, v129
    v_cvt_pk_bf16_f32 v8, v120, v121
    v_mfma_f32_16x16x32_bf16 v[96:99], v[212:215], v[68:71], v[96:99]
    ds_read_b128 v[208:211], v6 offset:49152
    v_cvt_pk_bf16_f32 v9, v122, v123
    v_mfma_f32_16x16x32_bf16 v[24:27], v[32:35], v[240:243], v[24:27]
    v_cvt_pk_bf16_f32 v10, v124, v125
    v_cvt_pk_bf16_f32 v11, v126, v127
    v_mfma_f32_16x16x32_bf16 v[28:31], v[32:35], v[244:247], v[28:31]
    v_exp_f32 v130, v130
    s_waitcnt lgkmcnt(5)
    v_mfma_f32_16x16x32_bf16 v[92:95], v[216:219], v[40:43], v[16:19]
    v_exp_f32 v131, v131
    v_mfma_f32_16x16x32_bf16 v[100:103], v[216:219], v[44:47], v[20:23]
    ds_read_b128 v[212:215], v7 offset:49152
    v_exp_f32 v132, v132
    v_mfma_f32_16x16x32_bf16 v[92:95], v[220:223], v[48:51], v[92:95]
    v_exp_f32 v133, v133
    v_mfma_f32_16x16x32_bf16 v[100:103], v[220:223], v[52:55], v[100:103]
    ds_read_b128 v[216:219], v4 offset:53248
    s_waitcnt lgkmcnt(5)
    v_mfma_f32_16x16x32_bf16 v[92:95], v[224:227], v[56:59], v[92:95]
    v_exp_f32 v134, v134
    v_mfma_f32_16x16x32_bf16 v[100:103], v[224:227], v[60:63], v[100:103]
    ds_read_b128 v[220:223], v5 offset:53248
    v_exp_f32 v135, v135
    v_mfma_f32_16x16x32_bf16 v[92:95], v[228:231], v[64:67], v[92:95]
    v_cvt_pk_bf16_f32 v12, v128, v129
    v_cvt_pk_bf16_f32 v13, v130, v131
    v_cvt_pk_bf16_f32 v14, v132, v133
    v_mfma_f32_16x16x32_bf16 v[100:103], v[228:231], v[68:71], v[100:103]
    ds_read_b128 v[224:227], v6 offset:53248
    v_cvt_pk_bf16_f32 v15, v134, v135
    s_waitcnt lgkmcnt(5)
    v_mfma_f32_16x16x32_bf16 v[104:107], v[200:203], v[40:43], v[16:19]
    v_max_f32 v36, v72, v73
    v_max_f32 v37, v80, v81
    v_max3_f32 v36, v74, v75, v36
    v_mfma_f32_16x16x32_bf16 v[112:115], v[200:203], v[44:47], v[20:23]
    ds_read_b128 v[228:231], v7 offset:53248
    v_max3_f32 v37, v82, v83, v37
    v_max3_f32 v36, v76, v77, v36
    v_mfma_f32_16x16x32_bf16 v[104:107], v[204:207], v[48:51], v[104:107]
    v_max3_f32 v37, v84, v85, v37
    v_max3_f32 v36, v78, v79, v36
    v_max3_f32 v37, v86, v87, v37
    v_mfma_f32_16x16x32_bf16 v[112:115], v[204:207], v[52:55], v[112:115]
    ds_read_b128 v[200:203], v4 offset:57344
    s_waitcnt lgkmcnt(5)
    v_mfma_f32_16x16x32_bf16 v[104:107], v[208:211], v[56:59], v[104:107]
    v_exp_f32 v72, v72
    v_mfma_f32_16x16x32_bf16 v[112:115], v[208:211], v[60:63], v[112:115]
    ds_read_b128 v[204:207], v5 offset:57344
    v_exp_f32 v73, v73
    v_mfma_f32_16x16x32_bf16 v[104:107], v[212:215], v[64:67], v[104:107]
    v_exp_f32 v74, v74
    v_mfma_f32_16x16x32_bf16 v[112:115], v[212:215], v[68:71], v[112:115]
    ds_read_b128 v[208:211], v6 offset:57344
    v_mfma_f32_16x16x32_bf16 v[24:27], v[32:35], v[248:251], v[24:27]
    v_exp_f32 v75, v75
    v_mfma_f32_16x16x32_bf16 v[28:31], v[32:35], v[252:255], v[28:31]
    v_exp_f32 v76, v76
    s_waitcnt lgkmcnt(5)
    v_mfma_f32_16x16x32_bf16 v[108:111], v[216:219], v[40:43], v[16:19]
    v_exp_f32 v77, v77
    v_mfma_f32_16x16x32_bf16 v[116:119], v[216:219], v[44:47], v[20:23]
    ds_read_b128 v[212:215], v7 offset:57344
    v_exp_f32 v78, v78
    v_mfma_f32_16x16x32_bf16 v[108:111], v[220:223], v[48:51], v[108:111]
    v_exp_f32 v79, v79
    v_mfma_f32_16x16x32_bf16 v[116:119], v[220:223], v[52:55], v[116:119]
    ds_read_b128 v[216:219], v4 offset:61440
    s_waitcnt lgkmcnt(5)
    v_mfma_f32_16x16x32_bf16 v[108:111], v[224:227], v[56:59], v[108:111]
    v_exp_f32 v80, v80
    v_mfma_f32_16x16x32_bf16 v[116:119], v[224:227], v[60:63], v[116:119]
    ds_read_b128 v[220:223], v5 offset:61440
    v_exp_f32 v81, v81
    v_mfma_f32_16x16x32_bf16 v[108:111], v[228:231], v[64:67], v[108:111]
    v_cvt_pk_bf16_f32 v72, v72, v73
    v_cvt_pk_bf16_f32 v73, v74, v75
    v_cvt_pk_bf16_f32 v74, v76, v77
    v_mfma_f32_16x16x32_bf16 v[116:119], v[228:231], v[68:71], v[116:119]
    ds_read_b128 v[224:227], v6 offset:61440
    v_cvt_pk_bf16_f32 v75, v78, v79
    s_waitcnt lgkmcnt(5)
    v_mfma_f32_16x16x32_bf16 v[120:123], v[200:203], v[40:43], v[16:19]
    v_exp_f32 v82, v82
    v_mfma_f32_16x16x32_bf16 v[128:131], v[200:203], v[44:47], v[20:23]
    ds_read_b128 v[228:231], v7 offset:61440
    v_exp_f32 v83, v83
    v_mfma_f32_16x16x32_bf16 v[120:123], v[204:207], v[48:51], v[120:123]
    v_exp_f32 v84, v84
    v_mfma_f32_16x16x32_bf16 v[128:131], v[204:207], v[52:55], v[128:131]
    v_exp_f32 v85, v85
    s_waitcnt lgkmcnt(4)
    v_mfma_f32_16x16x32_bf16 v[120:123], v[208:211], v[56:59], v[120:123]
    v_exp_f32 v86, v86
    v_mfma_f32_16x16x32_bf16 v[128:131], v[208:211], v[60:63], v[128:131]
    v_exp_f32 v87, v87
    v_cvt_pk_bf16_f32 v80, v80, v81
    v_mfma_f32_16x16x32_bf16 v[120:123], v[212:215], v[64:67], v[120:123]
    v_cvt_pk_bf16_f32 v81, v82, v83
    v_cvt_pk_bf16_f32 v82, v84, v85
    v_cvt_pk_bf16_f32 v83, v86, v87
    v_mfma_f32_16x16x32_bf16 v[128:131], v[212:215], v[68:71], v[128:131]
    v_max3_f32 v36, v88, v89, v36
    v_max3_f32 v37, v96, v97, v37
    v_mfma_f32_16x16x32_bf16 v[24:27], v[32:35], v[8:11], v[24:27]
    v_max3_f32 v36, v90, v91, v36
    v_max3_f32 v37, v98, v99, v37
    v_max3_f32 v36, v92, v93, v36
    v_mfma_f32_16x16x32_bf16 v[28:31], v[32:35], v[12:15], v[28:31]
    v_max3_f32 v37, v100, v101, v37
    v_max3_f32 v36, v94, v95, v36
    v_max3_f32 v37, v102, v103, v37
    s_waitcnt lgkmcnt(2)
    v_mfma_f32_16x16x32_bf16 v[124:127], v[216:219], v[40:43], v[16:19]
    v_max3_f32 v36, v104, v105, v36
    v_max3_f32 v37, v112, v113, v37
    v_max3_f32 v36, v106, v107, v36
    v_mfma_f32_16x16x32_bf16 v[132:135], v[216:219], v[44:47], v[20:23]
    v_max3_f32 v37, v114, v115, v37
    v_max3_f32 v36, v108, v109, v36
    v_max3_f32 v37, v116, v117, v37
    v_mfma_f32_16x16x32_bf16 v[124:127], v[220:223], v[48:51], v[124:127]
    v_max3_f32 v36, v110, v111, v36
    v_max3_f32 v37, v118, v119, v37
    v_mfma_f32_16x16x32_bf16 v[132:135], v[220:223], v[52:55], v[132:135]
    v_exp_f32 v88, v88
    s_waitcnt lgkmcnt(0)
    v_mfma_f32_16x16x32_bf16 v[124:127], v[224:227], v[56:59], v[124:127]
    v_exp_f32 v89, v89
    v_mfma_f32_16x16x32_bf16 v[132:135], v[224:227], v[60:63], v[132:135]
    v_exp_f32 v90, v90
    v_mfma_f32_16x16x32_bf16 v[124:127], v[228:231], v[64:67], v[124:127]
    v_exp_f32 v91, v91
    v_mfma_f32_16x16x32_bf16 v[132:135], v[228:231], v[68:71], v[132:135]
    v_exp_f32 v92, v92
    v_exp_f32 v93, v93
    v_exp_f32 v94, v94
    v_exp_f32 v95, v95
    v_exp_f32 v96, v96
    v_max3_f32 v36, v120, v121, v36
    v_max3_f32 v37, v128, v129, v37
    v_max3_f32 v36, v122, v123, v36
    v_max3_f32 v37, v130, v131, v37
    v_max3_f32 v36, v124, v125, v36
    v_max3_f32 v37, v132, v133, v37
    v_max3_f32 v36, v126, v127, v36
    v_max3_f32 v37, v134, v135, v37
    v_max_f32 v38, v36, v37
    v_cmp_lt_f32 vcc, 0, v38
    v_exp_f32 v97, v97
    v_cvt_pk_bf16_f32 v88, v88, v89
    s_nop 1
    s_cbranch_vccnz L_rd3
L_nr3:
    v_lshrrev_b32 v38, 4, v2
    v_lshrrev_b32 v3, 2, v38
    v_and_b32 v39, 7, v3
    v_lshlrev_b32 v3, 8, v3
    v_lshl_add_u32 v3, v39, 5, v3
    v_and_b32 v39, 3, v38
    v_lshl_add_u32 v3, v39, 3, v3
    v_add_u32 v16, 131072, v3
    v_xor_b32 v17, 32, v16
    v_xor_b32 v18, 64, v16
    v_xor_b32 v19, 96, v16
    v_xor_b32 v20, 128, v16
    v_xor_b32 v21, 160, v16
    v_xor_b32 v22, 192, v16
    v_xor_b32 v23, 224, v16
    s_waitcnt lgkmcnt(0)
    s_barrier
    ds_read_b64_tr_b16 v[200:201], v16 offset:0
    ds_read_b64_tr_b16 v[202:203], v16 offset:4096
    ds_read_b64_tr_b16 v[204:205], v17 offset:0
    ds_read_b64_tr_b16 v[206:207], v17 offset:4096
    ds_read_b64_tr_b16 v[208:209], v18 offset:0
    ds_read_b64_tr_b16 v[210:211], v18 offset:4096
    ds_read_b64_tr_b16 v[212:213], v19 offset:0
    ds_read_b64_tr_b16 v[214:215], v19 offset:4096
    ds_read_b64_tr_b16 v[216:217], v20 offset:0
    ds_read_b64_tr_b16 v[218:219], v20 offset:4096
    ds_read_b64_tr_b16 v[220:221], v21 offset:0
    ds_read_b64_tr_b16 v[222:223], v21 offset:4096
    ds_read_b64_tr_b16 v[224:225], v22 offset:0
    ds_read_b64_tr_b16 v[226:227], v22 offset:4096
    v_cvt_pk_bf16_f32 v89, v90, v91
    v_cvt_pk_bf16_f32 v90, v92, v93
    v_cvt_pk_bf16_f32 v91, v94, v95
    v_exp_f32 v98, v98
    v_exp_f32 v99, v99
    v_exp_f32 v100, v100
    v_exp_f32 v101, v101
    v_exp_f32 v102, v102
    v_exp_f32 v103, v103
    v_cvt_pk_bf16_f32 v96, v96, v97
    v_cvt_pk_bf16_f32 v97, v98, v99
    v_cvt_pk_bf16_f32 v98, v100, v101
    v_cvt_pk_bf16_f32 v99, v102, v103
    v_exp_f32 v104, v104
    v_exp_f32 v105, v105
    v_exp_f32 v106, v106
    s_waitcnt lgkmcnt(10)
    v_mfma_f32_16x16x32_bf16 v[40:43], v[200:203], v[136:139], 0
    ds_read_b64_tr_b16 v[228:229], v23 offset:0
    v_exp_f32 v107, v107
    v_mfma_f32_16x16x32_bf16 v[44:47], v[200:203], v[140:143], 0
    ds_read_b64_tr_b16 v[230:231], v23 offset:4096
    v_exp_f32 v108, v108
    v_mfma_f32_16x16x32_bf16 v[48:51], v[204:207], v[136:139], 0
    ds_read_b64_tr_b16 v[200:201], v16 offset:8192
    v_exp_f32 v109, v109
    v_mfma_f32_16x16x32_bf16 v[52:55], v[204:207], v[140:143], 0
    ds_read_b64_tr_b16 v[202:203], v16 offset:12288
    s_waitcnt lgkmcnt(10)
    v_mfma_f32_16x16x32_bf16 v[56:59], v[208:211], v[136:139], 0
    ds_read_b64_tr_b16 v[204:205], v17 offset:8192
    v_exp_f32 v110, v110
    v_mfma_f32_16x16x32_bf16 v[60:63], v[208:211], v[140:143], 0
    ds_read_b64_tr_b16 v[206:207], v17 offset:12288
    v_exp_f32 v111, v111
    v_mfma_f32_16x16x32_bf16 v[64:67], v[212:215], v[136:139], 0
    ds_read_b64_tr_b16 v[208:209], v18 offset:8192
    v_exp_f32 v112, v112
    v_mfma_f32_16x16x32_bf16 v[68:71], v[212:215], v[140:143], 0
    ds_read_b64_tr_b16 v[210:211], v18 offset:12288
    v_mfma_f32_16x16x32_bf16 v[24:27], v[32:35], v[72:75], v[24:27]
    v_exp_f32 v113, v113
    v_cvt_pk_bf16_f32 v104, v104, v105
    v_mfma_f32_16x16x32_bf16 v[28:31], v[32:35], v[80:83], v[28:31]
    v_cvt_pk_bf16_f32 v105, v106, v107
    v_cvt_pk_bf16_f32 v106, v108, v109
    v_cvt_pk_bf16_f32 v107, v110, v111
    s_waitcnt lgkmcnt(10)
    v_mfma_f32_16x16x32_bf16 v[40:43], v[216:219], v[168:171], v[40:43]
    ds_read_b64_tr_b16 v[212:213], v19 offset:8192
    v_exp_f32 v114, v114
    v_mfma_f32_16x16x32_bf16 v[44:47], v[216:219], v[172:175], v[44:47]
    ds_read_b64_tr_b16 v[214:215], v19 offset:12288
    v_exp_f32 v115, v115
    v_mfma_f32_16x16x32_bf16 v[48:51], v[220:223], v[168:171], v[48:51]
    ds_read_b64_tr_b16 v[216:217], v20 offset:8192
    v_exp_f32 v116, v116
    v_mfma_f32_16x16x32_bf16 v[52:55], v[220:223], v[172:175], v[52:55]
    ds_read_b64_tr_b16 v[218:219], v20 offset:12288
    s_waitcnt lgkmcnt(10)
    v_mfma_f32_16x16x32_bf16 v[56:59], v[224:227], v[168:171], v[56:59]
    ds_read_b64_tr_b16 v[220:221], v21 offset:8192
    v_exp_f32 v117, v117
    v_mfma_f32_16x16x32_bf16 v[60:63], v[224:227], v[172:175], v[60:63]
    ds_read_b64_tr_b16 v[222:223], v21 offset:12288
    v_exp_f32 v118, v118
    v_mfma_f32_16x16x32_bf16 v[64:67], v[228:231], v[168:171], v[64:67]
    ds_read_b64_tr_b16 v[224:225], v22 offset:8192
    v_exp_f32 v119, v119
    v_mfma_f32_16x16x32_bf16 v[68:71], v[228:231], v[172:175], v[68:71]
    ds_read_b64_tr_b16 v[226:227], v22 offset:12288
    v_cvt_pk_bf16_f32 v112, v112, v113
    s_waitcnt lgkmcnt(10)
    v_mfma_f32_16x16x32_bf16 v[40:43], v[200:203], v[144:147], v[40:43]
    ds_read_b64_tr_b16 v[228:229], v23 offset:8192
    v_cvt_pk_bf16_f32 v113, v114, v115
    v_cvt_pk_bf16_f32 v114, v116, v117
    v_mfma_f32_16x16x32_bf16 v[44:47], v[200:203], v[148:151], v[44:47]
    ds_read_b64_tr_b16 v[230:231], v23 offset:12288
    v_cvt_pk_bf16_f32 v115, v118, v119
    v_mfma_f32_16x16x32_bf16 v[48:51], v[204:207], v[144:147], v[48:51]
    ds_read_b64_tr_b16 v[200:201], v16 offset:16384
    v_exp_f32 v120, v120
    v_mfma_f32_16x16x32_bf16 v[52:55], v[204:207], v[148:151], v[52:55]
    ds_read_b64_tr_b16 v[202:203], v16 offset:20480
    s_waitcnt lgkmcnt(10)
    v_mfma_f32_16x16x32_bf16 v[56:59], v[208:211], v[144:147], v[56:59]
    ds_read_b64_tr_b16 v[204:205], v17 offset:16384
    v_exp_f32 v121, v121
    v_mfma_f32_16x16x32_bf16 v[60:63], v[208:211], v[148:151], v[60:63]
    ds_read_b64_tr_b16 v[206:207], v17 offset:20480
    v_exp_f32 v122, v122
    v_mfma_f32_16x16x32_bf16 v[64:67], v[212:215], v[144:147], v[64:67]
    ds_read_b64_tr_b16 v[208:209], v18 offset:16384
    v_exp_f32 v123, v123
    v_mfma_f32_16x16x32_bf16 v[68:71], v[212:215], v[148:151], v[68:71]
    ds_read_b64_tr_b16 v[210:211], v18 offset:20480
    v_mfma_f32_16x16x32_bf16 v[24:27], v[32:35], v[88:91], v[24:27]
    v_exp_f32 v124, v124
    v_mfma_f32_16x16x32_bf16 v[28:31], v[32:35], v[96:99], v[28:31]
    v_exp_f32 v125, v125
    s_waitcnt lgkmcnt(10)
    v_mfma_f32_16x16x32_bf16 v[40:43], v[216:219], v[176:179], v[40:43]
    ds_read_b64_tr_b16 v[212:213], v19 offset:16384
    v_exp_f32 v126, v126
    v_mfma_f32_16x16x32_bf16 v[44:47], v[216:219], v[180:183], v[44:47]
    ds_read_b64_tr_b16 v[214:215], v19 offset:20480
    v_exp_f32 v127, v127
    v_mfma_f32_16x16x32_bf16 v[48:51], v[220:223], v[176:179], v[48:51]
    ds_read_b64_tr_b16 v[216:217], v20 offset:16384
    v_exp_f32 v128, v128
    v_mfma_f32_16x16x32_bf16 v[52:55], v[220:223], v[180:183], v[52:55]
    ds_read_b64_tr_b16 v[218:219], v20 offset:20480
    s_waitcnt lgkmcnt(10)
    v_mfma_f32_16x16x32_bf16 v[56:59], v[224:227], v[176:179], v[56:59]
    ds_read_b64_tr_b16 v[220:221], v21 offset:16384
    v_exp_f32 v129, v129
    v_mfma_f32_16x16x32_bf16 v[60:63], v[224:227], v[180:183], v[60:63]
    ds_read_b64_tr_b16 v[222:223], v21 offset:20480
    v_cvt_pk_bf16_f32 v120, v120, v121
    v_cvt_pk_bf16_f32 v121, v122, v123
    v_mfma_f32_16x16x32_bf16 v[64:67], v[228:231], v[176:179], v[64:67]
    ds_read_b64_tr_b16 v[224:225], v22 offset:16384
    v_cvt_pk_bf16_f32 v122, v124, v125
    v_cvt_pk_bf16_f32 v123, v126, v127
    v_mfma_f32_16x16x32_bf16 v[68:71], v[228:231], v[180:183], v[68:71]
    ds_read_b64_tr_b16 v[226:227], v22 offset:20480
    s_waitcnt lgkmcnt(10)
    v_mfma_f32_16x16x32_bf16 v[40:43], v[200:203], v[152:155], v[40:43]
    ds_read_b64_tr_b16 v[228:229], v23 offset:16384
    v_exp_f32 v130, v130
    v_mfma_f32_16x16x32_bf16 v[44:47], v[200:203], v[156:159], v[44:47]
    ds_read_b64_tr_b16 v[230:231], v23 offset:20480
    v_exp_f32 v131, v131
    v_mfma_f32_16x16x32_bf16 v[48:51], v[204:207], v[152:155], v[48:51]
    ds_read_b64_tr_b16 v[200:201], v16 offset:24576
    v_exp_f32 v132, v132
    v_mfma_f32_16x16x32_bf16 v[52:55], v[204:207], v[156:159], v[52:55]
    ds_read_b64_tr_b16 v[202:203], v16 offset:28672
    s_waitcnt lgkmcnt(10)
    v_mfma_f32_16x16x32_bf16 v[56:59], v[208:211], v[152:155], v[56:59]
    ds_read_b64_tr_b16 v[204:205], v17 offset:24576
    v_exp_f32 v133, v133
    v_mfma_f32_16x16x32_bf16 v[60:63], v[208:211], v[156:159], v[60:63]
    ds_read_b64_tr_b16 v[206:207], v17 offset:28672
    v_exp_f32 v134, v134
    v_mfma_f32_16x16x32_bf16 v[64:67], v[212:215], v[152:155], v[64:67]
    ds_read_b64_tr_b16 v[208:209], v18 offset:24576
    v_exp_f32 v135, v135
    v_mfma_f32_16x16x32_bf16 v[68:71], v[212:215], v[156:159], v[68:71]
    ds_read_b64_tr_b16 v[210:211], v18 offset:28672
    v_cvt_pk_bf16_f32 v128, v128, v129
    v_mfma_f32_16x16x32_bf16 v[24:27], v[32:35], v[104:107], v[24:27]
    v_cvt_pk_bf16_f32 v129, v130, v131
    v_cvt_pk_bf16_f32 v130, v132, v133
    v_cvt_pk_bf16_f32 v131, v134, v135
    v_mfma_f32_16x16x32_bf16 v[28:31], v[32:35], v[112:115], v[28:31]
    v_add_u32 v16, 4294901760, v16
    v_add_u32 v17, 4294901760, v17
    s_waitcnt lgkmcnt(10)
    v_mfma_f32_16x16x32_bf16 v[40:43], v[216:219], v[184:187], v[40:43]
    ds_read_b64_tr_b16 v[212:213], v19 offset:24576
    v_add_u32 v18, 4294901760, v18
    v_mfma_f32_16x16x32_bf16 v[44:47], v[216:219], v[188:191], v[44:47]
    ds_read_b64_tr_b16 v[214:215], v19 offset:28672
    v_mfma_f32_16x16x32_bf16 v[48:51], v[220:223], v[184:187], v[48:51]
    ds_read_b64_tr_b16 v[216:217], v20 offset:24576
    v_add_u32 v19, 4294901760, v19
    v_mfma_f32_16x16x32_bf16 v[52:55], v[220:223], v[188:191], v[52:55]
    ds_read_b64_tr_b16 v[218:219], v20 offset:28672
    s_waitcnt lgkmcnt(10)
    v_mfma_f32_16x16x32_bf16 v[56:59], v[224:227], v[184:187], v[56:59]
    ds_read_b64_tr_b16 v[220:221], v21 offset:24576
    v_add_u32 v20, 4294901760, v20
    v_mfma_f32_16x16x32_bf16 v[60:63], v[224:227], v[188:191], v[60:63]
    ds_read_b64_tr_b16 v[222:223], v21 offset:28672
    v_mfma_f32_16x16x32_bf16 v[64:67], v[228:231], v[184:187], v[64:67]
    ds_read_b64_tr_b16 v[224:225], v22 offset:24576
    v_add_u32 v21, 4294901760, v21
    v_mfma_f32_16x16x32_bf16 v[68:71], v[228:231], v[188:191], v[68:71]
    ds_read_b64_tr_b16 v[226:227], v22 offset:28672
    s_waitcnt lgkmcnt(10)
    v_mfma_f32_16x16x32_bf16 v[40:43], v[200:203], v[160:163], v[40:43]
    ds_read_b64_tr_b16 v[228:229], v23 offset:24576
    v_add_u32 v22, 4294901760, v22
    v_mfma_f32_16x16x32_bf16 v[44:47], v[200:203], v[164:167], v[44:47]
    ds_read_b64_tr_b16 v[230:231], v23 offset:28672
    v_mfma_f32_16x16x32_bf16 v[48:51], v[204:207], v[160:163], v[48:51]
    v_add_u32 v23, 4294901760, v23
    v_mfma_f32_16x16x32_bf16 v[52:55], v[204:207], v[164:167], v[52:55]
    s_waitcnt lgkmcnt(8)
    v_mfma_f32_16x16x32_bf16 v[56:59], v[208:211], v[160:163], v[56:59]
    v_mfma_f32_16x16x32_bf16 v[60:63], v[208:211], v[164:167], v[60:63]
    v_mfma_f32_16x16x32_bf16 v[64:67], v[212:215], v[160:163], v[64:67]
    v_mfma_f32_16x16x32_bf16 v[68:71], v[212:215], v[164:167], v[68:71]
    v_mfma_f32_16x16x32_bf16 v[24:27], v[32:35], v[120:123], v[24:27]
    v_mfma_f32_16x16x32_bf16 v[28:31], v[32:35], v[128:131], v[28:31]
    s_waitcnt lgkmcnt(0)
    s_barrier
    ds_read_b64_tr_b16 v[200:201], v16 offset:0
    ds_read_b64_tr_b16 v[202:203], v16 offset:4096
    ds_read_b64_tr_b16 v[204:205], v17 offset:0
    ds_read_b64_tr_b16 v[206:207], v17 offset:4096
    ds_read_b64_tr_b16 v[208:209], v18 offset:0
    ds_read_b64_tr_b16 v[210:211], v18 offset:4096
    v_mfma_f32_16x16x32_bf16 v[40:43], v[216:219], v[192:195], v[40:43]
    ds_read_b64_tr_b16 v[212:213], v19 offset:0
    v_mfma_f32_16x16x32_bf16 v[44:47], v[216:219], v[196:199], v[44:47]
    ds_read_b64_tr_b16 v[214:215], v19 offset:4096
    v_mfma_f32_16x16x32_bf16 v[48:51], v[220:223], v[192:195], v[48:51]
    ds_read_b64_tr_b16 v[216:217], v20 offset:0
    v_mfma_f32_16x16x32_bf16 v[52:55], v[220:223], v[196:199], v[52:55]
    ds_read_b64_tr_b16 v[218:219], v20 offset:4096
    v_mfma_f32_16x16x32_bf16 v[56:59], v[224:227], v[192:195], v[56:59]
    ds_read_b64_tr_b16 v[220:221], v21 offset:0
    v_lshrrev_b32 v4, 1, v2
    v_and_b32 v4, 24, v4
    v_mfma_f32_16x16x32_bf16 v[60:63], v[224:227], v[196:199], v[60:63]
    ds_read_b64_tr_b16 v[222:223], v21 offset:4096
    buffer_load_dwordx2 v[6:7], v4, s[68:71], s99 offen offset:64 sc1
    v_mfma_f32_16x16x32_bf16 v[64:67], v[228:231], v[192:195], v[64:67]
    ds_read_b64_tr_b16 v[224:225], v22 offset:0
    v_mfma_f32_16x16x32_bf16 v[68:71], v[228:231], v[196:199], v[68:71]
    ds_read_b64_tr_b16 v[226:227], v22 offset:4096
    s_waitcnt lgkmcnt(10)
    v_mfma_f32_16x16x32_bf16 v[40:43], v[200:203], v[232:235], v[40:43]
    ds_read_b64_tr_b16 v[228:229], v23 offset:0
    v_mfma_f32_16x16x32_bf16 v[44:47], v[200:203], v[236:239], v[44:47]
    ds_read_b64_tr_b16 v[230:231], v23 offset:4096
    v_mfma_f32_16x16x32_bf16 v[48:51], v[204:207], v[232:235], v[48:51]
    ds_read_b64_tr_b16 v[200:201], v16 offset:8192
    v_rcp_f32 v36, v24
    v_mfma_f32_16x16x32_bf16 v[52:55], v[204:207], v[236:239], v[52:55]
    ds_read_b64_tr_b16 v[202:203], v16 offset:12288
    s_waitcnt lgkmcnt(10)
    v_mfma_f32_16x16x32_bf16 v[56:59], v[208:211], v[232:235], v[56:59]
    ds_read_b64_tr_b16 v[204:205], v17 offset:8192
    v_rcp_f32 v37, v28
    v_mfma_f32_16x16x32_bf16 v[60:63], v[208:211], v[236:239], v[60:63]
    ds_read_b64_tr_b16 v[206:207], v17 offset:12288
    v_mfma_f32_16x16x32_bf16 v[64:67], v[212:215], v[232:235], v[64:67]
    ds_read_b64_tr_b16 v[208:209], v18 offset:8192
    v_mfma_f32_16x16x32_bf16 v[68:71], v[212:215], v[236:239], v[68:71]
    ds_read_b64_tr_b16 v[210:211], v18 offset:12288
    s_waitcnt lgkmcnt(10)
    v_mfma_f32_16x16x32_bf16 v[40:43], v[216:219], v[72:75], v[40:43]
    ds_read_b64_tr_b16 v[212:213], v19 offset:8192
    v_mfma_f32_16x16x32_bf16 v[44:47], v[216:219], v[80:83], v[44:47]
    ds_read_b64_tr_b16 v[214:215], v19 offset:12288
    v_mfma_f32_16x16x32_bf16 v[48:51], v[220:223], v[72:75], v[48:51]
    ds_read_b64_tr_b16 v[216:217], v20 offset:8192
    v_mfma_f32_16x16x32_bf16 v[52:55], v[220:223], v[80:83], v[52:55]
    ds_read_b64_tr_b16 v[218:219], v20 offset:12288
    s_waitcnt lgkmcnt(10)
    v_mfma_f32_16x16x32_bf16 v[56:59], v[224:227], v[72:75], v[56:59]
    ds_read_b64_tr_b16 v[220:221], v21 offset:8192
    v_mfma_f32_16x16x32_bf16 v[60:63], v[224:227], v[80:83], v[60:63]
    ds_read_b64_tr_b16 v[222:223], v21 offset:12288
    v_mfma_f32_16x16x32_bf16 v[64:67], v[228:231], v[72:75], v[64:67]
    ds_read_b64_tr_b16 v[224:225], v22 offset:8192
    v_mfma_f32_16x16x32_bf16 v[68:71], v[228:231], v[80:83], v[68:71]
    ds_read_b64_tr_b16 v[226:227], v22 offset:12288
    s_waitcnt lgkmcnt(10)
    v_mfma_f32_16x16x32_bf16 v[40:43], v[200:203], v[240:243], v[40:43]
    ds_read_b64_tr_b16 v[228:229], v23 offset:8192
    v_mfma_f32_16x16x32_bf16 v[44:47], v[200:203], v[244:247], v[44:47]
    ds_read_b64_tr_b16 v[230:231], v23 offset:12288
    v_mfma_f32_16x16x32_bf16 v[48:51], v[204:207], v[240:243], v[48:51]
    ds_read_b64_tr_b16 v[200:201], v16 offset:16384
    v_mfma_f32_16x16x32_bf16 v[52:55], v[204:207], v[244:247], v[52:55]
    ds_read_b64_tr_b16 v[202:203], v16 offset:20480
    s_waitcnt lgkmcnt(10)
    v_mfma_f32_16x16x32_bf16 v[56:59], v[208:211], v[240:243], v[56:59]
    ds_read_b64_tr_b16 v[204:205], v20 offset:16384
    v_mfma_f32_16x16x32_bf16 v[60:63], v[208:211], v[244:247], v[60:63]
    ds_read_b64_tr_b16 v[206:207], v20 offset:20480
    v_mfma_f32_16x16x32_bf16 v[64:67], v[212:215], v[240:243], v[64:67]
    ds_read_b64_tr_b16 v[208:209], v16 offset:24576
    v_mfma_f32_16x16x32_bf16 v[68:71], v[212:215], v[244:247], v[68:71]
    ds_read_b64_tr_b16 v[210:211], v16 offset:28672
    s_waitcnt lgkmcnt(10)
    v_mfma_f32_16x16x32_bf16 v[40:43], v[216:219], v[88:91], v[40:43]
    ds_read_b64_tr_b16 v[212:213], v20 offset:24576
    v_mfma_f32_16x16x32_bf16 v[44:47], v[216:219], v[96:99], v[44:47]
    ds_read_b64_tr_b16 v[214:215], v20 offset:28672
    v_mfma_f32_16x16x32_bf16 v[48:51], v[220:223], v[88:91], v[48:51]
    ds_read_b64_tr_b16 v[216:217], v17 offset:16384
    v_mfma_f32_16x16x32_bf16 v[52:55], v[220:223], v[96:99], v[52:55]
    ds_read_b64_tr_b16 v[218:219], v17 offset:20480
    s_waitcnt lgkmcnt(10)
    v_mfma_f32_16x16x32_bf16 v[56:59], v[224:227], v[88:91], v[56:59]
    ds_read_b64_tr_b16 v[220:221], v21 offset:16384
    v_mfma_f32_16x16x32_bf16 v[60:63], v[224:227], v[96:99], v[60:63]
    ds_read_b64_tr_b16 v[222:223], v21 offset:20480
    v_mfma_f32_16x16x32_bf16 v[64:67], v[228:231], v[88:91], v[64:67]
    ds_read_b64_tr_b16 v[224:225], v17 offset:24576
    v_mfma_f32_16x16x32_bf16 v[68:71], v[228:231], v[96:99], v[68:71]
    ds_read_b64_tr_b16 v[226:227], v17 offset:28672
    s_waitcnt lgkmcnt(10)
    v_mfma_f32_16x16x32_bf16 v[40:43], v[200:203], v[248:251], v[40:43]
    ds_read_b64_tr_b16 v[228:229], v21 offset:24576
    v_mfma_f32_16x16x32_bf16 v[44:47], v[200:203], v[252:255], v[44:47]
    ds_read_b64_tr_b16 v[230:231], v21 offset:28672
    v_mfma_f32_16x16x32_bf16 v[40:43], v[204:207], v[104:107], v[40:43]
    ds_read_b64_tr_b16 v[200:201], v18 offset:16384
    v_mfma_f32_16x16x32_bf16 v[44:47], v[204:207], v[112:115], v[44:47]
    ds_read_b64_tr_b16 v[202:203], v18 offset:20480
    s_waitcnt lgkmcnt(10)
    v_mfma_f32_16x16x32_bf16 v[40:43], v[208:211], v[8:11], v[40:43]
    ds_read_b64_tr_b16 v[204:205], v22 offset:16384
    v_mfma_f32_16x16x32_bf16 v[44:47], v[208:211], v[12:15], v[44:47]
    ds_read_b64_tr_b16 v[206:207], v22 offset:20480
    v_mfma_f32_16x16x32_bf16 v[40:43], v[212:215], v[120:123], v[40:43]
    ds_read_b64_tr_b16 v[208:209], v18 offset:24576
    v_mfma_f32_16x16x32_bf16 v[44:47], v[212:215], v[128:131], v[44:47]
    ds_read_b64_tr_b16 v[210:211], v18 offset:28672
    s_waitcnt lgkmcnt(10)
    v_mfma_f32_16x16x32_bf16 v[48:51], v[216:219], v[248:251], v[48:51]
    ds_read_b64_tr_b16 v[212:213], v22 offset:24576
    v_mfma_f32_16x16x32_bf16 v[52:55], v[216:219], v[252:255], v[52:55]
    ds_read_b64_tr_b16 v[214:215], v22 offset:28672
    v_mul_f32 v40, v40, v36
    v_mul_f32 v41, v41, v36
    v_mul_f32 v42, v42, v36
    v_mul_f32 v43, v43, v36
    v_mfma_f32_16x16x32_bf16 v[48:51], v[220:223], v[104:107], v[48:51]
    ds_read_b64_tr_b16 v[216:217], v19 offset:16384
    v_cvt_pk_bf16_f32 v40, v40, v41
    v_cvt_pk_bf16_f32 v41, v42, v43
    v_or_b32 v40, 1, v40
    v_mul_f32 v44, v44, v37
    v_mfma_f32_16x16x32_bf16 v[52:55], v[220:223], v[112:115], v[52:55]
    ds_read_b64_tr_b16 v[218:219], v19 offset:20480
    v_mul_f32 v45, v45, v37
    v_mul_f32 v46, v46, v37
    v_mul_f32 v47, v47, v37
    s_waitcnt lgkmcnt(10)
    v_mfma_f32_16x16x32_bf16 v[48:51], v[224:227], v[8:11], v[48:51]
    ds_read_b64_tr_b16 v[220:221], v23 offset:16384
    v_cvt_pk_bf16_f32 v44, v44, v45
    v_cvt_pk_bf16_f32 v45, v46, v47
    v_or_b32 v44, 1, v44
    v_mfma_f32_16x16x32_bf16 v[52:55], v[224:227], v[12:15], v[52:55]
    ds_read_b64_tr_b16 v[222:223], v23 offset:20480
    v_mfma_f32_16x16x32_bf16 v[48:51], v[228:231], v[120:123], v[48:51]
    ds_read_b64_tr_b16 v[224:225], v19 offset:24576
    s_waitcnt vmcnt(0)
    v_cmp_ne_u64 vcc, s[92:93], v[6:7]
    v_mfma_f32_16x16x32_bf16 v[52:55], v[228:231], v[128:131], v[52:55]
    ds_read_b64_tr_b16 v[226:227], v19 offset:28672
    s_cbranch_vccnz L_x1
L_x1r:
    s_waitcnt lgkmcnt(10)
    v_mfma_f32_16x16x32_bf16 v[56:59], v[200:203], v[248:251], v[56:59]
    ds_read_b64_tr_b16 v[228:229], v23 offset:24576
    v_mfma_f32_16x16x32_bf16 v[60:63], v[200:203], v[252:255], v[60:63]
    ds_read_b64_tr_b16 v[230:231], v23 offset:28672
    v_mul_f32 v48, v48, v36
    v_mul_f32 v49, v49, v36
    v_mul_f32 v50, v50, v36
    v_mul_f32 v51, v51, v36
    v_mfma_f32_16x16x32_bf16 v[56:59], v[204:207], v[104:107], v[56:59]
    v_cvt_pk_bf16_f32 v42, v48, v49
    v_cvt_pk_bf16_f32 v43, v50, v51
    buffer_store_dwordx4 v[40:43], v2, s[68:71], s16 offen offset:0
    v_mul_f32 v52, v52, v37
    v_mfma_f32_16x16x32_bf16 v[60:63], v[204:207], v[112:115], v[60:63]
    v_mul_f32 v53, v53, v37
    v_mul_f32 v54, v54, v37
    v_mul_f32 v55, v55, v37
    v_cvt_pk_bf16_f32 v46, v52, v53
    s_waitcnt lgkmcnt(8)
    v_mfma_f32_16x16x32_bf16 v[56:59], v[208:211], v[8:11], v[56:59]
    v_cvt_pk_bf16_f32 v47, v54, v55
    buffer_store_dwordx4 v[44:47], v2, s[68:71], s16 offen offset:1024
    v_mfma_f32_16x16x32_bf16 v[60:63], v[208:211], v[12:15], v[60:63]
    v_mfma_f32_16x16x32_bf16 v[56:59], v[212:215], v[120:123], v[56:59]
    v_mfma_f32_16x16x32_bf16 v[60:63], v[212:215], v[128:131], v[60:63]
    s_waitcnt lgkmcnt(4)
    v_mfma_f32_16x16x32_bf16 v[64:67], v[216:219], v[248:251], v[64:67]
    v_mfma_f32_16x16x32_bf16 v[68:71], v[216:219], v[252:255], v[68:71]
    s_nop 3
    v_mul_f32 v56, v56, v36
    v_mul_f32 v57, v57, v36
    v_mul_f32 v58, v58, v36
    v_mul_f32 v59, v59, v36
    v_cvt_pk_bf16_f32 v56, v56, v57
    v_mfma_f32_16x16x32_bf16 v[64:67], v[220:223], v[104:107], v[64:67]
    v_cvt_pk_bf16_f32 v57, v58, v59
    v_or_b32 v56, 1, v56
    v_mul_f32 v60, v60, v37
    v_mul_f32 v61, v61, v37
    v_mul_f32 v62, v62, v37
    v_mfma_f32_16x16x32_bf16 v[68:71], v[220:223], v[112:115], v[68:71]
    v_mul_f32 v63, v63, v37
    v_cvt_pk_bf16_f32 v60, v60, v61
    v_cvt_pk_bf16_f32 v61, v62, v63
    v_or_b32 v60, 1, v60
    s_waitcnt lgkmcnt(0)
    v_mfma_f32_16x16x32_bf16 v[64:67], v[224:227], v[8:11], v[64:67]
    v_mfma_f32_16x16x32_bf16 v[68:71], v[224:227], v[12:15], v[68:71]
    v_mfma_f32_16x16x32_bf16 v[64:67], v[228:231], v[120:123], v[64:67]
    v_mfma_f32_16x16x32_bf16 v[68:71], v[228:231], v[128:131], v[68:71]
    s_nop 6
    v_mul_f32 v64, v64, v36
    v_mul_f32 v65, v65, v36
    v_mul_f32 v66, v66, v36
    v_mul_f32 v67, v67, v36
    v_cvt_pk_bf16_f32 v58, v64, v65
    v_cvt_pk_bf16_f32 v59, v66, v67
    buffer_store_dwordx4 v[56:59], v2, s[68:71], s16 offen offset:2048
    v_mul_f32 v68, v68, v37
    v_mul_f32 v69, v69, v37
    v_mul_f32 v70, v70, v37
    v_mul_f32 v71, v71, v37
    v_cvt_pk_bf16_f32 v62, v68, v69
    v_cvt_pk_bf16_f32 v63, v70, v71
    buffer_store_dwordx4 v[60:63], v2, s[68:71], s16 offen offset:3072
    s_cmp_lg_u32 s34, 0
    s_cbranch_scc1 L_x20
L_x2r0:
    s_waitcnt lgkmcnt(0)
    s_barrier
    ds_read_b64_tr_b16 v[200:201], v16 offset:32768
    ds_read_b64_tr_b16 v[202:203], v16 offset:36864
    ds_read_b64_tr_b16 v[204:205], v17 offset:32768
    ds_read_b64_tr_b16 v[206:207], v17 offset:36864
    ds_read_b64_tr_b16 v[208:209], v18 offset:32768
    ds_read_b64_tr_b16 v[210:211], v18 offset:36864
    ds_read_b64_tr_b16 v[212:213], v19 offset:32768
    ds_read_b64_tr_b16 v[214:215], v19 offset:36864
    ds_read_b64_tr_b16 v[216:217], v20 offset:32768
    ds_read_b64_tr_b16 v[218:219], v20 offset:36864
    ds_read_b64_tr_b16 v[220:221], v21 offset:32768
    ds_read_b64_tr_b16 v[222:223], v21 offset:36864
    ds_read_b64_tr_b16 v[224:225], v22 offset:32768
    ds_read_b64_tr_b16 v[226:227], v22 offset:36864
    s_waitcnt lgkmcnt(10)
    v_mfma_f32_16x16x32_bf16 v[76:79], v[200:203], v[136:139], 0
    ds_read_b64_tr_b16 v[228:229], v23 offset:32768
    v_mfma_f32_16x16x32_bf16 v[84:87], v[200:203], v[140:143], 0
    ds_read_b64_tr_b16 v[230:231], v23 offset:36864
    v_mfma_f32_16x16x32_bf16 v[92:95], v[204:207], v[136:139], 0
    ds_read_b64_tr_b16 v[200:201], v16 offset:40960
    v_mfma_f32_16x16x32_bf16 v[100:103], v[204:207], v[140:143], 0
    ds_read_b64_tr_b16 v[202:203], v16 offset:45056
    s_waitcnt lgkmcnt(10)
    v_mfma_f32_16x16x32_bf16 v[108:111], v[208:211], v[136:139], 0
    ds_read_b64_tr_b16 v[204:205], v17 offset:40960
    v_mfma_f32_16x16x32_bf16 v[116:119], v[208:211], v[140:143], 0
    ds_read_b64_tr_b16 v[206:207], v17 offset:45056
    v_mfma_f32_16x16x32_bf16 v[124:127], v[212:215], v[136:139], 0
    ds_read_b64_tr_b16 v[208:209], v18 offset:40960
    v_mfma_f32_16x16x32_bf16 v[132:135], v[212:215], v[140:143], 0
    ds_read_b64_tr_b16 v[210:211], v18 offset:45056
    s_waitcnt lgkmcnt(10)
    v_mfma_f32_16x16x32_bf16 v[76:79], v[216:219], v[168:171], v[76:79]
    ds_read_b64_tr_b16 v[212:213], v19 offset:40960
    v_mfma_f32_16x16x32_bf16 v[84:87], v[216:219], v[172:175], v[84:87]
    ds_read_b64_tr_b16 v[214:215], v19 offset:45056
    v_mfma_f32_16x16x32_bf16 v[92:95], v[220:223], v[168:171], v[92:95]
    ds_read_b64_tr_b16 v[216:217], v20 offset:40960
    v_mfma_f32_16x16x32_bf16 v[100:103], v[220:223], v[172:175], v[100:103]
    ds_read_b64_tr_b16 v[218:219], v20 offset:45056
    s_waitcnt lgkmcnt(10)
    v_mfma_f32_16x16x32_bf16 v[108:111], v[224:227], v[168:171], v[108:111]
    ds_read_b64_tr_b16 v[220:221], v21 offset:40960
    v_mfma_f32_16x16x32_bf16 v[116:119], v[224:227], v[172:175], v[116:119]
    ds_read_b64_tr_b16 v[222:223], v21 offset:45056
    v_mfma_f32_16x16x32_bf16 v[124:127], v[228:231], v[168:171], v[124:127]
    ds_read_b64_tr_b16 v[224:225], v22 offset:40960
    v_mfma_f32_16x16x32_bf16 v[132:135], v[228:231], v[172:175], v[132:135]
    ds_read_b64_tr_b16 v[226:227], v22 offset:45056
    s_waitcnt lgkmcnt(10)
    v_mfma_f32_16x16x32_bf16 v[76:79], v[200:203], v[144:147], v[76:79]
    ds_read_b64_tr_b16 v[228:229], v23 offset:40960
    v_lshrrev_b32 v57, 4, v2
    v_mul_u32_u24 v56, 3641, v57
    v_mfma_f32_16x16x32_bf16 v[84:87], v[200:203], v[148:151], v[84:87]
    ds_read_b64_tr_b16 v[230:231], v23 offset:45056
    v_mov_b32 v58, 864
    v_mad_u32_u16 v48, v56, v58, v2 op_sel:[1,0,0,0]
    v_mfma_f32_16x16x32_bf16 v[92:95], v[204:207], v[144:147], v[92:95]
    ds_read_b64_tr_b16 v[200:201], v16 offset:49152
    v_add_u32 v49, 233024, v56
    v_mad_u32_u16 v49, v49, v58, v2 op_sel:[1,0,0,0]
    v_mfma_f32_16x16x32_bf16 v[100:103], v[204:207], v[148:151], v[100:103]
    ds_read_b64_tr_b16 v[202:203], v16 offset:53248
    v_add_u32 v50, 466048, v56
    s_waitcnt lgkmcnt(10)
    v_mfma_f32_16x16x32_bf16 v[108:111], v[208:211], v[144:147], v[108:111]
    ds_read_b64_tr_b16 v[204:205], v17 offset:49152
    v_mad_u32_u16 v50, v50, v58, v2 op_sel:[1,0,0,0]
    v_add_u32 v51, 699072, v56
    v_mfma_f32_16x16x32_bf16 v[116:119], v[208:211], v[148:151], v[116:119]
    ds_read_b64_tr_b16 v[206:207], v17 offset:53248
    v_mad_u32_u16 v51, v51, v58, v2 op_sel:[1,0,0,0]
    v_add_u32 v52, 932096, v56
    v_mfma_f32_16x16x32_bf16 v[124:127], v[212:215], v[144:147], v[124:127]
    ds_read_b64_tr_b16 v[208:209], v18 offset:49152
    v_mad_u32_u16 v52, v52, v58, v2 op_sel:[1,0,0,0]
    v_add_u32 v53, 1165120, v56
    v_mfma_f32_16x16x32_bf16 v[132:135], v[212:215], v[148:151], v[132:135]
    ds_read_b64_tr_b16 v[210:211], v18 offset:53248
    v_mad_u32_u16 v53, v53, v58, v2 op_sel:[1,0,0,0]
    s_waitcnt lgkmcnt(10)
    v_mfma_f32_16x16x32_bf16 v[76:79], v[216:219], v[176:179], v[76:79]
    ds_read_b64_tr_b16 v[212:213], v19 offset:49152
    v_add_u32 v54, 1398144, v56
    v_mad_u32_u16 v54, v54, v58, v2 op_sel:[1,0,0,0]
    v_mfma_f32_16x16x32_bf16 v[84:87], v[216:219], v[180:183], v[84:87]
    ds_read_b64_tr_b16 v[214:215], v19 offset:53248
    v_add_u32 v55, 1631168, v56
    v_mad_u32_u16 v55, v55, v58, v2 op_sel:[1,0,0,0]
    v_mfma_f32_16x16x32_bf16 v[92:95], v[220:223], v[176:179], v[92:95]
    ds_read_b64_tr_b16 v[216:217], v20 offset:49152
    v_add_u32 v56, 1864192, v56
    v_mad_u32_u16 v56, v56, v58, v2 op_sel:[1,0,0,0]
    v_mfma_f32_16x16x32_bf16 v[100:103], v[220:223], v[180:183], v[100:103]
    ds_read_b64_tr_b16 v[218:219], v20 offset:53248
    s_waitcnt lgkmcnt(10)
    v_mfma_f32_16x16x32_bf16 v[108:111], v[224:227], v[176:179], v[108:111]
    ds_read_b64_tr_b16 v[220:221], v21 offset:49152
    v_mfma_f32_16x16x32_bf16 v[116:119], v[224:227], v[180:183], v[116:119]
    ds_read_b64_tr_b16 v[222:223], v21 offset:53248
    v_mfma_f32_16x16x32_bf16 v[124:127], v[228:231], v[176:179], v[124:127]
    ds_read_b64_tr_b16 v[224:225], v22 offset:49152
    v_mfma_f32_16x16x32_bf16 v[132:135], v[228:231], v[180:183], v[132:135]
    ds_read_b64_tr_b16 v[226:227], v22 offset:53248
    s_waitcnt lgkmcnt(10)
    v_mfma_f32_16x16x32_bf16 v[76:79], v[200:203], v[152:155], v[76:79]
    ds_read_b64_tr_b16 v[228:229], v23 offset:49152
    v_mfma_f32_16x16x32_bf16 v[84:87], v[200:203], v[156:159], v[84:87]
    ds_read_b64_tr_b16 v[230:231], v23 offset:53248
    v_mfma_f32_16x16x32_bf16 v[92:95], v[204:207], v[152:155], v[92:95]
    ds_read_b64_tr_b16 v[200:201], v16 offset:57344
    v_mfma_f32_16x16x32_bf16 v[100:103], v[204:207], v[156:159], v[100:103]
    ds_read_b64_tr_b16 v[202:203], v16 offset:61440
    s_waitcnt lgkmcnt(10)
    v_mfma_f32_16x16x32_bf16 v[108:111], v[208:211], v[152:155], v[108:111]
    ds_read_b64_tr_b16 v[204:205], v17 offset:57344
    v_add_u32 v16, 65536, v16
    v_mfma_f32_16x16x32_bf16 v[116:119], v[208:211], v[156:159], v[116:119]
    ds_read_b64_tr_b16 v[206:207], v17 offset:61440
    v_mfma_f32_16x16x32_bf16 v[124:127], v[212:215], v[152:155], v[124:127]
    ds_read_b64_tr_b16 v[208:209], v18 offset:57344
    v_add_u32 v17, 65536, v17
    v_mfma_f32_16x16x32_bf16 v[132:135], v[212:215], v[156:159], v[132:135]
    ds_read_b64_tr_b16 v[210:211], v18 offset:61440
    s_waitcnt lgkmcnt(10)
    v_mfma_f32_16x16x32_bf16 v[76:79], v[216:219], v[184:187], v[76:79]
    ds_read_b64_tr_b16 v[212:213], v19 offset:57344
    v_add_u32 v18, 65536, v18
    v_mfma_f32_16x16x32_bf16 v[84:87], v[216:219], v[188:191], v[84:87]
    ds_read_b64_tr_b16 v[214:215], v19 offset:61440
    v_mfma_f32_16x16x32_bf16 v[92:95], v[220:223], v[184:187], v[92:95]
    ds_read_b64_tr_b16 v[216:217], v20 offset:57344
    v_add_u32 v19, 65536, v19
    v_mfma_f32_16x16x32_bf16 v[100:103], v[220:223], v[188:191], v[100:103]
    ds_read_b64_tr_b16 v[218:219], v20 offset:61440
    s_waitcnt lgkmcnt(10)
    v_mfma_f32_16x16x32_bf16 v[108:111], v[224:227], v[184:187], v[108:111]
    ds_read_b64_tr_b16 v[220:221], v21 offset:57344
    v_add_u32 v20, 65536, v20
    v_mfma_f32_16x16x32_bf16 v[116:119], v[224:227], v[188:191], v[116:119]
    ds_read_b64_tr_b16 v[222:223], v21 offset:61440
    v_mfma_f32_16x16x32_bf16 v[124:127], v[228:231], v[184:187], v[124:127]
    ds_read_b64_tr_b16 v[224:225], v22 offset:57344
    v_add_u32 v21, 65536, v21
    v_mfma_f32_16x16x32_bf16 v[132:135], v[228:231], v[188:191], v[132:135]
    ds_read_b64_tr_b16 v[226:227], v22 offset:61440
    s_waitcnt lgkmcnt(10)
    v_mfma_f32_16x16x32_bf16 v[76:79], v[200:203], v[160:163], v[76:79]
    ds_read_b64_tr_b16 v[228:229], v23 offset:57344
    v_add_u32 v22, 65536, v22
    v_mfma_f32_16x16x32_bf16 v[84:87], v[200:203], v[164:167], v[84:87]
    ds_read_b64_tr_b16 v[230:231], v23 offset:61440
    v_mfma_f32_16x16x32_bf16 v[92:95], v[204:207], v[160:163], v[92:95]
    v_add_u32 v23, 65536, v23
    v_mfma_f32_16x16x32_bf16 v[100:103], v[204:207], v[164:167], v[100:103]
    s_waitcnt lgkmcnt(8)
    v_mfma_f32_16x16x32_bf16 v[108:111], v[208:211], v[160:163], v[108:111]
    v_mfma_f32_16x16x32_bf16 v[116:119], v[208:211], v[164:167], v[116:119]
    v_mfma_f32_16x16x32_bf16 v[124:127], v[212:215], v[160:163], v[124:127]
    v_mfma_f32_16x16x32_bf16 v[132:135], v[212:215], v[164:167], v[132:135]
    s_waitcnt lgkmcnt(0)
    s_barrier
    ds_read_b64_tr_b16 v[200:201], v16 offset:0
    ds_read_b64_tr_b16 v[202:203], v16 offset:4096
    ds_read_b64_tr_b16 v[204:205], v17 offset:0
    ds_read_b64_tr_b16 v[206:207], v17 offset:4096
    ds_read_b64_tr_b16 v[208:209], v18 offset:0
    ds_read_b64_tr_b16 v[210:211], v18 offset:4096
    v_mfma_f32_16x16x32_bf16 v[76:79], v[216:219], v[192:195], v[76:79]
    ds_read_b64_tr_b16 v[212:213], v19 offset:0
    v_mfma_f32_16x16x32_bf16 v[84:87], v[216:219], v[196:199], v[84:87]
    ds_read_b64_tr_b16 v[214:215], v19 offset:4096
    v_mfma_f32_16x16x32_bf16 v[92:95], v[220:223], v[192:195], v[92:95]
    ds_read_b64_tr_b16 v[216:217], v20 offset:0
    v_mfma_f32_16x16x32_bf16 v[100:103], v[220:223], v[196:199], v[100:103]
    ds_read_b64_tr_b16 v[218:219], v20 offset:4096
    v_mfma_f32_16x16x32_bf16 v[108:111], v[224:227], v[192:195], v[108:111]
    ds_read_b64_tr_b16 v[220:221], v21 offset:0
    v_mfma_f32_16x16x32_bf16 v[116:119], v[224:227], v[196:199], v[116:119]
    ds_read_b64_tr_b16 v[222:223], v21 offset:4096
    v_mfma_f32_16x16x32_bf16 v[124:127], v[228:231], v[192:195], v[124:127]
    ds_read_b64_tr_b16 v[224:225], v22 offset:0
    v_mfma_f32_16x16x32_bf16 v[132:135], v[228:231], v[196:199], v[132:135]
    ds_read_b64_tr_b16 v[226:227], v22 offset:4096
    s_waitcnt lgkmcnt(10)
    v_mfma_f32_16x16x32_bf16 v[76:79], v[200:203], v[232:235], v[76:79]
    ds_read_b64_tr_b16 v[228:229], v23 offset:0
    v_mfma_f32_16x16x32_bf16 v[84:87], v[200:203], v[236:239], v[84:87]
    ds_read_b64_tr_b16 v[230:231], v23 offset:4096
    v_mfma_f32_16x16x32_bf16 v[92:95], v[204:207], v[232:235], v[92:95]
    ds_read_b64_tr_b16 v[200:201], v16 offset:8192
    v_mfma_f32_16x16x32_bf16 v[100:103], v[204:207], v[236:239], v[100:103]
    ds_read_b64_tr_b16 v[202:203], v16 offset:12288
    s_waitcnt lgkmcnt(10)
    v_mfma_f32_16x16x32_bf16 v[108:111], v[208:211], v[232:235], v[108:111]
    ds_read_b64_tr_b16 v[204:205], v17 offset:8192
    v_mfma_f32_16x16x32_bf16 v[116:119], v[208:211], v[236:239], v[116:119]
    ds_read_b64_tr_b16 v[206:207], v17 offset:12288
    v_mfma_f32_16x16x32_bf16 v[124:127], v[212:215], v[232:235], v[124:127]
    ds_read_b64_tr_b16 v[208:209], v18 offset:8192
    v_mfma_f32_16x16x32_bf16 v[132:135], v[212:215], v[236:239], v[132:135]
    ds_read_b64_tr_b16 v[210:211], v18 offset:12288
    s_waitcnt lgkmcnt(10)
    v_mfma_f32_16x16x32_bf16 v[76:79], v[216:219], v[72:75], v[76:79]
    ds_read_b64_tr_b16 v[212:213], v19 offset:8192
    v_mfma_f32_16x16x32_bf16 v[84:87], v[216:219], v[80:83], v[84:87]
    ds_read_b64_tr_b16 v[214:215], v19 offset:12288
    v_mfma_f32_16x16x32_bf16 v[92:95], v[220:223], v[72:75], v[92:95]
    ds_read_b64_tr_b16 v[216:217], v20 offset:8192
    v_mfma_f32_16x16x32_bf16 v[100:103], v[220:223], v[80:83], v[100:103]
    ds_read_b64_tr_b16 v[218:219], v20 offset:12288
    s_waitcnt lgkmcnt(10)
    v_mfma_f32_16x16x32_bf16 v[108:111], v[224:227], v[72:75], v[108:111]
    ds_read_b64_tr_b16 v[220:221], v21 offset:8192
    v_mfma_f32_16x16x32_bf16 v[116:119], v[224:227], v[80:83], v[116:119]
    ds_read_b64_tr_b16 v[222:223], v21 offset:12288
    v_mfma_f32_16x16x32_bf16 v[124:127], v[228:231], v[72:75], v[124:127]
    ds_read_b64_tr_b16 v[224:225], v22 offset:8192
    v_mfma_f32_16x16x32_bf16 v[132:135], v[228:231], v[80:83], v[132:135]
    ds_read_b64_tr_b16 v[226:227], v22 offset:12288
    s_waitcnt lgkmcnt(10)
    v_mfma_f32_16x16x32_bf16 v[76:79], v[200:203], v[240:243], v[76:79]
    ds_read_b64_tr_b16 v[228:229], v23 offset:8192
    v_mfma_f32_16x16x32_bf16 v[84:87], v[200:203], v[244:247], v[84:87]
    ds_read_b64_tr_b16 v[230:231], v23 offset:12288
    v_mfma_f32_16x16x32_bf16 v[92:95], v[204:207], v[240:243], v[92:95]
    ds_read_b64_tr_b16 v[200:201], v16 offset:16384
    v_mfma_f32_16x16x32_bf16 v[100:103], v[204:207], v[244:247], v[100:103]
    ds_read_b64_tr_b16 v[202:203], v16 offset:20480
    s_waitcnt lgkmcnt(10)
    v_mfma_f32_16x16x32_bf16 v[108:111], v[208:211], v[240:243], v[108:111]
    ds_read_b64_tr_b16 v[204:205], v20 offset:16384
    v_mfma_f32_16x16x32_bf16 v[116:119], v[208:211], v[244:247], v[116:119]
    ds_read_b64_tr_b16 v[206:207], v20 offset:20480
    v_mfma_f32_16x16x32_bf16 v[124:127], v[212:215], v[240:243], v[124:127]
    ds_read_b64_tr_b16 v[208:209], v16 offset:24576
    v_mfma_f32_16x16x32_bf16 v[132:135], v[212:215], v[244:247], v[132:135]
    ds_read_b64_tr_b16 v[210:211], v16 offset:28672
    s_waitcnt lgkmcnt(10)
    v_mfma_f32_16x16x32_bf16 v[76:79], v[216:219], v[88:91], v[76:79]
    ds_read_b64_tr_b16 v[212:213], v20 offset:24576
    v_mfma_f32_16x16x32_bf16 v[84:87], v[216:219], v[96:99], v[84:87]
    ds_read_b64_tr_b16 v[214:215], v20 offset:28672
    v_mfma_f32_16x16x32_bf16 v[92:95], v[220:223], v[88:91], v[92:95]
    ds_read_b64_tr_b16 v[216:217], v17 offset:16384
    v_mfma_f32_16x16x32_bf16 v[100:103], v[220:223], v[96:99], v[100:103]
    ds_read_b64_tr_b16 v[218:219], v17 offset:20480
    s_waitcnt lgkmcnt(10)
    v_mfma_f32_16x16x32_bf16 v[108:111], v[224:227], v[88:91], v[108:111]
    ds_read_b64_tr_b16 v[220:221], v21 offset:16384
    v_mfma_f32_16x16x32_bf16 v[116:119], v[224:227], v[96:99], v[116:119]
    ds_read_b64_tr_b16 v[222:223], v21 offset:20480
    v_mfma_f32_16x16x32_bf16 v[124:127], v[228:231], v[88:91], v[124:127]
    ds_read_b64_tr_b16 v[224:225], v17 offset:24576
    v_mfma_f32_16x16x32_bf16 v[132:135], v[228:231], v[96:99], v[132:135]
    ds_read_b64_tr_b16 v[226:227], v17 offset:28672
    s_waitcnt lgkmcnt(10)
    v_mfma_f32_16x16x32_bf16 v[76:79], v[200:203], v[248:251], v[76:79]
    ds_read_b64_tr_b16 v[228:229], v21 offset:24576
    v_mfma_f32_16x16x32_bf16 v[84:87], v[200:203], v[252:255], v[84:87]
    ds_read_b64_tr_b16 v[230:231], v21 offset:28672
    v_mfma_f32_16x16x32_bf16 v[76:79], v[204:207], v[104:107], v[76:79]
    ds_read_b64_tr_b16 v[200:201], v18 offset:16384
    v_mfma_f32_16x16x32_bf16 v[84:87], v[204:207], v[112:115], v[84:87]
    ds_read_b64_tr_b16 v[202:203], v18 offset:20480
    s_waitcnt lgkmcnt(10)
    v_mfma_f32_16x16x32_bf16 v[76:79], v[208:211], v[8:11], v[76:79]
    ds_read_b64_tr_b16 v[204:205], v22 offset:16384
    v_mfma_f32_16x16x32_bf16 v[84:87], v[208:211], v[12:15], v[84:87]
    ds_read_b64_tr_b16 v[206:207], v22 offset:20480
    v_mfma_f32_16x16x32_bf16 v[76:79], v[212:215], v[120:123], v[76:79]
    ds_read_b64_tr_b16 v[208:209], v18 offset:24576
    v_mfma_f32_16x16x32_bf16 v[84:87], v[212:215], v[128:131], v[84:87]
    ds_read_b64_tr_b16 v[210:211], v18 offset:28672
    s_waitcnt lgkmcnt(10)
    v_mfma_f32_16x16x32_bf16 v[92:95], v[216:219], v[248:251], v[92:95]
    ds_read_b64_tr_b16 v[212:213], v22 offset:24576
    v_mfma_f32_16x16x32_bf16 v[100:103], v[216:219], v[252:255], v[100:103]
    ds_read_b64_tr_b16 v[214:215], v22 offset:28672
    v_mul_f32 v76, v76, v36
    v_mul_f32 v77, v77, v36
    v_mul_f32 v78, v78, v36
    v_mul_f32 v79, v79, v36
    v_mfma_f32_16x16x32_bf16 v[92:95], v[220:223], v[104:107], v[92:95]
    ds_read_b64_tr_b16 v[216:217], v19 offset:16384
    v_cvt_pk_bf16_f32 v76, v76, v77
    v_cvt_pk_bf16_f32 v77, v78, v79
    v_or_b32 v76, 1, v76
    v_mul_f32 v84, v84, v37
    v_mfma_f32_16x16x32_bf16 v[100:103], v[220:223], v[112:115], v[100:103]
    ds_read_b64_tr_b16 v[218:219], v19 offset:20480
    v_mul_f32 v85, v85, v37
    v_mul_f32 v86, v86, v37
    v_mul_f32 v87, v87, v37
    s_waitcnt lgkmcnt(10)
    v_mfma_f32_16x16x32_bf16 v[92:95], v[224:227], v[8:11], v[92:95]
    ds_read_b64_tr_b16 v[220:221], v23 offset:16384
    v_cvt_pk_bf16_f32 v84, v84, v85
    v_cvt_pk_bf16_f32 v85, v86, v87
    v_or_b32 v84, 1, v84
    v_mfma_f32_16x16x32_bf16 v[100:103], v[224:227], v[12:15], v[100:103]
    ds_read_b64_tr_b16 v[222:223], v23 offset:20480
    v_mfma_f32_16x16x32_bf16 v[92:95], v[228:231], v[120:123], v[92:95]
    ds_read_b64_tr_b16 v[224:225], v19 offset:24576
    v_mfma_f32_16x16x32_bf16 v[100:103], v[228:231], v[128:131], v[100:103]
    ds_read_b64_tr_b16 v[226:227], v19 offset:28672
    s_waitcnt lgkmcnt(10)
    v_mfma_f32_16x16x32_bf16 v[108:111], v[200:203], v[248:251], v[108:111]
    ds_read_b64_tr_b16 v[228:229], v23 offset:24576
    v_mfma_f32_16x16x32_bf16 v[116:119], v[200:203], v[252:255], v[116:119]
    ds_read_b64_tr_b16 v[230:231], v23 offset:28672
    v_mul_f32 v92, v92, v36
    v_mul_f32 v93, v93, v36
    v_mul_f32 v94, v94, v36
    v_mul_f32 v95, v95, v36
    v_mfma_f32_16x16x32_bf16 v[108:111], v[204:207], v[104:107], v[108:111]
    v_cvt_pk_bf16_f32 v78, v92, v93
    v_cvt_pk_bf16_f32 v79, v94, v95
    buffer_store_dwordx4 v[76:79], v2, s[68:71], s17 offen offset:0
    v_mul_f32 v100, v100, v37
    v_mfma_f32_16x16x32_bf16 v[116:119], v[204:207], v[112:115], v[116:119]
    v_mul_f32 v101, v101, v37
    v_mul_f32 v102, v102, v37
    v_mul_f32 v103, v103, v37
    v_cvt_pk_bf16_f32 v86, v100, v101
    s_waitcnt lgkmcnt(8)
    v_mfma_f32_16x16x32_bf16 v[108:111], v[208:211], v[8:11], v[108:111]
    v_cvt_pk_bf16_f32 v87, v102, v103
    buffer_store_dwordx4 v[84:87], v2, s[68:71], s17 offen offset:1024
    v_mfma_f32_16x16x32_bf16 v[116:119], v[208:211], v[12:15], v[116:119]
    v_mfma_f32_16x16x32_bf16 v[108:111], v[212:215], v[120:123], v[108:111]
    v_mfma_f32_16x16x32_bf16 v[116:119], v[212:215], v[128:131], v[116:119]
    s_waitcnt lgkmcnt(4)
    v_mfma_f32_16x16x32_bf16 v[124:127], v[216:219], v[248:251], v[124:127]
    v_mfma_f32_16x16x32_bf16 v[132:135], v[216:219], v[252:255], v[132:135]
    s_nop 3
    v_mul_f32 v108, v108, v36
    v_mul_f32 v109, v109, v36
    v_mul_f32 v110, v110, v36
    v_mul_f32 v111, v111, v36
    v_cvt_pk_bf16_f32 v108, v108, v109
    v_mfma_f32_16x16x32_bf16 v[124:127], v[220:223], v[104:107], v[124:127]
    v_cvt_pk_bf16_f32 v109, v110, v111
    v_or_b32 v108, 1, v108
    v_mul_f32 v116, v116, v37
    v_mul_f32 v117, v117, v37
    v_mul_f32 v118, v118, v37
    v_mfma_f32_16x16x32_bf16 v[132:135], v[220:223], v[112:115], v[132:135]
    v_mul_f32 v119, v119, v37
    v_cvt_pk_bf16_f32 v116, v116, v117
    v_cvt_pk_bf16_f32 v117, v118, v119
    v_or_b32 v116, 1, v116
    s_waitcnt lgkmcnt(0)
    v_mfma_f32_16x16x32_bf16 v[124:127], v[224:227], v[8:11], v[124:127]
    v_mfma_f32_16x16x32_bf16 v[132:135], v[224:227], v[12:15], v[132:135]
    v_mfma_f32_16x16x32_bf16 v[124:127], v[228:231], v[120:123], v[124:127]
    v_mfma_f32_16x16x32_bf16 v[132:135], v[228:231], v[128:131], v[132:135]
    s_nop 6
    v_mul_f32 v124, v124, v36
    v_mul_f32 v125, v125, v36
    v_mul_f32 v126, v126, v36
    v_mul_f32 v127, v127, v36
    v_cvt_pk_bf16_f32 v110, v124, v125
    v_cvt_pk_bf16_f32 v111, v126, v127
    buffer_store_dwordx4 v[108:111], v2, s[68:71], s17 offen offset:2048
    v_mul_f32 v132, v132, v37
    v_mul_f32 v133, v133, v37
    v_mul_f32 v134, v134, v37
    v_mul_f32 v135, v135, v37
    v_cvt_pk_bf16_f32 v118, v132, v133
    v_cvt_pk_bf16_f32 v119, v134, v135
    buffer_store_dwordx4 v[116:119], v2, s[68:71], s17 offen offset:3072
    s_cmp_lg_u32 s34, 0
    s_cbranch_scc1 L_x21
L_x2r1:
    s_lshl_b32 s11, s6, 1
    s_add_u32 s11, s11, s4
    s_add_u32 s11, s11, 2
    s_and_b32 s12, s11, 6
    s_lshl_b32 s12, s12, 1
    s_sub_u32 s12, s12, s40
    s_lshl_b32 s12, s12, 1
    s_and_b32 s11, s11, 1
    s_add_u32 s11, s11, 6
    s_add_u32 s11, s11, s12
    s_mul_i32 s11, s11, 36864
    s_add_u32 s11, s11, s100
    s_mov_b32 s12, 93184
    s_cmp_eq_u32 s4, 1
    s_cselect_b32 s12, 102400, s12
    s_cmp_eq_u32 s4, 2
    s_cselect_b32 s12, 111616, s12
    s_cmp_eq_u32 s4, 3
    s_cselect_b32 s12, 120832, s12
    s_add_u32 m0, s12, 0
    s_nop 0
    buffer_load_dwordx4 v48, s[60:63], s11 offen offset:0 nt lds
    buffer_load_dwordx4 v49, s[60:63], s11 offen offset:1024 nt lds
    buffer_load_dwordx4 v50, s[60:63], s11 offen offset:2048 nt lds
    buffer_load_dwordx4 v51, s[60:63], s11 offen offset:3072 nt lds
    s_add_u32 s11, s11, 4096
    s_add_u32 m0, s12, 4096
    s_nop 0
    buffer_load_dwordx4 v52, s[60:63], s11 offen offset:0 nt lds
    buffer_load_dwordx4 v53, s[60:63], s11 offen offset:1024 nt lds
    buffer_load_dwordx4 v54, s[60:63], s11 offen offset:2048 nt lds
    buffer_load_dwordx4 v55, s[60:63], s11 offen offset:3072 nt lds
    s_add_u32 s11, s11, 4096
    s_add_u32 m0, s12, 8192
    s_nop 0
    buffer_load_dwordx4 v56, s[60:63], s11 offen offset:0 nt lds
L_wo_26:
    s_cmp_ge_u32 s4, 2
    s_cbranch_scc1 L_wo_27
    s_lshl_b32 s11, s6, 1
    s_add_u32 s11, s11, s4
    s_add_u32 s11, s11, 6
    s_and_b32 s12, s11, 6
    s_lshl_b32 s12, s12, 1
    s_sub_u32 s12, s12, s40
    s_lshl_b32 s12, s12, 1
    s_and_b32 s11, s11, 1
    s_add_u32 s11, s11, 6
    s_add_u32 s11, s11, s12
    s_mul_i32 s11, s11, 36864
    s_add_u32 s11, s11, s100
    s_mov_b32 s12, 37888
    s_cmp_eq_u32 s4, 1
    s_cselect_b32 s12, 47104, s12
    s_add_u32 m0, s12, 0
    s_nop 0
    buffer_load_dwordx4 v48, s[60:63], s11 offen offset:0 nt lds
    buffer_load_dwordx4 v49, s[60:63], s11 offen offset:1024 nt lds
    buffer_load_dwordx4 v50, s[60:63], s11 offen offset:2048 nt lds
    buffer_load_dwordx4 v51, s[60:63], s11 offen offset:3072 nt lds
    s_add_u32 s11, s11, 4096
    s_add_u32 m0, s12, 4096
    s_nop 0
    buffer_load_dwordx4 v52, s[60:63], s11 offen offset:0 nt lds
    buffer_load_dwordx4 v53, s[60:63], s11 offen offset:1024 nt lds
    buffer_load_dwordx4 v54, s[60:63], s11 offen offset:2048 nt lds
    buffer_load_dwordx4 v55, s[60:63], s11 offen offset:3072 nt lds
    s_add_u32 s11, s11, 4096
    s_add_u32 m0, s12, 8192
    s_nop 0
    buffer_load_dwordx4 v56, s[60:63], s11 offen offset:0 nt lds
L_wo_27:
    s_barrier
    s_cmp_lt_u32 s4, 2
    s_cbranch_scc1 L_wo_28
    s_lshl_b32 s11, s6, 1
    s_add_u32 s11, s11, s4
    s_add_u32 s11, s11, 14
    s_and_b32 s12, s11, 6
    s_lshl_b32 s12, s12, 1
    s_sub_u32 s12, s12, s40
    s_lshl_b32 s12, s12, 1
    s_and_b32 s11, s11, 1
    s_add_u32 s11, s11, 6
    s_add_u32 s11, s11, s12
    s_mul_i32 s11, s11, 36864
    s_add_u32 s11, s11, s100
    s_mov_b32 s12, 130048
    s_cmp_eq_u32 s4, 3
    s_cselect_b32 s12, 139264, s12
    s_add_u32 m0, s12, 0
    s_nop 0
    buffer_load_dwordx4 v48, s[60:63], s11 offen offset:0 nt lds
    buffer_load_dwordx4 v49, s[60:63], s11 offen offset:1024 nt lds
    buffer_load_dwordx4 v50, s[60:63], s11 offen offset:2048 nt lds
    buffer_load_dwordx4 v51, s[60:63], s11 offen offset:3072 nt lds
    s_add_u32 s11, s11, 4096
    s_add_u32 m0, s12, 4096
    s_nop 0
    buffer_load_dwordx4 v52, s[60:63], s11 offen offset:0 nt lds
    buffer_load_dwordx4 v53, s[60:63], s11 offen offset:1024 nt lds
    buffer_load_dwordx4 v54, s[60:63], s11 offen offset:2048 nt lds
    buffer_load_dwordx4 v55, s[60:63], s11 offen offset:3072 nt lds
    s_add_u32 s11, s11, 4096
    s_add_u32 m0, s12, 8192
    s_nop 0
    buffer_load_dwordx4 v56, s[60:63], s11 offen offset:0 nt lds
L_wo_28:
    s_lshl_b32 s11, s94, 2
    s_add_u32 s11, s11, s6
    s_lshl_b32 s11, s11, 2
    s_add_u32 s11, s11, s8
    s_mul_i32 s98, s11, 49152
    s_lshl_b32 s25, s11, 8
    s_add_u32 s25, s25, 68157440
    s_mul_i32 s12, s4, 3072
    s_add_u32 s98, s98, s12
    s_add_u32 s98, s98, 33554432
    s_add_u32 s12, s12, 148480
    v_add_u32 v4, s12, v2
    v_mov_b32 v11, s12
    s_add_u32 s11, s8, 1
    s_and_b32 s11, s11, 3
    s_mul_i32 s11, s11, 12288
    s_add_u32 s20, s98, s11
    s_add_u32 s11, s8, 2
    s_and_b32 s11, s11, 3
    s_mul_i32 s11, s11, 12288
    s_add_u32 s21, s98, s11
    s_add_u32 s11, s8, 3
    s_and_b32 s11, s11, 3
    s_mul_i32 s11, s11, 12288
    s_add_u32 s22, s98, s11
    s_lshl_b32 s11, s4, 2
    s_add_u32 s25, s25, s11
    v_lshrrev_b32 v6, 4, v2
    v_add_u32 v6, s8, v6
    v_add_u32 v6, 1, v6
    v_and_b32 v6, 3, v6
    v_lshlrev_b32 v6, 4, v6
    s_lshl_b32 s11, s7, 2
    s_add_u32 s11, s11, s8
    s_mul_i32 s100, s11, 73728
    s_mul_i32 s11, s9, 1152
    s_add_u32 s100, s100, s11
    s_mul_i32 s11, s6, 288
    s_add_u32 s100, s100, s11
    v_bfe_u32 v8, v2, 4, 4
    v_mul_u32_u24 v8, 2304, v8
    v_lshrrev_b32 v10, 8, v2
    v_lshl_add_u32 v8, v10, 3, v8
    s_lshr_b32 s11, s4, 1
    s_mul_i32 s11, s11, 36864
    s_and_b32 s12, s4, 1
    s_lshl_b32 s12, s12, 2
    s_add_u32 s11, s11, s12
    s_add_u32 s11, s11, 256
    v_add_u32 v9, s11, v8
    s_lshl_b32 s11, s4, 6
    v_add_u32 v8, s11, v8
    s_mov_b32 s24, 7
    s_mov_b32 s23, 0
    s_mov_b32 s26, 15
    s_mov_b32 s96, 200000
    v_mov_b32 v136, 0
    v_mov_b32 v137, 0
    v_mov_b32 v138, 0
    v_mov_b32 v139, 0
    v_mov_b32 v140, 0
    v_mov_b32 v141, 0
    v_mov_b32 v142, 0
    v_mov_b32 v143, 0
    v_mov_b32 v144, 0
    v_mov_b32 v145, 0
    v_mov_b32 v146, 0
    v_mov_b32 v147, 0
    v_mov_b32 v148, 0
    v_mov_b32 v149, 0
    v_mov_b32 v150, 0
    v_mov_b32 v151, 0
    v_mov_b32 v152, 0
    v_mov_b32 v153, 0
    s_waitcnt vmcnt(0) lgkmcnt(0)
    s_barrier
    s_setprio 0
L_fp:
    s_cmp_eq_u32 s24, 0
    s_cbranch_scc1 L_fq
    s_mov_b64 exec, 7
    buffer_load_dword v5, v6, s[68:71], s25 offen sc1
    s_mov_b64 exec, -1
L_fq:
    s_bitcmp1_b32 s26, 3
    s_cbranch_scc0 L_fn3
    ds_read_b32 v12, v11 offset:3068
    s_waitcnt lgkmcnt(0)
    v_cmp_ne_u32 vcc, s92, v12
    s_cbranch_vccnz L_fn3
    ds_read_b128 v[108:111], v4 offset:0
    ds_read_b128 v[112:115], v4 offset:1024
    ds_read_b128 v[116:119], v4 offset:2048
    s_waitcnt lgkmcnt(2)
    v_xor_b32 v12, s92, v111
    s_waitcnt lgkmcnt(1)
    v_xor_b32 v13, s92, v115
    s_waitcnt lgkmcnt(0)
    v_xor_b32 v14, s92, v119
    v_or3_b32 v12, v12, v13, v14
    v_cmp_ne_u32 vcc, 0, v12
    s_cbranch_vccnz L_fn3
    v_lshlrev_b32 v12, 16, v108
    v_and_b32 v13, 0xffff0000, v108
    v_add_f32 v136, v136, v12
    v_add_f32 v137, v137, v13
    v_lshlrev_b32 v14, 16, v109
    v_and_b32 v15, 0xffff0000, v109
    v_add_f32 v138, v138, v14
    v_add_f32 v139, v139, v15
    v_lshlrev_b32 v12, 16, v110
    v_and_b32 v13, 0xffff0000, v110
    v_add_f32 v140, v140, v12
    v_add_f32 v141, v141, v13
    v_lshlrev_b32 v14, 16, v112
    v_and_b32 v15, 0xffff0000, v112
    v_add_f32 v142, v142, v14
    v_add_f32 v143, v143, v15
    v_lshlrev_b32 v12, 16, v113
    v_and_b32 v13, 0xffff0000, v113
    v_add_f32 v144, v144, v12
    v_add_f32 v145, v145, v13
    v_lshlrev_b32 v14, 16, v114
    v_and_b32 v15, 0xffff0000, v114
    v_add_f32 v146, v146, v14
    v_add_f32 v147, v147, v15
    v_lshlrev_b32 v12, 16, v116
    v_and_b32 v13, 0xffff0000, v116
    v_add_f32 v148, v148, v12
    v_add_f32 v149, v149, v13
    v_lshlrev_b32 v14, 16, v117
    v_and_b32 v15, 0xffff0000, v117
    v_add_f32 v150, v150, v14
    v_add_f32 v151, v151, v15
    v_lshlrev_b32 v12, 16, v118
    v_and_b32 v13, 0xffff0000, v118
    v_add_f32 v152, v152, v12
    v_add_f32 v153, v153, v13
    s_bitset0_b32 s26, 3
L_fn3:
    s_waitcnt vmcnt(0)
    v_cmp_eq_u32 vcc, s92, v5
    s_mov_b32 s27, s23
    s_cmp_lt_u32 s96, 100000
    s_cselect_b32 s23, -1, vcc_lo
    s_and_b32 s23, s23, s24
    s_cbranch_scc0 L_fr
    s_andn2_b32 s24, s24, s23
    s_bitcmp1_b32 s23, 0
    s_cbranch_scc0 L_fs0
    buffer_load_dwordx4 v[72:75], v2, s[68:71], s20 offen offset:0 sc1
    buffer_load_dwordx4 v[76:79], v2, s[68:71], s20 offen offset:1024 sc1
    buffer_load_dwordx4 v[80:83], v2, s[68:71], s20 offen offset:2048 sc1
L_fs0:
    s_bitcmp1_b32 s23, 1
    s_cbranch_scc0 L_fs1
    buffer_load_dwordx4 v[84:87], v2, s[68:71], s21 offen offset:0 sc1
    buffer_load_dwordx4 v[88:91], v2, s[68:71], s21 offen offset:1024 sc1
    buffer_load_dwordx4 v[92:95], v2, s[68:71], s21 offen offset:2048 sc1
L_fs1:
    s_bitcmp1_b32 s23, 2
    s_cbranch_scc0 L_fs2
    buffer_load_dwordx4 v[96:99], v2, s[68:71], s22 offen offset:0 sc1
    buffer_load_dwordx4 v[100:103], v2, s[68:71], s22 offen offset:1024 sc1
    buffer_load_dwordx4 v[104:107], v2, s[68:71], s22 offen offset:2048 sc1
L_fs2:
L_fr:
    s_bitcmp1_b32 s27, 0
    s_cbranch_scc0 L_fn0
    v_xor_b32 v12, s92, v75
    v_xor_b32 v13, s92, v79
    v_xor_b32 v14, s92, v83
    v_or3_b32 v12, v12, v13, v14
    v_cmp_ne_u32 vcc, 0, v12
    s_cbranch_vccnz L_fb0
    v_lshlrev_b32 v12, 16, v72
    v_and_b32 v13, 0xffff0000, v72
    v_add_f32 v136, v136, v12
    v_add_f32 v137, v137, v13
    v_lshlrev_b32 v14, 16, v73
    v_and_b32 v15, 0xffff0000, v73
    v_add_f32 v138, v138, v14
    v_add_f32 v139, v139, v15
    v_lshlrev_b32 v12, 16, v74
    v_and_b32 v13, 0xffff0000, v74
    v_add_f32 v140, v140, v12
    v_add_f32 v141, v141, v13
    v_lshlrev_b32 v14, 16, v76
    v_and_b32 v15, 0xffff0000, v76
    v_add_f32 v142, v142, v14
    v_add_f32 v143, v143, v15
    v_lshlrev_b32 v12, 16, v77
    v_and_b32 v13, 0xffff0000, v77
    v_add_f32 v144, v144, v12
    v_add_f32 v145, v145, v13
    v_lshlrev_b32 v14, 16, v78
    v_and_b32 v15, 0xffff0000, v78
    v_add_f32 v146, v146, v14
    v_add_f32 v147, v147, v15
    v_lshlrev_b32 v12, 16, v80
    v_and_b32 v13, 0xffff0000, v80
    v_add_f32 v148, v148, v12
    v_add_f32 v149, v149, v13
    v_lshlrev_b32 v14, 16, v81
    v_and_b32 v15, 0xffff0000, v81
    v_add_f32 v150, v150, v14
    v_add_f32 v151, v151, v15
    v_lshlrev_b32 v12, 16, v82
    v_and_b32 v13, 0xffff0000, v82
    v_add_f32 v152, v152, v12
    v_add_f32 v153, v153, v13
    s_bitset0_b32 s26, 0
    s_branch L_fn0
L_fb0:
    buffer_load_dwordx4 v[72:75], v2, s[68:71], s20 offen offset:0 sc1
    buffer_load_dwordx4 v[76:79], v2, s[68:71], s20 offen offset:1024 sc1
    buffer_load_dwordx4 v[80:83], v2, s[68:71], s20 offen offset:2048 sc1
    s_bitset1_b32 s23, 0
L_fn0:
    s_bitcmp1_b32 s27, 1
    s_cbranch_scc0 L_fn1
    v_xor_b32 v12, s92, v87
    v_xor_b32 v13, s92, v91
    v_xor_b32 v14, s92, v95
    v_or3_b32 v12, v12, v13, v14
    v_cmp_ne_u32 vcc, 0, v12
    s_cbranch_vccnz L_fb1
    v_lshlrev_b32 v12, 16, v84
    v_and_b32 v13, 0xffff0000, v84
    v_add_f32 v136, v136, v12
    v_add_f32 v137, v137, v13
    v_lshlrev_b32 v14, 16, v85
    v_and_b32 v15, 0xffff0000, v85
    v_add_f32 v138, v138, v14
    v_add_f32 v139, v139, v15
    v_lshlrev_b32 v12, 16, v86
    v_and_b32 v13, 0xffff0000, v86
    v_add_f32 v140, v140, v12
    v_add_f32 v141, v141, v13
    v_lshlrev_b32 v14, 16, v88
    v_and_b32 v15, 0xffff0000, v88
    v_add_f32 v142, v142, v14
    v_add_f32 v143, v143, v15
    v_lshlrev_b32 v12, 16, v89
    v_and_b32 v13, 0xffff0000, v89
    v_add_f32 v144, v144, v12
    v_add_f32 v145, v145, v13
    v_lshlrev_b32 v14, 16, v90
    v_and_b32 v15, 0xffff0000, v90
    v_add_f32 v146, v146, v14
    v_add_f32 v147, v147, v15
    v_lshlrev_b32 v12, 16, v92
    v_and_b32 v13, 0xffff0000, v92
    v_add_f32 v148, v148, v12
    v_add_f32 v149, v149, v13
    v_lshlrev_b32 v14, 16, v93
    v_and_b32 v15, 0xffff0000, v93
    v_add_f32 v150, v150, v14
    v_add_f32 v151, v151, v15
    v_lshlrev_b32 v12, 16, v94
    v_and_b32 v13, 0xffff0000, v94
    v_add_f32 v152, v152, v12
    v_add_f32 v153, v153, v13
    s_bitset0_b32 s26, 1
    s_branch L_fn1
L_fb1:
    buffer_load_dwordx4 v[84:87], v2, s[68:71], s21 offen offset:0 sc1
    buffer_load_dwordx4 v[88:91], v2, s[68:71], s21 offen offset:1024 sc1
    buffer_load_dwordx4 v[92:95], v2, s[68:71], s21 offen offset:2048 sc1
    s_bitset1_b32 s23, 1
L_fn1:
    s_bitcmp1_b32 s27, 2
    s_cbranch_scc0 L_fn2
    v_xor_b32 v12, s92, v99
    v_xor_b32 v13, s92, v103
    v_xor_b32 v14, s92, v107
    v_or3_b32 v12, v12, v13, v14
    v_cmp_ne_u32 vcc, 0, v12
    s_cbranch_vccnz L_fb2
    v_lshlrev_b32 v12, 16, v96
    v_and_b32 v13, 0xffff0000, v96
    v_add_f32 v136, v136, v12
    v_add_f32 v137, v137, v13
    v_lshlrev_b32 v14, 16, v97
    v_and_b32 v15, 0xffff0000, v97
    v_add_f32 v138, v138, v14
    v_add_f32 v139, v139, v15
    v_lshlrev_b32 v12, 16, v98
    v_and_b32 v13, 0xffff0000, v98
    v_add_f32 v140, v140, v12
    v_add_f32 v141, v141, v13
    v_lshlrev_b32 v14, 16, v100
    v_and_b32 v15, 0xffff0000, v100
    v_add_f32 v142, v142, v14
    v_add_f32 v143, v143, v15
    v_lshlrev_b32 v12, 16, v101
    v_and_b32 v13, 0xffff0000, v101
    v_add_f32 v144, v144, v12
    v_add_f32 v145, v145, v13
    v_lshlrev_b32 v14, 16, v102
    v_and_b32 v15, 0xffff0000, v102
    v_add_f32 v146, v146, v14
    v_add_f32 v147, v147, v15
    v_lshlrev_b32 v12, 16, v104
    v_and_b32 v13, 0xffff0000, v104
    v_add_f32 v148, v148, v12
    v_add_f32 v149, v149, v13
    v_lshlrev_b32 v14, 16, v105
    v_and_b32 v15, 0xffff0000, v105
    v_add_f32 v150, v150, v14
    v_add_f32 v151, v151, v15
    v_lshlrev_b32 v12, 16, v106
    v_and_b32 v13, 0xffff0000, v106
    v_add_f32 v152, v152, v12
    v_add_f32 v153, v153, v13
    s_bitset0_b32 s26, 2
    s_branch L_fn2
L_fb2:
    buffer_load_dwordx4 v[96:99], v2, s[68:71], s22 offen offset:0 sc1
    buffer_load_dwordx4 v[100:103], v2, s[68:71], s22 offen offset:1024 sc1
    buffer_load_dwordx4 v[104:107], v2, s[68:71], s22 offen offset:2048 sc1
    s_bitset1_b32 s23, 2
L_fn2:
    s_cmp_eq_u32 s26, 0
    s_cbranch_scc1 L_fd
    s_sub_u32 s96, s96, 1
    s_cbranch_scc0 L_fp
L_fd:
    v_cvt_pk_bf16_f32 v73, v136, v137
    v_cvt_pk_bf16_f32 v74, v138, v139
    v_cvt_pk_bf16_f32 v75, v140, v141
    v_cvt_pk_bf16_f32 v76, v142, v143
    v_cvt_pk_bf16_f32 v77, v144, v145
    v_cvt_pk_bf16_f32 v78, v146, v147
    v_cvt_pk_bf16_f32 v79, v148, v149
    v_cvt_pk_bf16_f32 v80, v150, v151
    v_cvt_pk_bf16_f32 v81, v152, v153
    s_add_u32 s11, s100, 36864
    buffer_store_dwordx2 v[74:75], v8, s[64:67], s100 offen offset:0
    buffer_store_dwordx2 v[76:77], v8, s[64:67], s11 offen offset:0
    buffer_store_dwordx2 v[78:79], v8, s[64:67], s100 offen offset:32
    buffer_store_dwordx2 v[80:81], v8, s[64:67], s11 offen offset:32
    buffer_store_dword v73, v9, s[64:67], s100 offen
    s_branch L_fin
L_redo:
    s_cmp_eq_u32 s27, s15
    s_cbranch_scc1 L_noredo
    s_mov_b32 s27, s15
    s_nop 7
    ds_read_b128 v[200:203], v4 offset:0
    ds_read_b128 v[204:207], v5 offset:0
    ds_read_b128 v[208:211], v6 offset:0
    ds_read_b128 v[212:215], v7 offset:0
    ds_read_b128 v[216:219], v4 offset:4096
    ds_read_b128 v[220:223], v5 offset:4096
    ds_read_b128 v[224:227], v6 offset:4096
    v_mov_b32 v38, v36
    v_mov_b32 v39, v37
    s_nop 0
    v_permlane16_swap_b32 v36, v38
    v_permlane16_swap_b32 v37, v39
    v_max_f32 v36, v36, v38
    v_max_f32 v37, v37, v39
    v_mov_b32 v38, v36
    v_mov_b32 v39, v37
    s_nop 0
    v_permlane32_swap_b32 v36, v38
    v_permlane32_swap_b32 v37, v39
    v_max_f32 v36, v36, v38
    v_max_f32 v37, v37, v39
    v_add_f32 v36, 0x41800000, v36
    v_add_f32 v37, 0x41800000, v37
    v_max_f32 v36, 0, v36
    v_max_f32 v37, 0, v37
    v_sub_f32 v16, v16, v36
    v_sub_f32 v17, v17, v36
    v_sub_f32 v18, v18, v36
    v_sub_f32 v19, v19, v36
    v_sub_f32 v20, v20, v37
    v_sub_f32 v21, v21, v37
    v_sub_f32 v22, v22, v37
    v_sub_f32 v23, v23, v37
    v_exp_f32 v36, -v36
    v_exp_f32 v37, -v37
    v_mul_f32 v136, v136, v36
    v_mul_f32 v137, v137, v36
    v_mul_f32 v138, v138, v36
    v_mul_f32 v139, v139, v36
    v_mul_f32 v140, v140, v37
    v_mul_f32 v141, v141, v37
    v_mul_f32 v142, v142, v37
    v_mul_f32 v143, v143, v37
    v_mul_f32 v144, v144, v36
    v_mul_f32 v145, v145, v36
    v_mul_f32 v146, v146, v36
    v_mul_f32 v147, v147, v36
    v_mul_f32 v148, v148, v37
    v_mul_f32 v149, v149, v37
    v_mul_f32 v150, v150, v37
    v_mul_f32 v151, v151, v37
    v_mul_f32 v152, v152, v36
    v_mul_f32 v153, v153, v36
    v_mul_f32 v154, v154, v36
    v_mul_f32 v155, v155, v36
    v_mul_f32 v156, v156, v37
    v_mul_f32 v157, v157, v37
    v_mul_f32 v158, v158, v37
    v_mul_f32 v159, v159, v37
    v_mul_f32 v160, v160, v36
    v_mul_f32 v161, v161, v36
    v_mul_f32 v162, v162, v36
    v_mul_f32 v163, v163, v36
    v_mul_f32 v164, v164, v37
    v_mul_f32 v165, v165, v37
    v_mul_f32 v166, v166, v37
    v_mul_f32 v167, v167, v37
    v_mul_f32 v168, v168, v36
    v_mul_f32 v169, v169, v36
    v_mul_f32 v170, v170, v36
    v_mul_f32 v171, v171, v36
    v_mul_f32 v172, v172, v37
    v_mul_f32 v173, v173, v37
    v_mul_f32 v174, v174, v37
    v_mul_f32 v175, v175, v37
    v_mul_f32 v176, v176, v36
    v_mul_f32 v177, v177, v36
    v_mul_f32 v178, v178, v36
    v_mul_f32 v179, v179, v36
    v_mul_f32 v180, v180, v37
    v_mul_f32 v181, v181, v37
    v_mul_f32 v182, v182, v37
    v_mul_f32 v183, v183, v37
    v_mul_f32 v184, v184, v36
    v_mul_f32 v185, v185, v36
    v_mul_f32 v186, v186, v36
    v_mul_f32 v187, v187, v36
    v_mul_f32 v188, v188, v37
    v_mul_f32 v189, v189, v37
    v_mul_f32 v190, v190, v37
    v_mul_f32 v191, v191, v37
    v_mul_f32 v192, v192, v36
    v_mul_f32 v193, v193, v36
    v_mul_f32 v194, v194, v36
    v_mul_f32 v195, v195, v36
    v_mul_f32 v196, v196, v37
    v_mul_f32 v197, v197, v37
    v_mul_f32 v198, v198, v37
    v_mul_f32 v199, v199, v37
    v_mul_f32 v24, v24, v36
    v_mul_f32 v25, v25, v36
    v_mul_f32 v26, v26, v36
    v_mul_f32 v27, v27, v36
    v_mul_f32 v28, v28, v37
    v_mul_f32 v29, v29, v37
    v_mul_f32 v30, v30, v37
    v_mul_f32 v31, v31, v37
    s_nop 1
    s_branch L_att
L_x1:
    s_mov_b32 s96, 200000
L_plx1:
    v_lshrrev_b32 v3, 1, v2
    v_and_b32 v3, 24, v3
    buffer_load_dwordx2 v[6:7], v3, s[68:71], s99 offen offset:64 sc1
    s_sub_u32 s96, s96, 1
    s_cbranch_scc1 L_pxx1
    s_waitcnt vmcnt(0)
L_pcx1:
    v_cmp_ne_u64 s[28:29], s[92:93], v[6:7]
    s_nop 1
    s_cmp_lg_u64 s[28:29], 0
    s_cbranch_scc1 L_plx1
L_pxx1:
    s_mov_b32 s96, 200000
    s_branch L_x1r
L_x20:
    buffer_store_dwordx4 v[40:43], v2, s[68:71], s16 offen offset:0 sc1
    buffer_store_dwordx4 v[44:47], v2, s[68:71], s16 offen offset:1024 sc1
    buffer_store_dwordx4 v[56:59], v2, s[68:71], s16 offen offset:2048 sc1
    buffer_store_dwordx4 v[60:63], v2, s[68:71], s16 offen offset:3072 sc1
    s_branch L_x2r0
L_x21:
    buffer_store_dwordx4 v[76:79], v2, s[68:71], s17 offen offset:0 sc1
    buffer_store_dwordx4 v[84:87], v2, s[68:71], s17 offen offset:1024 sc1
    buffer_store_dwordx4 v[108:111], v2, s[68:71], s17 offen offset:2048 sc1
    buffer_store_dwordx4 v[116:119], v2, s[68:71], s17 offen offset:3072 sc1
    s_branch L_x2r1
L_rd0:
    s_mov_b32 s24, 0
    s_branch L_rdg
L_rd1:
    s_mov_b32 s24, 1
    v_add_u32 v4, 32768, v4
    v_add_u32 v5, 32768, v5
    v_add_u32 v6, 32768, v6
    v_add_u32 v7, 32768, v7
    s_branch L_rdg
L_rd2:
    s_mov_b32 s24, 2
    s_branch L_rdg
L_rd3:
    s_mov_b32 s24, 3
    v_add_u32 v4, 32768, v4
    v_add_u32 v5, 32768, v5
    v_add_u32 v6, 32768, v6
    v_add_u32 v7, 32768, v7
L_rdg:
    s_nop 7
    s_nop 7
    v_mov_b32 v38, v36
    v_mov_b32 v39, v37
    s_nop 0
    v_permlane16_swap_b32 v36, v38
    v_permlane16_swap_b32 v37, v39
    v_max_f32 v36, v36, v38
    v_max_f32 v37, v37, v39
    v_mov_b32 v38, v36
    v_mov_b32 v39, v37
    s_nop 0
    v_permlane32_swap_b32 v36, v38
    v_permlane32_swap_b32 v37, v39
    v_max_f32 v36, v36, v38
    v_max_f32 v37, v37, v39
    v_add_f32 v36, 0x41800000, v36
    v_add_f32 v37, 0x41800000, v37
    v_max_f32 v36, 0, v36
    v_max_f32 v37, 0, v37
    v_ceil_f32 v36, v36
    v_ceil_f32 v37, v37
    v_sub_f32 v16, v16, v36
    v_sub_f32 v17, v17, v36
    v_sub_f32 v18, v18, v36
    v_sub_f32 v19, v19, v36
    v_sub_f32 v20, v20, v37
    v_sub_f32 v21, v21, v37
    v_sub_f32 v22, v22, v37
    v_sub_f32 v23, v23, v37
    v_cvt_i32_f32 v36, -v36
    v_cvt_i32_f32 v37, -v37
    v_ldexp_f32 v36, 1.0, v36
    v_ldexp_f32 v37, 1.0, v37
    v_mul_f32 v24, v24, v36
    v_mul_f32 v25, v25, v36
    v_mul_f32 v26, v26, v36
    v_mul_f32 v27, v27, v36
    v_mul_f32 v28, v28, v37
    v_mul_f32 v29, v29, v37
    v_mul_f32 v30, v30, v37
    v_mul_f32 v31, v31, v37
    v_lshlrev_b32 v38, 16, v136
    v_and_b32 v136, 0xffff0000, v136
    v_mul_f32 v38, v38, v36
    v_mul_f32 v136, v136, v36
    v_cvt_pk_bf16_f32 v136, v38, v136
    v_lshlrev_b32 v38, 16, v137
    v_and_b32 v137, 0xffff0000, v137
    v_mul_f32 v38, v38, v36
    v_mul_f32 v137, v137, v36
    v_cvt_pk_bf16_f32 v137, v38, v137
    v_lshlrev_b32 v38, 16, v138
    v_and_b32 v138, 0xffff0000, v138
    v_mul_f32 v38, v38, v36
    v_mul_f32 v138, v138, v36
    v_cvt_pk_bf16_f32 v138, v38, v138
    v_lshlrev_b32 v38, 16, v139
    v_and_b32 v139, 0xffff0000, v139
    v_mul_f32 v38, v38, v36
    v_mul_f32 v139, v139, v36
    v_cvt_pk_bf16_f32 v139, v38, v139
    v_lshlrev_b32 v38, 16, v140
    v_and_b32 v140, 0xffff0000, v140
    v_mul_f32 v38, v38, v37
    v_mul_f32 v140, v140, v37
    v_cvt_pk_bf16_f32 v140, v38, v140
    v_lshlrev_b32 v38, 16, v141
    v_and_b32 v141, 0xffff0000, v141
    v_mul_f32 v38, v38, v37
    v_mul_f32 v141, v141, v37
    v_cvt_pk_bf16_f32 v141, v38, v141
    v_lshlrev_b32 v38, 16, v142
    v_and_b32 v142, 0xffff0000, v142
    v_mul_f32 v38, v38, v37
    v_mul_f32 v142, v142, v37
    v_cvt_pk_bf16_f32 v142, v38, v142
    v_lshlrev_b32 v38, 16, v143
    v_and_b32 v143, 0xffff0000, v143
    v_mul_f32 v38, v38, v37
    v_mul_f32 v143, v143, v37
    v_cvt_pk_bf16_f32 v143, v38, v143
    v_lshlrev_b32 v38, 16, v144
    v_and_b32 v144, 0xffff0000, v144
    v_mul_f32 v38, v38, v36
    v_mul_f32 v144, v144, v36
    v_cvt_pk_bf16_f32 v144, v38, v144
    v_lshlrev_b32 v38, 16, v145
    v_and_b32 v145, 0xffff0000, v145
    v_mul_f32 v38, v38, v36
    v_mul_f32 v145, v145, v36
    v_cvt_pk_bf16_f32 v145, v38, v145
    v_lshlrev_b32 v38, 16, v146
    v_and_b32 v146, 0xffff0000, v146
    v_mul_f32 v38, v38, v36
    v_mul_f32 v146, v146, v36
    v_cvt_pk_bf16_f32 v146, v38, v146
    v_lshlrev_b32 v38, 16, v147
    v_and_b32 v147, 0xffff0000, v147
    v_mul_f32 v38, v38, v36
    v_mul_f32 v147, v147, v36
    v_cvt_pk_bf16_f32 v147, v38, v147
    v_lshlrev_b32 v38, 16, v148
    v_and_b32 v148, 0xffff0000, v148
    v_mul_f32 v38, v38, v37
    v_mul_f32 v148, v148, v37
    v_cvt_pk_bf16_f32 v148, v38, v148
    v_lshlrev_b32 v38, 16, v149
    v_and_b32 v149, 0xffff0000, v149
    v_mul_f32 v38, v38, v37
    v_mul_f32 v149, v149, v37
    v_cvt_pk_bf16_f32 v149, v38, v149
    v_lshlrev_b32 v38, 16, v150
    v_and_b32 v150, 0xffff0000, v150
    v_mul_f32 v38, v38, v37
    v_mul_f32 v150, v150, v37
    v_cvt_pk_bf16_f32 v150, v38, v150
    v_lshlrev_b32 v38, 16, v151
    v_and_b32 v151, 0xffff0000, v151
    v_mul_f32 v38, v38, v37
    v_mul_f32 v151, v151, v37
    v_cvt_pk_bf16_f32 v151, v38, v151
    v_lshlrev_b32 v38, 16, v152
    v_and_b32 v152, 0xffff0000, v152
    v_mul_f32 v38, v38, v36
    v_mul_f32 v152, v152, v36
    v_cvt_pk_bf16_f32 v152, v38, v152
    v_lshlrev_b32 v38, 16, v153
    v_and_b32 v153, 0xffff0000, v153
    v_mul_f32 v38, v38, v36
    v_mul_f32 v153, v153, v36
    v_cvt_pk_bf16_f32 v153, v38, v153
    v_lshlrev_b32 v38, 16, v154
    v_and_b32 v154, 0xffff0000, v154
    v_mul_f32 v38, v38, v36
    v_mul_f32 v154, v154, v36
    v_cvt_pk_bf16_f32 v154, v38, v154
    v_lshlrev_b32 v38, 16, v155
    v_and_b32 v155, 0xffff0000, v155
    v_mul_f32 v38, v38, v36
    v_mul_f32 v155, v155, v36
    v_cvt_pk_bf16_f32 v155, v38, v155
    v_lshlrev_b32 v38, 16, v156
    v_and_b32 v156, 0xffff0000, v156
    v_mul_f32 v38, v38, v37
    v_mul_f32 v156, v156, v37
    v_cvt_pk_bf16_f32 v156, v38, v156
    v_lshlrev_b32 v38, 16, v157
    v_and_b32 v157, 0xffff0000, v157
    v_mul_f32 v38, v38, v37
    v_mul_f32 v157, v157, v37
    v_cvt_pk_bf16_f32 v157, v38, v157
    v_lshlrev_b32 v38, 16, v158
    v_and_b32 v158, 0xffff0000, v158
    v_mul_f32 v38, v38, v37
    v_mul_f32 v158, v158, v37
    v_cvt_pk_bf16_f32 v158, v38, v158
    v_lshlrev_b32 v38, 16, v159
    v_and_b32 v159, 0xffff0000, v159
    v_mul_f32 v38, v38, v37
    v_mul_f32 v159, v159, v37
    v_cvt_pk_bf16_f32 v159, v38, v159
    v_lshlrev_b32 v38, 16, v160
    v_and_b32 v160, 0xffff0000, v160
    v_mul_f32 v38, v38, v36
    v_mul_f32 v160, v160, v36
    v_cvt_pk_bf16_f32 v160, v38, v160
    v_lshlrev_b32 v38, 16, v161
    v_and_b32 v161, 0xffff0000, v161
    v_mul_f32 v38, v38, v36
    v_mul_f32 v161, v161, v36
    v_cvt_pk_bf16_f32 v161, v38, v161
    v_lshlrev_b32 v38, 16, v162
    v_and_b32 v162, 0xffff0000, v162
    v_mul_f32 v38, v38, v36
    v_mul_f32 v162, v162, v36
    v_cvt_pk_bf16_f32 v162, v38, v162
    v_lshlrev_b32 v38, 16, v163
    v_and_b32 v163, 0xffff0000, v163
    v_mul_f32 v38, v38, v36
    v_mul_f32 v163, v163, v36
    v_cvt_pk_bf16_f32 v163, v38, v163
    v_lshlrev_b32 v38, 16, v164
    v_and_b32 v164, 0xffff0000, v164
    v_mul_f32 v38, v38, v37
    v_mul_f32 v164, v164, v37
    v_cvt_pk_bf16_f32 v164, v38, v164
    v_lshlrev_b32 v38, 16, v165
    v_and_b32 v165, 0xffff0000, v165
    v_mul_f32 v38, v38, v37
    v_mul_f32 v165, v165, v37
    v_cvt_pk_bf16_f32 v165, v38, v165
    v_lshlrev_b32 v38, 16, v166
    v_and_b32 v166, 0xffff0000, v166
    v_mul_f32 v38, v38, v37
    v_mul_f32 v166, v166, v37
    v_cvt_pk_bf16_f32 v166, v38, v166
    v_lshlrev_b32 v38, 16, v167
    v_and_b32 v167, 0xffff0000, v167
    v_mul_f32 v38, v38, v37
    v_mul_f32 v167, v167, v37
    v_cvt_pk_bf16_f32 v167, v38, v167
    v_lshlrev_b32 v38, 16, v168
    v_and_b32 v168, 0xffff0000, v168
    v_mul_f32 v38, v38, v36
    v_mul_f32 v168, v168, v36
    v_cvt_pk_bf16_f32 v168, v38, v168
    v_lshlrev_b32 v38, 16, v169
    v_and_b32 v169, 0xffff0000, v169
    v_mul_f32 v38, v38, v36
    v_mul_f32 v169, v169, v36
    v_cvt_pk_bf16_f32 v169, v38, v169
    v_lshlrev_b32 v38, 16, v170
    v_and_b32 v170, 0xffff0000, v170
    v_mul_f32 v38, v38, v36
    v_mul_f32 v170, v170, v36
    v_cvt_pk_bf16_f32 v170, v38, v170
    v_lshlrev_b32 v38, 16, v171
    v_and_b32 v171, 0xffff0000, v171
    v_mul_f32 v38, v38, v36
    v_mul_f32 v171, v171, v36
    v_cvt_pk_bf16_f32 v171, v38, v171
    v_lshlrev_b32 v38, 16, v172
    v_and_b32 v172, 0xffff0000, v172
    v_mul_f32 v38, v38, v37
    v_mul_f32 v172, v172, v37
    v_cvt_pk_bf16_f32 v172, v38, v172
    v_lshlrev_b32 v38, 16, v173
    v_and_b32 v173, 0xffff0000, v173
    v_mul_f32 v38, v38, v37
    v_mul_f32 v173, v173, v37
    v_cvt_pk_bf16_f32 v173, v38, v173
    v_lshlrev_b32 v38, 16, v174
    v_and_b32 v174, 0xffff0000, v174
    v_mul_f32 v38, v38, v37
    v_mul_f32 v174, v174, v37
    v_cvt_pk_bf16_f32 v174, v38, v174
    v_lshlrev_b32 v38, 16, v175
    v_and_b32 v175, 0xffff0000, v175
    v_mul_f32 v38, v38, v37
    v_mul_f32 v175, v175, v37
    v_cvt_pk_bf16_f32 v175, v38, v175
    v_lshlrev_b32 v38, 16, v176
    v_and_b32 v176, 0xffff0000, v176
    v_mul_f32 v38, v38, v36
    v_mul_f32 v176, v176, v36
    v_cvt_pk_bf16_f32 v176, v38, v176
    v_lshlrev_b32 v38, 16, v177
    v_and_b32 v177, 0xffff0000, v177
    v_mul_f32 v38, v38, v36
    v_mul_f32 v177, v177, v36
    v_cvt_pk_bf16_f32 v177, v38, v177
    v_lshlrev_b32 v38, 16, v178
    v_and_b32 v178, 0xffff0000, v178
    v_mul_f32 v38, v38, v36
    v_mul_f32 v178, v178, v36
    v_cvt_pk_bf16_f32 v178, v38, v178
    v_lshlrev_b32 v38, 16, v179
    v_and_b32 v179, 0xffff0000, v179
    v_mul_f32 v38, v38, v36
    v_mul_f32 v179, v179, v36
    v_cvt_pk_bf16_f32 v179, v38, v179
    v_lshlrev_b32 v38, 16, v180
    v_and_b32 v180, 0xffff0000, v180
    v_mul_f32 v38, v38, v37
    v_mul_f32 v180, v180, v37
    v_cvt_pk_bf16_f32 v180, v38, v180
    v_lshlrev_b32 v38, 16, v181
    v_and_b32 v181, 0xffff0000, v181
    v_mul_f32 v38, v38, v37
    v_mul_f32 v181, v181, v37
    v_cvt_pk_bf16_f32 v181, v38, v181
    v_lshlrev_b32 v38, 16, v182
    v_and_b32 v182, 0xffff0000, v182
    v_mul_f32 v38, v38, v37
    v_mul_f32 v182, v182, v37
    v_cvt_pk_bf16_f32 v182, v38, v182
    v_lshlrev_b32 v38, 16, v183
    v_and_b32 v183, 0xffff0000, v183
    v_mul_f32 v38, v38, v37
    v_mul_f32 v183, v183, v37
    v_cvt_pk_bf16_f32 v183, v38, v183
    v_lshlrev_b32 v38, 16, v184
    v_and_b32 v184, 0xffff0000, v184
    v_mul_f32 v38, v38, v36
    v_mul_f32 v184, v184, v36
    v_cvt_pk_bf16_f32 v184, v38, v184
    v_lshlrev_b32 v38, 16, v185
    v_and_b32 v185, 0xffff0000, v185
    v_mul_f32 v38, v38, v36
    v_mul_f32 v185, v185, v36
    v_cvt_pk_bf16_f32 v185, v38, v185
    v_lshlrev_b32 v38, 16, v186
    v_and_b32 v186, 0xffff0000, v186
    v_mul_f32 v38, v38, v36
    v_mul_f32 v186, v186, v36
    v_cvt_pk_bf16_f32 v186, v38, v186
    v_lshlrev_b32 v38, 16, v187
    v_and_b32 v187, 0xffff0000, v187
    v_mul_f32 v38, v38, v36
    v_mul_f32 v187, v187, v36
    v_cvt_pk_bf16_f32 v187, v38, v187
    v_lshlrev_b32 v38, 16, v188
    v_and_b32 v188, 0xffff0000, v188
    v_mul_f32 v38, v38, v37
    v_mul_f32 v188, v188, v37
    v_cvt_pk_bf16_f32 v188, v38, v188
    v_lshlrev_b32 v38, 16, v189
    v_and_b32 v189, 0xffff0000, v189
    v_mul_f32 v38, v38, v37
    v_mul_f32 v189, v189, v37
    v_cvt_pk_bf16_f32 v189, v38, v189
    v_lshlrev_b32 v38, 16, v190
    v_and_b32 v190, 0xffff0000, v190
    v_mul_f32 v38, v38, v37
    v_mul_f32 v190, v190, v37
    v_cvt_pk_bf16_f32 v190, v38, v190
    v_lshlrev_b32 v38, 16, v191
    v_and_b32 v191, 0xffff0000, v191
    v_mul_f32 v38, v38, v37
    v_mul_f32 v191, v191, v37
    v_cvt_pk_bf16_f32 v191, v38, v191
    v_lshlrev_b32 v38, 16, v192
    v_and_b32 v192, 0xffff0000, v192
    v_mul_f32 v38, v38, v36
    v_mul_f32 v192, v192, v36
    v_cvt_pk_bf16_f32 v192, v38, v192
    v_lshlrev_b32 v38, 16, v193
    v_and_b32 v193, 0xffff0000, v193
    v_mul_f32 v38, v38, v36
    v_mul_f32 v193, v193, v36
    v_cvt_pk_bf16_f32 v193, v38, v193
    v_lshlrev_b32 v38, 16, v194
    v_and_b32 v194, 0xffff0000, v194
    v_mul_f32 v38, v38, v36
    v_mul_f32 v194, v194, v36
    v_cvt_pk_bf16_f32 v194, v38, v194
    v_lshlrev_b32 v38, 16, v195
    v_and_b32 v195, 0xffff0000, v195
    v_mul_f32 v38, v38, v36
    v_mul_f32 v195, v195, v36
    v_cvt_pk_bf16_f32 v195, v38, v195
    v_lshlrev_b32 v38, 16, v196
    v_and_b32 v196, 0xffff0000, v196
    v_mul_f32 v38, v38, v37
    v_mul_f32 v196, v196, v37
    v_cvt_pk_bf16_f32 v196, v38, v196
    v_lshlrev_b32 v38, 16, v197
    v_and_b32 v197, 0xffff0000, v197
    v_mul_f32 v38, v38, v37
    v_mul_f32 v197, v197, v37
    v_cvt_pk_bf16_f32 v197, v38, v197
    v_lshlrev_b32 v38, 16, v198
    v_and_b32 v198, 0xffff0000, v198
    v_mul_f32 v38, v38, v37
    v_mul_f32 v198, v198, v37
    v_cvt_pk_bf16_f32 v198, v38, v198
    v_lshlrev_b32 v38, 16, v199
    v_and_b32 v199, 0xffff0000, v199
    v_mul_f32 v38, v38, v37
    v_mul_f32 v199, v199, v37
    v_cvt_pk_bf16_f32 v199, v38, v199
    v_lshlrev_b32 v38, 16, v232
    v_and_b32 v232, 0xffff0000, v232
    v_mul_f32 v38, v38, v36
    v_mul_f32 v232, v232, v36
    v_cvt_pk_bf16_f32 v232, v38, v232
    v_lshlrev_b32 v38, 16, v233
    v_and_b32 v233, 0xffff0000, v233
    v_mul_f32 v38, v38, v36
    v_mul_f32 v233, v233, v36
    v_cvt_pk_bf16_f32 v233, v38, v233
    v_lshlrev_b32 v38, 16, v234
    v_and_b32 v234, 0xffff0000, v234
    v_mul_f32 v38, v38, v36
    v_mul_f32 v234, v234, v36
    v_cvt_pk_bf16_f32 v234, v38, v234
    v_lshlrev_b32 v38, 16, v235
    v_and_b32 v235, 0xffff0000, v235
    v_mul_f32 v38, v38, v36
    v_mul_f32 v235, v235, v36
    v_cvt_pk_bf16_f32 v235, v38, v235
    v_lshlrev_b32 v38, 16, v236
    v_and_b32 v236, 0xffff0000, v236
    v_mul_f32 v38, v38, v37
    v_mul_f32 v236, v236, v37
    v_cvt_pk_bf16_f32 v236, v38, v236
    v_lshlrev_b32 v38, 16, v237
    v_and_b32 v237, 0xffff0000, v237
    v_mul_f32 v38, v38, v37
    v_mul_f32 v237, v237, v37
    v_cvt_pk_bf16_f32 v237, v38, v237
    v_lshlrev_b32 v38, 16, v238
    v_and_b32 v238, 0xffff0000, v238
    v_mul_f32 v38, v38, v37
    v_mul_f32 v238, v238, v37
    v_cvt_pk_bf16_f32 v238, v38, v238
    v_lshlrev_b32 v38, 16, v239
    v_and_b32 v239, 0xffff0000, v239
    v_mul_f32 v38, v38, v37
    v_mul_f32 v239, v239, v37
    v_cvt_pk_bf16_f32 v239, v38, v239
    v_lshlrev_b32 v38, 16, v240
    v_and_b32 v240, 0xffff0000, v240
    v_mul_f32 v38, v38, v36
    v_mul_f32 v240, v240, v36
    v_cvt_pk_bf16_f32 v240, v38, v240
    v_lshlrev_b32 v38, 16, v241
    v_and_b32 v241, 0xffff0000, v241
    v_mul_f32 v38, v38, v36
    v_mul_f32 v241, v241, v36
    v_cvt_pk_bf16_f32 v241, v38, v241
    v_lshlrev_b32 v38, 16, v242
    v_and_b32 v242, 0xffff0000, v242
    v_mul_f32 v38, v38, v36
    v_mul_f32 v242, v242, v36
    v_cvt_pk_bf16_f32 v242, v38, v242
    v_lshlrev_b32 v38, 16, v243
    v_and_b32 v243, 0xffff0000, v243
    v_mul_f32 v38, v38, v36
    v_mul_f32 v243, v243, v36
    v_cvt_pk_bf16_f32 v243, v38, v243
    v_lshlrev_b32 v38, 16, v244
    v_and_b32 v244, 0xffff0000, v244
    v_mul_f32 v38, v38, v37
    v_mul_f32 v244, v244, v37
    v_cvt_pk_bf16_f32 v244, v38, v244
    v_lshlrev_b32 v38, 16, v245
    v_and_b32 v245, 0xffff0000, v245
    v_mul_f32 v38, v38, v37
    v_mul_f32 v245, v245, v37
    v_cvt_pk_bf16_f32 v245, v38, v245
    v_lshlrev_b32 v38, 16, v246
    v_and_b32 v246, 0xffff0000, v246
    v_mul_f32 v38, v38, v37
    v_mul_f32 v246, v246, v37
    v_cvt_pk_bf16_f32 v246, v38, v246
    v_lshlrev_b32 v38, 16, v247
    v_and_b32 v247, 0xffff0000, v247
    v_mul_f32 v38, v38, v37
    v_mul_f32 v247, v247, v37
    v_cvt_pk_bf16_f32 v247, v38, v247
    v_lshlrev_b32 v38, 16, v248
    v_and_b32 v248, 0xffff0000, v248
    v_mul_f32 v38, v38, v36
    v_mul_f32 v248, v248, v36
    v_cvt_pk_bf16_f32 v248, v38, v248
    v_lshlrev_b32 v38, 16, v249
    v_and_b32 v249, 0xffff0000, v249
    v_mul_f32 v38, v38, v36
    v_mul_f32 v249, v249, v36
    v_cvt_pk_bf16_f32 v249, v38, v249
    v_lshlrev_b32 v38, 16, v250
    v_and_b32 v250, 0xffff0000, v250
    v_mul_f32 v38, v38, v36
    v_mul_f32 v250, v250, v36
    v_cvt_pk_bf16_f32 v250, v38, v250
    v_lshlrev_b32 v38, 16, v251
    v_and_b32 v251, 0xffff0000, v251
    v_mul_f32 v38, v38, v36
    v_mul_f32 v251, v251, v36
    v_cvt_pk_bf16_f32 v251, v38, v251
    v_lshlrev_b32 v38, 16, v252
    v_and_b32 v252, 0xffff0000, v252
    v_mul_f32 v38, v38, v37
    v_mul_f32 v252, v252, v37
    v_cvt_pk_bf16_f32 v252, v38, v252
    v_lshlrev_b32 v38, 16, v253
    v_and_b32 v253, 0xffff0000, v253
    v_mul_f32 v38, v38, v37
    v_mul_f32 v253, v253, v37
    v_cvt_pk_bf16_f32 v253, v38, v253
    v_lshlrev_b32 v38, 16, v254
    v_and_b32 v254, 0xffff0000, v254
    v_mul_f32 v38, v38, v37
    v_mul_f32 v254, v254, v37
    v_cvt_pk_bf16_f32 v254, v38, v254
    v_lshlrev_b32 v38, 16, v255
    v_and_b32 v255, 0xffff0000, v255
    v_mul_f32 v38, v38, v37
    v_mul_f32 v255, v255, v37
    v_cvt_pk_bf16_f32 v255, v38, v255
    v_lshlrev_b32 v38, 16, v8
    v_and_b32 v8, 0xffff0000, v8
    v_mul_f32 v38, v38, v36
    v_mul_f32 v8, v8, v36
    v_cvt_pk_bf16_f32 v8, v38, v8
    v_lshlrev_b32 v38, 16, v9
    v_and_b32 v9, 0xffff0000, v9
    v_mul_f32 v38, v38, v36
    v_mul_f32 v9, v9, v36
    v_cvt_pk_bf16_f32 v9, v38, v9
    v_lshlrev_b32 v38, 16, v10
    v_and_b32 v10, 0xffff0000, v10
    v_mul_f32 v38, v38, v36
    v_mul_f32 v10, v10, v36
    v_cvt_pk_bf16_f32 v10, v38, v10
    v_lshlrev_b32 v38, 16, v11
    v_and_b32 v11, 0xffff0000, v11
    v_mul_f32 v38, v38, v36
    v_mul_f32 v11, v11, v36
    v_cvt_pk_bf16_f32 v11, v38, v11
    v_lshlrev_b32 v38, 16, v12
    v_and_b32 v12, 0xffff0000, v12
    v_mul_f32 v38, v38, v37
    v_mul_f32 v12, v12, v37
    v_cvt_pk_bf16_f32 v12, v38, v12
    v_lshlrev_b32 v38, 16, v13
    v_and_b32 v13, 0xffff0000, v13
    v_mul_f32 v38, v38, v37
    v_mul_f32 v13, v13, v37
    v_cvt_pk_bf16_f32 v13, v38, v13
    v_lshlrev_b32 v38, 16, v14
    v_and_b32 v14, 0xffff0000, v14
    v_mul_f32 v38, v38, v37
    v_mul_f32 v14, v14, v37
    v_cvt_pk_bf16_f32 v14, v38, v14
    v_lshlrev_b32 v38, 16, v15
    v_and_b32 v15, 0xffff0000, v15
    v_mul_f32 v38, v38, v37
    v_mul_f32 v15, v15, v37
    v_cvt_pk_bf16_f32 v15, v38, v15
    s_waitcnt lgkmcnt(6)
    ds_read_b128 v[200:203], v4 offset:0
    s_waitcnt lgkmcnt(6)
    ds_read_b128 v[204:207], v5 offset:0
    s_waitcnt lgkmcnt(6)
    ds_read_b128 v[208:211], v6 offset:0
    s_waitcnt lgkmcnt(6)
    ds_read_b128 v[212:215], v7 offset:0
    s_waitcnt lgkmcnt(6)
    ds_read_b128 v[216:219], v4 offset:4096
    s_waitcnt lgkmcnt(6)
    ds_read_b128 v[220:223], v5 offset:4096
    s_waitcnt lgkmcnt(6)
    ds_read_b128 v[224:227], v6 offset:4096
    ds_read_b128 v[228:231], v7 offset:4096
    s_waitcnt lgkmcnt(7)
    v_mfma_f32_16x16x32_bf16 v[72:75], v[200:203], v[40:43], v[16:19]
    v_mfma_f32_16x16x32_bf16 v[80:83], v[200:203], v[44:47], v[20:23]
    s_waitcnt lgkmcnt(6)
    v_mfma_f32_16x16x32_bf16 v[72:75], v[204:207], v[48:51], v[72:75]
    v_mfma_f32_16x16x32_bf16 v[80:83], v[204:207], v[52:55], v[80:83]
    s_waitcnt lgkmcnt(5)
    v_mfma_f32_16x16x32_bf16 v[72:75], v[208:211], v[56:59], v[72:75]
    v_mfma_f32_16x16x32_bf16 v[80:83], v[208:211], v[60:63], v[80:83]
    s_waitcnt lgkmcnt(4)
    v_mfma_f32_16x16x32_bf16 v[72:75], v[212:215], v[64:67], v[72:75]
    v_mfma_f32_16x16x32_bf16 v[80:83], v[212:215], v[68:71], v[80:83]
    s_waitcnt lgkmcnt(3)
    v_mfma_f32_16x16x32_bf16 v[76:79], v[216:219], v[40:43], v[16:19]
    v_mfma_f32_16x16x32_bf16 v[84:87], v[216:219], v[44:47], v[20:23]
    s_waitcnt lgkmcnt(2)
    v_mfma_f32_16x16x32_bf16 v[76:79], v[220:223], v[48:51], v[76:79]
    v_mfma_f32_16x16x32_bf16 v[84:87], v[220:223], v[52:55], v[84:87]
    s_waitcnt lgkmcnt(1)
    v_mfma_f32_16x16x32_bf16 v[76:79], v[224:227], v[56:59], v[76:79]
    v_mfma_f32_16x16x32_bf16 v[84:87], v[224:227], v[60:63], v[84:87]
    s_waitcnt lgkmcnt(0)
    v_mfma_f32_16x16x32_bf16 v[76:79], v[228:231], v[64:67], v[76:79]
    v_mfma_f32_16x16x32_bf16 v[84:87], v[228:231], v[68:71], v[84:87]
    ds_read_b128 v[200:203], v4 offset:8192
    ds_read_b128 v[204:207], v5 offset:8192
    ds_read_b128 v[208:211], v6 offset:8192
    ds_read_b128 v[212:215], v7 offset:8192
    ds_read_b128 v[216:219], v4 offset:12288
    ds_read_b128 v[220:223], v5 offset:12288
    ds_read_b128 v[224:227], v6 offset:12288
    ds_read_b128 v[228:231], v7 offset:12288
    s_waitcnt lgkmcnt(7)
    v_mfma_f32_16x16x32_bf16 v[88:91], v[200:203], v[40:43], v[16:19]
    v_mfma_f32_16x16x32_bf16 v[96:99], v[200:203], v[44:47], v[20:23]
    s_waitcnt lgkmcnt(6)
    v_mfma_f32_16x16x32_bf16 v[88:91], v[204:207], v[48:51], v[88:91]
    v_mfma_f32_16x16x32_bf16 v[96:99], v[204:207], v[52:55], v[96:99]
    s_waitcnt lgkmcnt(5)
    v_mfma_f32_16x16x32_bf16 v[88:91], v[208:211], v[56:59], v[88:91]
    v_mfma_f32_16x16x32_bf16 v[96:99], v[208:211], v[60:63], v[96:99]
    s_waitcnt lgkmcnt(4)
    v_mfma_f32_16x16x32_bf16 v[88:91], v[212:215], v[64:67], v[88:91]
    v_mfma_f32_16x16x32_bf16 v[96:99], v[212:215], v[68:71], v[96:99]
    s_waitcnt lgkmcnt(3)
    v_mfma_f32_16x16x32_bf16 v[92:95], v[216:219], v[40:43], v[16:19]
    v_mfma_f32_16x16x32_bf16 v[100:103], v[216:219], v[44:47], v[20:23]
    s_waitcnt lgkmcnt(2)
    v_mfma_f32_16x16x32_bf16 v[92:95], v[220:223], v[48:51], v[92:95]
    v_mfma_f32_16x16x32_bf16 v[100:103], v[220:223], v[52:55], v[100:103]
    s_waitcnt lgkmcnt(1)
    v_mfma_f32_16x16x32_bf16 v[92:95], v[224:227], v[56:59], v[92:95]
    v_mfma_f32_16x16x32_bf16 v[100:103], v[224:227], v[60:63], v[100:103]
    s_waitcnt lgkmcnt(0)
    v_mfma_f32_16x16x32_bf16 v[92:95], v[228:231], v[64:67], v[92:95]
    v_mfma_f32_16x16x32_bf16 v[100:103], v[228:231], v[68:71], v[100:103]
    ds_read_b128 v[200:203], v4 offset:16384
    ds_read_b128 v[204:207], v5 offset:16384
    ds_read_b128 v[208:211], v6 offset:16384
    ds_read_b128 v[212:215], v7 offset:16384
    ds_read_b128 v[216:219], v4 offset:20480
    ds_read_b128 v[220:223], v5 offset:20480
    ds_read_b128 v[224:227], v6 offset:20480
    ds_read_b128 v[228:231], v7 offset:20480
    s_waitcnt lgkmcnt(7)
    v_mfma_f32_16x16x32_bf16 v[104:107], v[200:203], v[40:43], v[16:19]
    v_mfma_f32_16x16x32_bf16 v[112:115], v[200:203], v[44:47], v[20:23]
    s_waitcnt lgkmcnt(6)
    v_mfma_f32_16x16x32_bf16 v[104:107], v[204:207], v[48:51], v[104:107]
    v_mfma_f32_16x16x32_bf16 v[112:115], v[204:207], v[52:55], v[112:115]
    s_waitcnt lgkmcnt(5)
    v_mfma_f32_16x16x32_bf16 v[104:107], v[208:211], v[56:59], v[104:107]
    v_mfma_f32_16x16x32_bf16 v[112:115], v[208:211], v[60:63], v[112:115]
    s_waitcnt lgkmcnt(4)
    v_mfma_f32_16x16x32_bf16 v[104:107], v[212:215], v[64:67], v[104:107]
    v_mfma_f32_16x16x32_bf16 v[112:115], v[212:215], v[68:71], v[112:115]
    s_waitcnt lgkmcnt(3)
    v_mfma_f32_16x16x32_bf16 v[108:111], v[216:219], v[40:43], v[16:19]
    v_mfma_f32_16x16x32_bf16 v[116:119], v[216:219], v[44:47], v[20:23]
    s_waitcnt lgkmcnt(2)
    v_mfma_f32_16x16x32_bf16 v[108:111], v[220:223], v[48:51], v[108:111]
    v_mfma_f32_16x16x32_bf16 v[116:119], v[220:223], v[52:55], v[116:119]
    s_waitcnt lgkmcnt(1)
    v_mfma_f32_16x16x32_bf16 v[108:111], v[224:227], v[56:59], v[108:111]
    v_mfma_f32_16x16x32_bf16 v[116:119], v[224:227], v[60:63], v[116:119]
    s_waitcnt lgkmcnt(0)
    v_mfma_f32_16x16x32_bf16 v[108:111], v[228:231], v[64:67], v[108:111]
    v_mfma_f32_16x16x32_bf16 v[116:119], v[228:231], v[68:71], v[116:119]
    ds_read_b128 v[200:203], v4 offset:24576
    ds_read_b128 v[204:207], v5 offset:24576
    ds_read_b128 v[208:211], v6 offset:24576
    ds_read_b128 v[212:215], v7 offset:24576
    ds_read_b128 v[216:219], v4 offset:28672
    ds_read_b128 v[220:223], v5 offset:28672
    ds_read_b128 v[224:227], v6 offset:28672
    ds_read_b128 v[228:231], v7 offset:28672
    s_waitcnt lgkmcnt(7)
    v_mfma_f32_16x16x32_bf16 v[120:123], v[200:203], v[40:43], v[16:19]
    v_mfma_f32_16x16x32_bf16 v[128:131], v[200:203], v[44:47], v[20:23]
    s_waitcnt lgkmcnt(6)
    v_mfma_f32_16x16x32_bf16 v[120:123], v[204:207], v[48:51], v[120:123]
    v_mfma_f32_16x16x32_bf16 v[128:131], v[204:207], v[52:55], v[128:131]
    s_waitcnt lgkmcnt(5)
    v_mfma_f32_16x16x32_bf16 v[120:123], v[208:211], v[56:59], v[120:123]
    v_mfma_f32_16x16x32_bf16 v[128:131], v[208:211], v[60:63], v[128:131]
    s_waitcnt lgkmcnt(4)
    v_mfma_f32_16x16x32_bf16 v[120:123], v[212:215], v[64:67], v[120:123]
    v_mfma_f32_16x16x32_bf16 v[128:131], v[212:215], v[68:71], v[128:131]
    s_waitcnt lgkmcnt(3)
    v_mfma_f32_16x16x32_bf16 v[124:127], v[216:219], v[40:43], v[16:19]
    v_mfma_f32_16x16x32_bf16 v[132:135], v[216:219], v[44:47], v[20:23]
    s_waitcnt lgkmcnt(2)
    v_mfma_f32_16x16x32_bf16 v[124:127], v[220:223], v[48:51], v[124:127]
    v_mfma_f32_16x16x32_bf16 v[132:135], v[220:223], v[52:55], v[132:135]
    s_waitcnt lgkmcnt(1)
    v_mfma_f32_16x16x32_bf16 v[124:127], v[224:227], v[56:59], v[124:127]
    v_mfma_f32_16x16x32_bf16 v[132:135], v[224:227], v[60:63], v[132:135]
    s_waitcnt lgkmcnt(0)
    v_mfma_f32_16x16x32_bf16 v[124:127], v[228:231], v[64:67], v[124:127]
    v_mfma_f32_16x16x32_bf16 v[132:135], v[228:231], v[68:71], v[132:135]
    s_nop 7
    s_nop 7
    s_cmp_lg_u32 s24, 0
    s_cbranch_scc1 L_re0
    v_exp_f32 v72, v72
    v_exp_f32 v73, v73
    v_exp_f32 v74, v74
    v_exp_f32 v75, v75
    v_exp_f32 v76, v76
    v_exp_f32 v77, v77
    v_exp_f32 v78, v78
    v_exp_f32 v79, v79
    v_exp_f32 v80, v80
    v_exp_f32 v81, v81
    v_cvt_pk_bf16_f32 v136, v72, v73
    v_cvt_pk_bf16_f32 v137, v74, v75
    v_cvt_pk_bf16_f32 v138, v76, v77
    v_cvt_pk_bf16_f32 v139, v78, v79
    v_exp_f32 v82, v82
    v_exp_f32 v83, v83
    v_exp_f32 v84, v84
    v_exp_f32 v85, v85
    v_exp_f32 v86, v86
    v_exp_f32 v87, v87
    v_cvt_pk_bf16_f32 v140, v80, v81
    v_cvt_pk_bf16_f32 v141, v82, v83
    v_cvt_pk_bf16_f32 v142, v84, v85
    v_cvt_pk_bf16_f32 v143, v86, v87
    v_exp_f32 v88, v88
    v_exp_f32 v89, v89
    v_exp_f32 v90, v90
    v_exp_f32 v91, v91
    v_exp_f32 v92, v92
    v_exp_f32 v93, v93
    v_exp_f32 v94, v94
    v_exp_f32 v95, v95
    v_exp_f32 v96, v96
    v_exp_f32 v97, v97
    v_cvt_pk_bf16_f32 v144, v88, v89
    v_cvt_pk_bf16_f32 v145, v90, v91
    v_cvt_pk_bf16_f32 v146, v92, v93
    v_cvt_pk_bf16_f32 v147, v94, v95
    v_exp_f32 v98, v98
    v_exp_f32 v99, v99
    s_nop 1
    s_branch L_nr0
L_re0:
    s_cmp_lg_u32 s24, 1
    s_cbranch_scc1 L_re1
    v_subrev_u32 v4, 32768, v4
    v_subrev_u32 v5, 32768, v5
    v_subrev_u32 v6, 32768, v6
    v_subrev_u32 v7, 32768, v7
    v_exp_f32 v72, v72
    v_exp_f32 v73, v73
    v_exp_f32 v74, v74
    v_exp_f32 v75, v75
    v_exp_f32 v76, v76
    v_exp_f32 v77, v77
    v_exp_f32 v78, v78
    v_exp_f32 v79, v79
    v_exp_f32 v80, v80
    v_exp_f32 v81, v81
    v_cvt_pk_bf16_f32 v168, v72, v73
    v_cvt_pk_bf16_f32 v169, v74, v75
    v_cvt_pk_bf16_f32 v170, v76, v77
    v_cvt_pk_bf16_f32 v171, v78, v79
    v_exp_f32 v82, v82
    v_exp_f32 v83, v83
    v_exp_f32 v84, v84
    v_exp_f32 v85, v85
    v_exp_f32 v86, v86
    v_exp_f32 v87, v87
    v_cvt_pk_bf16_f32 v172, v80, v81
    v_cvt_pk_bf16_f32 v173, v82, v83
    v_cvt_pk_bf16_f32 v174, v84, v85
    v_cvt_pk_bf16_f32 v175, v86, v87
    v_exp_f32 v88, v88
    v_exp_f32 v89, v89
    v_exp_f32 v90, v90
    v_exp_f32 v91, v91
    v_exp_f32 v92, v92
    v_exp_f32 v93, v93
    v_exp_f32 v94, v94
    v_exp_f32 v95, v95
    v_exp_f32 v96, v96
    v_exp_f32 v97, v97
    v_cvt_pk_bf16_f32 v176, v88, v89
    v_cvt_pk_bf16_f32 v177, v90, v91
    v_cvt_pk_bf16_f32 v178, v92, v93
    v_cvt_pk_bf16_f32 v179, v94, v95
    s_nop 1
    s_branch L_nr1
L_re1:
    s_cmp_lg_u32 s24, 2
    s_cbranch_scc1 L_re2
    v_exp_f32 v72, v72
    v_exp_f32 v73, v73
    v_exp_f32 v74, v74
    v_exp_f32 v75, v75
    v_exp_f32 v76, v76
    v_exp_f32 v77, v77
    v_exp_f32 v78, v78
    v_exp_f32 v79, v79
    v_exp_f32 v80, v80
    v_exp_f32 v81, v81
    v_cvt_pk_bf16_f32 v232, v72, v73
    v_cvt_pk_bf16_f32 v233, v74, v75
    v_cvt_pk_bf16_f32 v234, v76, v77
    v_cvt_pk_bf16_f32 v235, v78, v79
    v_exp_f32 v82, v82
    v_exp_f32 v83, v83
    v_exp_f32 v84, v84
    v_exp_f32 v85, v85
    v_exp_f32 v86, v86
    v_exp_f32 v87, v87
    v_cvt_pk_bf16_f32 v236, v80, v81
    v_cvt_pk_bf16_f32 v237, v82, v83
    v_cvt_pk_bf16_f32 v238, v84, v85
    v_cvt_pk_bf16_f32 v239, v86, v87
    v_exp_f32 v88, v88
    v_exp_f32 v89, v89
    v_exp_f32 v90, v90
    v_exp_f32 v91, v91
    v_exp_f32 v92, v92
    v_exp_f32 v93, v93
    v_exp_f32 v94, v94
    v_exp_f32 v95, v95
    v_exp_f32 v96, v96
    v_exp_f32 v97, v97
    v_cvt_pk_bf16_f32 v240, v88, v89
    v_cvt_pk_bf16_f32 v241, v90, v91
    s_nop 1
    s_branch L_nr2
L_re2:
    v_subrev_u32 v4, 32768, v4
    v_subrev_u32 v5, 32768, v5
    v_subrev_u32 v6, 32768, v6
    v_subrev_u32 v7, 32768, v7
    v_exp_f32 v72, v72
    v_exp_f32 v73, v73
    v_exp_f32 v74, v74
    v_exp_f32 v75, v75
    v_exp_f32 v76, v76
    v_exp_f32 v77, v77
    v_exp_f32 v78, v78
    v_exp_f32 v79, v79
    v_exp_f32 v80, v80
    v_exp_f32 v81, v81
    v_cvt_pk_bf16_f32 v72, v72, v73
    v_cvt_pk_bf16_f32 v73, v74, v75
    v_cvt_pk_bf16_f32 v74, v76, v77
    v_cvt_pk_bf16_f32 v75, v78, v79
    v_exp_f32 v82, v82
    v_exp_f32 v83, v83
    v_exp_f32 v84, v84
    v_exp_f32 v85, v85
    v_exp_f32 v86, v86
    v_exp_f32 v87, v87
    v_cvt_pk_bf16_f32 v80, v80, v81
    v_cvt_pk_bf16_f32 v81, v82, v83
    v_cvt_pk_bf16_f32 v82, v84, v85
    v_cvt_pk_bf16_f32 v83, v86, v87
    v_exp_f32 v88, v88
    v_exp_f32 v89, v89
    v_exp_f32 v90, v90
    v_exp_f32 v91, v91
    v_exp_f32 v92, v92
    v_exp_f32 v93, v93
    v_exp_f32 v94, v94
    v_exp_f32 v95, v95
    v_exp_f32 v96, v96
    v_exp_f32 v97, v97
    v_cvt_pk_bf16_f32 v88, v88, v89
    s_nop 1
    s_branch L_nr3
L_re3:
L_rta0:
    s_sub_u32 s96, s96, 1
    s_cbranch_scc1 L_rya0
    v_and_b32 v3, v40, v44
    v_and_b32 v3, v3, v48
    v_and_b32 v3, v3, v52
    v_and_b32 v3, 1, v3
    v_cmp_ne_u32 vcc, 1, v3
    s_cbranch_vccz L_rl_29
    s_sub_u32 s14, s36, 4096
    buffer_load_dwordx4 v[40:43], v2, s[68:71], s14 offen offset:0 sc1
    buffer_load_dwordx4 v[44:47], v2, s[68:71], s14 offen offset:1024 sc1
    buffer_load_dwordx4 v[48:51], v2, s[68:71], s14 offen offset:2048 sc1
    buffer_load_dwordx4 v[52:55], v2, s[68:71], s14 offen offset:3072 sc1
L_rl_29:
    s_waitcnt vmcnt(0)
    s_branch L_rva0
L_rya0:
    s_mov_b32 s96, 200000
    s_branch L_rxa0
L_rta1:
    s_sub_u32 s96, s96, 1
    s_cbranch_scc1 L_rya1
    v_and_b32 v3, v56, v60
    v_and_b32 v3, v3, v64
    v_and_b32 v3, v3, v68
    v_and_b32 v3, 1, v3
    v_cmp_ne_u32 vcc, 1, v3
    s_cbranch_vccz L_rl_30
    s_sub_u32 s14, s37, 4096
    buffer_load_dwordx4 v[56:59], v2, s[68:71], s14 offen offset:0 sc1
    buffer_load_dwordx4 v[60:63], v2, s[68:71], s14 offen offset:1024 sc1
    buffer_load_dwordx4 v[64:67], v2, s[68:71], s14 offen offset:2048 sc1
    buffer_load_dwordx4 v[68:71], v2, s[68:71], s14 offen offset:3072 sc1
L_rl_30:
    s_waitcnt vmcnt(0)
    s_branch L_rva1
L_rya1:
    s_mov_b32 s96, 200000
    s_branch L_rxa1
L_rta2:
    s_sub_u32 s96, s96, 1
    s_cbranch_scc1 L_rya2
    v_and_b32 v3, v72, v76
    v_and_b32 v3, v3, v80
    v_and_b32 v3, v3, v84
    v_and_b32 v3, 1, v3
    v_cmp_ne_u32 vcc, 1, v3
    s_cbranch_vccz L_rl_31
    s_sub_u32 s14, s38, 4096
    buffer_load_dwordx4 v[72:75], v2, s[68:71], s14 offen offset:0 sc1
    buffer_load_dwordx4 v[76:79], v2, s[68:71], s14 offen offset:1024 sc1
    buffer_load_dwordx4 v[80:83], v2, s[68:71], s14 offen offset:2048 sc1
    buffer_load_dwordx4 v[84:87], v2, s[68:71], s14 offen offset:3072 sc1
L_rl_31:
    s_waitcnt vmcnt(0)
    s_branch L_rva2
L_rya2:
    s_mov_b32 s96, 200000
    s_branch L_rxa2
L_rta3:
    s_sub_u32 s96, s96, 1
    s_cbranch_scc1 L_rya3
    v_and_b32 v3, v88, v92
    v_and_b32 v3, v3, v96
    v_and_b32 v3, v3, v100
    v_and_b32 v3, 1, v3
    v_cmp_ne_u32 vcc, 1, v3
    s_cbranch_vccz L_rl_32
    s_sub_u32 s14, s39, 4096
    buffer_load_dwordx4 v[88:91], v2, s[68:71], s14 offen offset:0 sc1
    buffer_load_dwordx4 v[92:95], v2, s[68:71], s14 offen offset:1024 sc1
    buffer_load_dwordx4 v[96:99], v2, s[68:71], s14 offen offset:2048 sc1
    buffer_load_dwordx4 v[100:103], v2, s[68:71], s14 offen offset:3072 sc1
L_rl_32:
    s_waitcnt vmcnt(0)
    s_branch L_rva3
L_rya3:
    s_mov_b32 s96, 200000
    s_branch L_rxa3
L_rtB:
    s_sub_u32 s96, s96, 1
    s_cbranch_scc1 L_ryB
    v_and_b32 v3, v104, v108
    v_and_b32 v3, v3, v112
    v_and_b32 v3, v3, v116
    v_and_b32 v3, 1, v3
    v_cmp_ne_u32 vcc, 1, v3
    s_cbranch_vccz L_rl_33
    buffer_load_dwordx4 v[104:107], v2, s[68:71], s37 offen offset:0 sc1
    buffer_load_dwordx4 v[108:111], v2, s[68:71], s37 offen offset:1024 sc1
    buffer_load_dwordx4 v[112:115], v2, s[68:71], s37 offen offset:2048 sc1
    buffer_load_dwordx4 v[116:119], v2, s[68:71], s37 offen offset:3072 sc1
L_rl_33:
    v_and_b32 v3, v120, v124
    v_and_b32 v3, v3, v128
    v_and_b32 v3, v3, v132
    v_and_b32 v3, 1, v3
    v_cmp_ne_u32 vcc, 1, v3
    s_cbranch_vccz L_rl_34
    buffer_load_dwordx4 v[120:123], v2, s[68:71], s38 offen offset:0 sc1
    buffer_load_dwordx4 v[124:127], v2, s[68:71], s38 offen offset:1024 sc1
    buffer_load_dwordx4 v[128:131], v2, s[68:71], s38 offen offset:2048 sc1
    buffer_load_dwordx4 v[132:135], v2, s[68:71], s38 offen offset:3072 sc1
L_rl_34:
    v_and_b32 v3, v20, v24
    v_and_b32 v3, v3, v28
    v_and_b32 v3, v3, v32
    v_and_b32 v3, 1, v3
    v_cmp_ne_u32 vcc, 1, v3
    s_cbranch_vccz L_rl_35
    buffer_load_dwordx4 v[20:23], v2, s[68:71], s39 offen offset:0 sc1
    buffer_load_dwordx4 v[24:27], v2, s[68:71], s39 offen offset:1024 sc1
    buffer_load_dwordx4 v[28:31], v2, s[68:71], s39 offen offset:2048 sc1
    buffer_load_dwordx4 v[32:35], v2, s[68:71], s39 offen offset:3072 sc1
L_rl_35:
    v_and_b32 v3, v36, v240
    v_and_b32 v3, v3, v244
    v_and_b32 v3, v3, v248
    v_and_b32 v3, 1, v3
    v_cmp_ne_u32 vcc, 1, v3
    s_cbranch_vccz L_rl_36
    buffer_load_dwordx4 v[36:39], v2, s[68:71], s36 offen offset:0 sc1
    buffer_load_dwordx4 v[240:243], v2, s[68:71], s36 offen offset:1024 sc1
    buffer_load_dwordx4 v[244:247], v2, s[68:71], s36 offen offset:2048 sc1
    buffer_load_dwordx4 v[248:251], v2, s[68:71], s36 offen offset:3072 sc1
L_rl_36:
    s_waitcnt vmcnt(0)
    s_branch L_rvB
L_ryB:
    s_mov_b32 s96, 200000
    s_branch L_rxB
L_codeend:
    s_endpgm
.section .rodata,"a"
.p2align 6
.amdhsa_kernel concat_heads__mha_block_cached__mha_block_cached__near_ridge_kernel
  .amdhsa_next_free_vgpr 256
  .amdhsa_next_free_sgpr 102
  .amdhsa_accum_offset 256
  .amdhsa_group_segment_fixed_size 0
  .amdhsa_kernarg_size 104
  .amdhsa_user_sgpr_count 2
  .amdhsa_user_sgpr_kernarg_segment_ptr 1
  .amdhsa_system_sgpr_workgroup_id_x 1
.end_amdhsa_kernel
```
